```python
import torch

def _softmax(x, axis=-1):
    return torch.softmax(x, dim=axis)

def _gelu(x):
    return torch.nn.functional.gelu(x, approximate='tanh')

def _silu(x):
    return torch.nn.functional.silu(x)

def _sigmoid(x):
    return torch.sigmoid(x)

def _layernorm(x, axis=-1, eps=1e-05):
    m = x.mean(dim=axis, keepdim=True)
    v = x.var(dim=axis, keepdim=True, unbiased=False)
    return (x - m) / torch.sqrt(v + eps)

def _scatter_add(tgt, idx, src, axis=0):
    return tgt.clone().index_add_(axis, idx, src)

def _segment_sum(src, seg, n):
    out = torch.zeros((n,) + src.shape[1:], dtype=src.dtype)
    return out.index_add_(0, seg, src)

def _pad(x, pw):
    flat = tuple((v for pair in reversed(pw) for v in pair))
    return torch.nn.functional.pad(x, flat)
kernel_name = 'adaLN_cond__memory_aug_recurrent_mem_tr__dense_activation_relu__prompt'

def setup_inputs():

    _w = lambda a: (lambda t: t.to(torch.bfloat16) if t.is_floating_point() else t)(torch.as_tensor(a))

    def _A_setup():
        B, S, Dm = (1, 2048, 512)
        H, Dh = (32, 128)
        M, seg = (8, 32)
        seg = min(seg, S)
        S = S // seg * seg
        return {'x': _w((lambda *s: torch.randn(*s, dtype=torch.bfloat16) * 0.05)(B, S, Dm)), 'mem0': _w((lambda *s: torch.randn(*s, dtype=torch.bfloat16) * 0.4)(B, M, Dm)), 'Wq': _w((lambda *s: torch.randn(*s, dtype=torch.bfloat16) * 3.2)(Dm, H, Dh) * Dm ** (-0.5)), 'Wk': _w((lambda *s: torch.randn(*s, dtype=torch.bfloat16) * 3.2)(Dm, H, Dh) * Dm ** (-0.5)), 'Wv': _w((lambda *s: torch.randn(*s, dtype=torch.bfloat16) * 0.4)(Dm, H, Dh) * Dm ** (-0.5)), 'Wo': _w((lambda *s: torch.randn(*s, dtype=torch.bfloat16) * 0.4)(H, Dh, Dm) * (H * Dh) ** (-0.5)), 'seg_len': seg}
    _A_in = _A_setup()

    def _B_setup():
        B, S, D, Dff = (1, 2048, 512, 1792)
        return {'x': _w((lambda *s: torch.randn(*s, dtype=torch.bfloat16) * 0.05)(B, S, D)), 'w1': _w((lambda *s: torch.randn(*s, dtype=torch.bfloat16) * 0.05)(D, Dff)), 'w2': _w((lambda *s: torch.randn(*s, dtype=torch.bfloat16) * 0.05)(Dff, D))}
    _B_in = _B_setup()
    return {'A_x': _A_in['x'], 'A_mem0': _A_in['mem0'], 'A_Wq': _A_in['Wq'], 'A_Wk': _A_in['Wk'], 'A_Wv': _A_in['Wv'], 'A_Wo': _A_in['Wo'], 'A_seg_len': _A_in['seg_len'], 'B_x': _B_in['x'], 'B_w1': _B_in['w1'], 'B_w2': _B_in['w2'], 'c': _w((lambda *s: torch.randn(*s, dtype=torch.bfloat16) * 0.1)(1, 512) * 8.0), 'w_mod': _w((lambda *s: torch.randn(*s, dtype=torch.bfloat16) * 0.1)(512, 6 * 512) * 512 ** (-0.5) * 8.0)}

def reference(A_x, A_mem0, A_Wq, A_Wk, A_Wv, A_Wo, A_seg_len, B_x, B_w1, B_w2, c, w_mod):

    def _A_ref(x, mem0, Wq, Wk, Wv, Wo, seg_len):
        B, S, Dm = x.shape
        H, Dh = (Wq.shape[1], Wq.shape[2])
        M = mem0.shape[1]
        scale = Dh ** (-0.5)
        n_seg = S // seg_len
        L = M + seg_len
        idx = torch.arange(L)
        mask = (idx[:, None] < M) | (idx[:, None] >= idx[None, :])
        mem = mem0
        outs = []
        for s in range(n_seg):
            xs = x[:, s * seg_len:(s + 1) * seg_len, :].clone()
            h = torch.concatenate([mem, xs], axis=1)
            q = torch.einsum('btd,dhe->bhte', h, Wq)
            k = torch.einsum('btd,dhe->bhte', h, Wk)
            v = torch.einsum('btd,dhe->bhte', h, Wv)
            scores = torch.einsum('bhqe,bhke->bhqk', q, k) * scale
            scores = torch.where(mask[None, None], scores, -1000000000.0)
            p = _softmax(scores, axis=-1)
            o = torch.einsum('bhqk,bhke->bhqe', p, v)
            o = torch.einsum('bhte,hed->btd', o, Wo)
            mem = o[:, :M, :].clone()
            outs.append(o[:, M:, :])
        return torch.concatenate(outs, axis=1)

    def _B_ref(x, w1, w2):
        h = torch.einsum('bsd,df->bsf', x, w1)
        zero = torch.zeros_like(h)
        h = torch.maximum(h, zero)
        return torch.einsum('bsf,fd->bsd', h, w2)
    x = A_x
    mod = (_silu(c) @ w_mod).reshape(c.shape[0], 6, 1, -1)
    sa, ca, ga, sb, cb, gb = (mod[:, 0].clone(), mod[:, 1].clone(), mod[:, 2].clone(), mod[:, 3].clone(), mod[:, 4].clone(), mod[:, 5].clone())
    h = _layernorm(x, axis=-1) * (1 + ca) + sa
    x = x + ga * _A_ref(h, A_mem0, A_Wq, A_Wk, A_Wv, A_Wo, A_seg_len)
    h = _layernorm(x, axis=-1) * (1 + cb) + sb
    x = x + gb * _B_ref(h, B_w1, B_w2)
    return x
```

```asm
; @launch grid=(256,1,1) block=(256,1,1) lds=163840
.amdgcn_target "amdgcn-amd-amdhsa--gfx950"
.text
.globl adaLN_cond__memory_aug_recurrent_mem_tr__dense_activation_relu__prompt_kernel
.p2align 8
.type adaLN_cond__memory_aug_recurrent_mem_tr__dense_activation_relu__prompt_kernel,@function
adaLN_cond__memory_aug_recurrent_mem_tr__dense_activation_relu__prompt_kernel:
    s_cmp_ge_u32 s2, 256
    s_cbranch_scc1 L_exit
    s_getreg_b32 s101, hwreg(HW_REG_XCC_ID)
    s_sub_u32 s101, s101, s2
    s_and_b32 s101, s101, 7
    s_cmp_lg_u32 s2, 0
    s_cbranch_scc1 L_disp
    s_load_dwordx2 s[12:13], s[0:1], 104
    s_add_u32 s3, s101, 1
    v_mov_b32 v1, 140
    v_mov_b32 v2, s3
    s_waitcnt lgkmcnt(0)
    s_mov_b64 exec, 1
    global_store_dword v1, v2, s[12:13] sc1
    s_mov_b64 exec, -1
L_disp:
    s_add_u32 s3, s2, s101
    s_sub_u32 s3, s3, 3
    s_and_b32 s3, s3, 7
    s_cmp_lg_u32 s3, 0
    s_cbranch_scc1 L_bulk
    s_lshr_b32 s14, s2, 3
    s_load_dwordx2 s[8:9], s[0:1], 40
    s_load_dwordx4 s[52:55], s[0:1], 8
    s_load_dwordx4 s[56:59], s[0:1], 24
    s_load_dwordx2 s[12:13], s[0:1], 104
    s_load_dwordx2 s[4:5], s[0:1], 112
    v_lshrrev_b32 v115, 6, v0
    v_and_b32 v112, 63, v0
    v_readfirstlane_b32 s15, v115
    s_mov_b32 s10, 4194304
    s_mov_b32 s11, 0x20000
    v_and_b32 v113, 15, v112
    v_lshrrev_b32 v114, 4, v112
    v_and_b32 v117, 1, v114
    s_mul_i32 s41, s15, 34816
    s_add_u32 s41, s41, 24576
    v_lshrrev_b32 v115, 3, v113
    v_lshl_add_u32 v115, v117, 4, v115
    v_lshrrev_b32 v116, 1, v114
    v_lshl_add_u32 v115, v116, 2, v115
    v_and_b32 v116, 7, v113
    v_lshlrev_b32 v116, 4, v116
    v_lshlrev_b32 v118, 6, v117
    v_xor_b32 v116, v116, v118
    v_lshl_add_u32 v118, v115, 10, v116
    s_lshl_b32 s42, s14, 17
    s_lshl_b32 s43, s15, 8
    s_add_u32 s42, s42, s43
    s_xor_b32 s64, s15, 0
    s_lshl_b32 s64, s64, 15
    s_add_u32 s64, s64, s42
    s_xor_b32 s65, s15, 1
    s_lshl_b32 s65, s65, 15
    s_add_u32 s65, s65, s42
    s_xor_b32 s66, s15, 2
    s_lshl_b32 s66, s66, 15
    s_add_u32 s66, s66, s42
    s_xor_b32 s67, s15, 3
    s_lshl_b32 s67, s67, 15
    s_add_u32 s67, s67, s42
    s_waitcnt lgkmcnt(0)
    s_add_u32 m0, s41, 4096
    s_add_u32 s49, s64, 0
    buffer_load_dwordx4 v118, s[8:11], s49 offen nt lds
    s_add_u32 m0, s41, 5120
    s_add_u32 s49, s64, 2048
    buffer_load_dwordx4 v118, s[8:11], s49 offen nt lds
    s_add_u32 m0, s41, 6144
    s_add_u32 s49, s64, 8192
    buffer_load_dwordx4 v118, s[8:11], s49 offen nt lds
    s_add_u32 m0, s41, 7168
    s_add_u32 s49, s64, 10240
    buffer_load_dwordx4 v118, s[8:11], s49 offen nt lds
    s_add_u32 m0, s41, 8192
    s_add_u32 s49, s65, 0
    buffer_load_dwordx4 v118, s[8:11], s49 offen nt lds
    s_add_u32 m0, s41, 9216
    s_add_u32 s49, s65, 2048
    buffer_load_dwordx4 v118, s[8:11], s49 offen nt lds
    s_add_u32 m0, s41, 10240
    s_add_u32 s49, s65, 8192
    buffer_load_dwordx4 v118, s[8:11], s49 offen nt lds
    s_add_u32 m0, s41, 11264
    s_add_u32 s49, s65, 10240
    buffer_load_dwordx4 v118, s[8:11], s49 offen nt lds
    s_add_u32 m0, s41, 12288
    s_add_u32 s49, s66, 0
    buffer_load_dwordx4 v118, s[8:11], s49 offen nt lds
    s_add_u32 m0, s41, 13312
    s_add_u32 s49, s66, 2048
    buffer_load_dwordx4 v118, s[8:11], s49 offen nt lds
    s_add_u32 m0, s41, 14336
    s_add_u32 s49, s66, 8192
    buffer_load_dwordx4 v118, s[8:11], s49 offen nt lds
    s_add_u32 m0, s41, 15360
    s_add_u32 s49, s66, 10240
    buffer_load_dwordx4 v118, s[8:11], s49 offen nt lds
    s_add_u32 m0, s41, 16384
    s_add_u32 s49, s64, 128
    buffer_load_dwordx4 v118, s[8:11], s49 offen nt lds
    s_add_u32 m0, s41, 17408
    s_add_u32 s49, s64, 2176
    buffer_load_dwordx4 v118, s[8:11], s49 offen nt lds
    s_add_u32 m0, s41, 18432
    s_add_u32 s49, s64, 8320
    buffer_load_dwordx4 v118, s[8:11], s49 offen nt lds
    s_add_u32 m0, s41, 19456
    s_add_u32 s49, s64, 10368
    buffer_load_dwordx4 v118, s[8:11], s49 offen nt lds
    s_mov_b32 s60, s8
    s_mov_b32 s61, s9
    s_mov_b32 s6, 268435456
    s_mov_b32 s7, 0x20000
    v_lshlrev_b32 v2, 4, v112
    v_add_u32 v3, s41, v2
    s_add_u32 s39, s41, 32768
    s_lshl_b32 s43, s15, 11
    s_add_u32 s37, s43, 16384
    s_lshl_b32 s100, s15, 10
    v_and_b32 v115, 1, v112
    v_mul_u32_u24 v115, 0xaaaa, v115
    v_add_u32 v1, 0x4444, v115
    s_lshl_b32 s44, s15, 9
    v_lshrrev_b32 v127, 2, v113
    v_lshlrev_b32 v4, 7, v127
    v_and_b32 v115, 1, v127
    v_lshlrev_b32 v115, 6, v115
    v_lshlrev_b32 v116, 5, v114
    v_xor_b32 v115, v115, v116
    v_add_u32 v4, v4, v115
    v_and_b32 v115, 3, v113
    v_lshl_add_u32 v4, v115, 2, v4
    v_add_u32 v4, s44, v4
    v_add_u32 v4, 8192, v4
    v_lshlrev_b32 v115, 3, v112
    v_add_u32 v7, s44, v115
    v_and_b32 v8, -9, v7
    v_and_b32 v115, -9, v115
    v_lshlrev_b32 v116, 6, v117
    v_xor_b32 v5, v115, v116
    v_bfe_u32 v115, v113, 1, 2
    v_lshlrev_b32 v6, 2, v115
    v_and_b32 v115, 1, v113
    v_lshl_add_u32 v6, v115, 4, v6
    v_lshl_add_u32 v6, v114, 6, v6
    v_lshrrev_b32 v115, 3, v113
    v_lshl_add_u32 v6, v115, 8, v6
    v_add_u32 v6, s44, v6
    v_add_u32 v6, 10240, v6
    v_lshlrev_b32 v10, 6, v115
    v_and_b32 v115, 1, v127
    v_lshl_add_u32 v10, v115, 7, v10
    v_lshl_add_u32 v10, v117, 5, v10
    v_and_b32 v115, 3, v113
    v_lshl_add_u32 v10, v115, 3, v10
    v_lshrrev_b32 v116, 1, v114
    v_lshl_add_u32 v10, v116, 31, v10
    v_lshlrev_b32 v121, 8, v114
    v_lshl_add_u32 v121, v115, 3, v121
    v_lshl_add_u32 v121, v117, 6, v121
    v_and_b32 v116, 1, v127
    v_lshl_add_u32 v121, v116, 7, v121
    v_lshrrev_b32 v116, 1, v127
    v_lshl_add_u32 v121, v116, 5, v121
    v_add_u32 v121, s41, v121
    v_xor_b32 v122, 64, v121
    v_lshl_add_u32 v116, v117, 2, v127
    s_lshl_b32 s45, s15, 1
    v_xor_b32 v116, s45, v116
    v_lshlrev_b32 v123, 10, v114
    v_lshl_add_u32 v123, v127, 8, v123
    v_lshl_add_u32 v123, v116, 5, v123
    v_lshl_add_u32 v123, v115, 3, v123
    v_add_u32 v123, 24576, v123
    v_xor_b32 v124, 32, v123
    v_add_u32 v125, 69632, v123
    v_add_u32 v126, 69632, v124
    s_lshl_b32 s46, s14, 8
    v_and_b32 v116, 2, v114
    v_lshlrev_b32 v116, 1, v116
    v_lshl_add_u32 v116, v117, 4, v116
    v_lshlrev_b32 v115, 1, v114
    v_xor_b32 v115, v115, v113
    v_lshlrev_b32 v115, 4, v115
    v_lshl_add_u32 v119, v116, 13, v115
    s_lshl_b32 s45, s15, 18
    s_and_b32 s45, s15, 1
    s_lshl_b32 s45, s45, 13
    s_lshr_b32 s47, s15, 1
    s_lshl_b32 s47, s47, 18
    s_add_u32 s45, s45, s47
    s_add_u32 s45, s45, s46
    v_add_u32 v119, s45, v119
    v_xor_b32 v120, 128, v119
    s_lshl_b32 s45, s15, 15
    v_lshlrev_b32 v115, 11, v127
    v_add_u32 v115, s46, v115
    v_and_b32 v115, 0x1fff, v115
    v_lshl_add_u32 v9, v114, 13, v115
    v_lshl_add_u32 v9, v113, 4, v9
    v_add_u32 v9, s45, v9
    v_bfe_u32 v115, v112, 3, 2
    v_lshlrev_b32 v115, 11, v115
    v_add_u32 v115, s46, v115
    v_and_b32 v115, 0x1fff, v115
    v_lshrrev_b32 v116, 5, v112
    v_lshl_add_u32 v9, v116, 13, v115
    v_and_b32 v116, 31, v112
    v_lshl_add_u32 v9, v116, 3, v9
    s_lshl_b32 s45, s15, 14
    v_add_u32 v9, s45, v9
    s_mov_b32 s17, 0x3e0293ee
    s_mov_b32 s94, 0x3e0293ee
    s_mov_b32 s95, 0x3e0293ee
    s_mov_b32 s16, 0x0
    s_mov_b32 s36, 0x0
    s_mov_b32 s29, 0x0
    s_mov_b32 s96, 0x0
    s_mov_b32 s35, 0x0
    s_mov_b32 s27, 0xc0000
    s_mov_b32 s92, 0x3f803f80
    s_mov_b32 s93, 0x3f803f80
    s_mov_b32 s88, 0xaaaaaaaa
    s_mov_b32 s89, 0xaaaaaaaa
    s_mov_b32 s50, 0x10001
    s_mov_b32 s51, 0x0
    s_and_b32 s99, s14, 1
    s_lshl_b32 s99, s99, 8
    s_add_u32 s99, s99, 80805888
    s_lshl_b32 s98, s14, 2
    s_add_u32 s98, s98, 80805888
    s_lshl_b32 s30, s14, 13
    s_add_u32 s30, s30, 79691776
    s_add_u32 s26, s30, s43
    s_bfe_u32 s47, s14, 0x20002
    s_lshl_b32 s32, s47, 10
    s_lshr_b32 s47, s14, 4
    s_lshl_b32 s47, s47, 9
    s_add_u32 s32, s32, s47
    s_and_b32 s47, s14, 3
    s_lshl_b32 s47, s47, 7
    s_add_u32 s32, s32, s47
    s_add_u32 s32, s32, 80740352
    s_add_u32 s32, s46, 80740352
    s_and_b32 s32, s14, 17
    s_lshl_b32 s32, s32, 8
    s_and_b32 s47, s14, 6
    s_lshl_b32 s47, s47, 9
    s_add_u32 s32, s32, s47
    s_and_b32 s47, s14, 8
    s_lshl_b32 s47, s47, 6
    s_add_u32 s32, s32, s47
    s_add_u32 s32, s32, 80740352
    s_lshl_b32 s18, s14, 20
    s_add_u32 s18, s18, s43
    s_add_u32 s18, s18, 0
    s_add_u32 s19, s18, 8192
    s_lshl_b32 s20, s14, 18
    s_add_u32 s20, s20, s100
    s_add_u32 s20, s20, 51380224
    s_lshl_b32 s38, s14, 7
    s_add_u32 s40, s38, 80876544
    s_add_u32 s38, s38, 80872448
    v_mov_b64 v[16:17], 0
    v_mov_b64 v[18:19], 0
    v_mov_b64 v[12:13], -1
    v_mov_b64 v[14:15], -1
    v_and_b32 v115, 4, v113
    v_lshlrev_b32 v115, 2, v115
    v_mov_b32 v116, 0x3f80
    v_lshlrev_b32 v116, v115, v116
    v_bfe_u32 v115, v113, 1, 1
    v_cmp_eq_u32 vcc, 0, v115
    s_nop 1
    v_cndmask_b32 v48, 0, v116, vcc
    v_cmp_eq_u32 vcc, 1, v115
    s_nop 1
    v_cndmask_b32 v49, 0, v116, vcc
    v_cmp_eq_u32 vcc, 0, v115
    s_nop 1
    v_cndmask_b32 v50, 0, v116, vcc
    v_cmp_eq_u32 vcc, 1, v115
    s_nop 1
    v_cndmask_b32 v51, 0, v116, vcc
    ds_write_b128 v2, v[48:51] offset:14336
    v_lshrrev_b32 v0, 1, v113
    v_lshlrev_b32 v0, 10, v0
    v_lshl_add_u32 v0, v117, 4, v0
    v_and_b32 v115, 2, v114
    v_lshl_add_u32 v0, v115, 5, v0
    v_and_b32 v115, 1, v113
    v_lshl_add_u32 v0, v115, 3, v0
    s_lshl_b32 s47, s15, 8
    v_add_u32 v0, s47, v0
    s_mov_b32 s8, s60
    s_mov_b32 s9, s61
    s_add_u32 m0, s41, 20480
    s_add_u32 s49, s65, 128
    buffer_load_dwordx4 v118, s[8:11], s49 offen nt lds
    s_add_u32 m0, s41, 21504
    s_add_u32 s49, s65, 2176
    buffer_load_dwordx4 v118, s[8:11], s49 offen nt lds
    s_add_u32 m0, s41, 22528
    s_add_u32 s49, s65, 8320
    buffer_load_dwordx4 v118, s[8:11], s49 offen nt lds
    s_add_u32 m0, s41, 23552
    s_add_u32 s49, s65, 10368
    buffer_load_dwordx4 v118, s[8:11], s49 offen nt lds
    s_mov_b32 s8, s60
    s_mov_b32 s9, s61
    s_add_u32 m0, s41, 24576
    s_add_u32 s49, s66, 128
    buffer_load_dwordx4 v118, s[8:11], s49 offen nt lds
    s_add_u32 m0, s41, 25600
    s_add_u32 s49, s66, 2176
    buffer_load_dwordx4 v118, s[8:11], s49 offen nt lds
    s_add_u32 m0, s41, 26624
    s_add_u32 s49, s66, 8320
    buffer_load_dwordx4 v118, s[8:11], s49 offen nt lds
    s_add_u32 m0, s41, 27648
    s_add_u32 s49, s66, 10368
    buffer_load_dwordx4 v118, s[8:11], s49 offen nt lds
    s_mov_b32 s8, s60
    s_mov_b32 s9, s61
    s_add_u32 m0, s41, 28672
    s_add_u32 s49, s67, 128
    buffer_load_dwordx4 v118, s[8:11], s49 offen nt lds
    s_add_u32 m0, s41, 29696
    s_add_u32 s49, s67, 2176
    buffer_load_dwordx4 v118, s[8:11], s49 offen nt lds
    s_add_u32 m0, s41, 30720
    s_add_u32 s49, s67, 8320
    buffer_load_dwordx4 v118, s[8:11], s49 offen nt lds
    s_add_u32 m0, s41, 31744
    s_add_u32 s49, s67, 10368
    buffer_load_dwordx4 v118, s[8:11], s49 offen nt lds
    global_load_dword v24, v0, s[52:53] offset:0
    global_load_dword v25, v0, s[52:53] offset:32
    global_load_dword v26, v0, s[52:53] offset:4
    global_load_dword v27, v0, s[52:53] offset:36
    global_load_dword v28, v0, s[52:53] offset:128
    global_load_dword v29, v0, s[52:53] offset:160
    global_load_dword v30, v0, s[52:53] offset:132
    global_load_dword v31, v0, s[52:53] offset:164
    v_mov_b32 v21, 140
    global_load_dword v21, v21, s[12:13] sc1
    v_and_b32 v11, 0x270, v2
    v_and_b32 v115, 0x80, v2
    v_lshl_add_u32 v11, v115, 1, v11
    v_and_b32 v115, 0x100, v2
    v_lshrrev_b32 v115, 1, v115
    v_or_b32 v11, v11, v115
    s_cmp_eq_u32 s15, 1
    s_cselect_b64 vcc, -1, 0
    v_cndmask_b32 v10, v10, v11, vcc
    s_waitcnt vmcnt(33)
    s_barrier
    s_mov_b32 s8, s56
    s_mov_b32 s9, s57
    s_add_u32 m0, s41, 0
    s_mov_b32 s49, 0
    buffer_load_dwordx4 v119, s[8:11], s49 offen nt lds
    s_add_u32 m0, s41, 1024
    s_mov_b32 s49, 16384
    buffer_load_dwordx4 v120, s[8:11], s49 offen nt lds
    s_add_u32 m0, s41, 2048
    s_mov_b32 s49, 65536
    buffer_load_dwordx4 v119, s[8:11], s49 offen nt lds
    s_add_u32 m0, s41, 3072
    s_mov_b32 s49, 81920
    buffer_load_dwordx4 v120, s[8:11], s49 offen nt lds
    ds_read_b64_tr_b16 v[192:193], v121 offset:4096
    ds_read_b64_tr_b16 v[200:201], v122 offset:4096
    ds_read_b64_tr_b16 v[194:195], v121 offset:5120
    ds_read_b64_tr_b16 v[202:203], v122 offset:5120
    ds_read_b64_tr_b16 v[196:197], v121 offset:6144
    ds_read_b64_tr_b16 v[204:205], v122 offset:6144
    ds_read_b64_tr_b16 v[198:199], v121 offset:7168
    ds_read_b64_tr_b16 v[206:207], v122 offset:7168
    s_waitcnt lgkmcnt(0)
    s_waitcnt vmcnt(33)
    s_barrier
    s_mov_b32 s8, s56
    s_mov_b32 s9, s57
    s_add_u32 m0, s41, 4096
    s_mov_b32 s49, 1048576
    buffer_load_dwordx4 v119, s[8:11], s49 offen nt lds
    s_add_u32 m0, s41, 5120
    s_mov_b32 s49, 1064960
    buffer_load_dwordx4 v120, s[8:11], s49 offen nt lds
    s_add_u32 m0, s41, 6144
    s_mov_b32 s49, 1114112
    buffer_load_dwordx4 v119, s[8:11], s49 offen nt lds
    s_add_u32 m0, s41, 7168
    s_mov_b32 s49, 1130496
    buffer_load_dwordx4 v120, s[8:11], s49 offen nt lds
    ds_read_b64_tr_b16 v[208:209], v121 offset:8192
    ds_read_b64_tr_b16 v[216:217], v122 offset:8192
    ds_read_b64_tr_b16 v[210:211], v121 offset:9216
    ds_read_b64_tr_b16 v[218:219], v122 offset:9216
    ds_read_b64_tr_b16 v[212:213], v121 offset:10240
    ds_read_b64_tr_b16 v[220:221], v122 offset:10240
    ds_read_b64_tr_b16 v[214:215], v121 offset:11264
    ds_read_b64_tr_b16 v[222:223], v122 offset:11264
    s_waitcnt lgkmcnt(0)
    s_waitcnt vmcnt(33)
    s_barrier
    s_mov_b32 s8, s56
    s_mov_b32 s9, s57
    s_add_u32 m0, s41, 8192
    s_mov_b32 s49, 2097152
    buffer_load_dwordx4 v119, s[8:11], s49 offen nt lds
    s_add_u32 m0, s41, 9216
    s_mov_b32 s49, 2113536
    buffer_load_dwordx4 v120, s[8:11], s49 offen nt lds
    s_add_u32 m0, s41, 10240
    s_mov_b32 s49, 2162688
    buffer_load_dwordx4 v119, s[8:11], s49 offen nt lds
    s_add_u32 m0, s41, 11264
    s_mov_b32 s49, 2179072
    buffer_load_dwordx4 v120, s[8:11], s49 offen nt lds
    ds_read_b64_tr_b16 v[224:225], v121 offset:12288
    ds_read_b64_tr_b16 v[232:233], v122 offset:12288
    ds_read_b64_tr_b16 v[226:227], v121 offset:13312
    ds_read_b64_tr_b16 v[234:235], v122 offset:13312
    ds_read_b64_tr_b16 v[228:229], v121 offset:14336
    ds_read_b64_tr_b16 v[236:237], v122 offset:14336
    ds_read_b64_tr_b16 v[230:231], v121 offset:15360
    ds_read_b64_tr_b16 v[238:239], v122 offset:15360
    s_waitcnt lgkmcnt(0)
    s_waitcnt vmcnt(33)
    s_barrier
    s_mov_b32 s8, s56
    s_mov_b32 s9, s57
    s_add_u32 m0, s41, 12288
    s_mov_b32 s49, 3145728
    buffer_load_dwordx4 v119, s[8:11], s49 offen nt lds
    s_add_u32 m0, s41, 13312
    s_mov_b32 s49, 3162112
    buffer_load_dwordx4 v120, s[8:11], s49 offen nt lds
    s_add_u32 m0, s41, 14336
    s_mov_b32 s49, 3211264
    buffer_load_dwordx4 v119, s[8:11], s49 offen nt lds
    s_add_u32 m0, s41, 15360
    s_mov_b32 s49, 3227648
    buffer_load_dwordx4 v120, s[8:11], s49 offen nt lds
    ds_read_b64_tr_b16 v[240:241], v121 offset:16384
    ds_read_b64_tr_b16 v[248:249], v122 offset:16384
    ds_read_b64_tr_b16 v[242:243], v121 offset:17408
    ds_read_b64_tr_b16 v[250:251], v122 offset:17408
    ds_read_b64_tr_b16 v[244:245], v121 offset:18432
    ds_read_b64_tr_b16 v[252:253], v122 offset:18432
    ds_read_b64_tr_b16 v[246:247], v121 offset:19456
    ds_read_b64_tr_b16 v[254:255], v122 offset:19456
    s_waitcnt lgkmcnt(0)
    s_waitcnt vmcnt(33)
    s_barrier
    s_mov_b32 s8, s56
    s_mov_b32 s9, s57
    s_add_u32 m0, s41, 16384
    s_mov_b32 s49, 524288
    buffer_load_dwordx4 v119, s[8:11], s49 offen nt lds
    s_add_u32 m0, s41, 17408
    s_mov_b32 s49, 540672
    buffer_load_dwordx4 v120, s[8:11], s49 offen nt lds
    s_add_u32 m0, s41, 18432
    s_mov_b32 s49, 589824
    buffer_load_dwordx4 v119, s[8:11], s49 offen nt lds
    s_add_u32 m0, s41, 19456
    s_mov_b32 s49, 606208
    buffer_load_dwordx4 v120, s[8:11], s49 offen nt lds
    ds_read_b64_tr_b16 v[48:49], v121 offset:20480
    ds_read_b64_tr_b16 v[56:57], v122 offset:20480
    ds_read_b64_tr_b16 v[50:51], v121 offset:21504
    ds_read_b64_tr_b16 v[58:59], v122 offset:21504
    ds_read_b64_tr_b16 v[52:53], v121 offset:22528
    ds_read_b64_tr_b16 v[60:61], v122 offset:22528
    ds_read_b64_tr_b16 v[54:55], v121 offset:23552
    ds_read_b64_tr_b16 v[62:63], v122 offset:23552
    s_waitcnt lgkmcnt(0)
    ds_write_b128 v3, v[48:51] offset:20480
    ds_write_b128 v3, v[52:55] offset:21504
    ds_write_b128 v3, v[56:59] offset:22528
    ds_write_b128 v3, v[60:63] offset:23552
    s_waitcnt vmcnt(33)
    s_barrier
    ds_read_b64_tr_b16 v[48:49], v121 offset:24576
    ds_read_b64_tr_b16 v[56:57], v122 offset:24576
    ds_read_b64_tr_b16 v[50:51], v121 offset:25600
    ds_read_b64_tr_b16 v[58:59], v122 offset:25600
    ds_read_b64_tr_b16 v[52:53], v121 offset:26624
    ds_read_b64_tr_b16 v[60:61], v122 offset:26624
    ds_read_b64_tr_b16 v[54:55], v121 offset:27648
    ds_read_b64_tr_b16 v[62:63], v122 offset:27648
    s_waitcnt lgkmcnt(0)
    ds_write_b128 v3, v[48:51] offset:24576
    ds_write_b128 v3, v[52:55] offset:25600
    ds_write_b128 v3, v[56:59] offset:26624
    ds_write_b128 v3, v[60:63] offset:27648
    s_waitcnt vmcnt(29)
    s_barrier
    ds_read_b64_tr_b16 v[48:49], v121 offset:28672
    ds_read_b64_tr_b16 v[56:57], v122 offset:28672
    ds_read_b64_tr_b16 v[50:51], v121 offset:29696
    ds_read_b64_tr_b16 v[58:59], v122 offset:29696
    ds_read_b64_tr_b16 v[52:53], v121 offset:30720
    ds_read_b64_tr_b16 v[60:61], v122 offset:30720
    ds_read_b64_tr_b16 v[54:55], v121 offset:31744
    ds_read_b64_tr_b16 v[62:63], v122 offset:31744
    s_waitcnt lgkmcnt(0)
    ds_write_b128 v3, v[48:51] offset:28672
    ds_write_b128 v3, v[52:55] offset:29696
    ds_write_b128 v3, v[56:59] offset:30720
    ds_write_b128 v3, v[60:63] offset:31744
    s_waitcnt vmcnt(16)
    s_barrier
    ds_read_b64_tr_b16 a[64:65], v123 offset:0
    ds_read_b64_tr_b16 a[72:73], v124 offset:0
    ds_read_b64_tr_b16 a[66:67], v123 offset:34816
    ds_read_b64_tr_b16 a[74:75], v124 offset:34816
    ds_read_b64_tr_b16 a[68:69], v125 offset:0
    ds_read_b64_tr_b16 a[76:77], v126 offset:0
    ds_read_b64_tr_b16 a[70:71], v125 offset:34816
    ds_read_b64_tr_b16 a[78:79], v126 offset:34816
    s_waitcnt lgkmcnt(0)
    s_waitcnt vmcnt(12)
    s_waitcnt vmcnt(20)
L_vfc:
    v_readfirstlane_b32 s44, v21
    s_add_u32 s96, s96, 1
    s_cmp_gt_u32 s96, 0x200000
    s_cbranch_scc1 L_vxc
    s_cmp_lg_u32 s44, 0
    s_cbranch_scc1 L_vgc
    v_mov_b32 v21, 140
    global_load_dword v21, v21, s[12:13] sc1
    s_waitcnt vmcnt(0)
    s_branch L_vfc
L_vgc:
    s_sub_u32 s44, s44, 1
    s_and_b32 s44, s44, 7
    s_cmp_eq_u32 s44, s101
    s_cbranch_scc1 L_vxc
    s_mov_b32 s101, s44
    s_branch L_restart
L_vxc:
    s_barrier
    s_mov_b32 s8, s56
    s_mov_b32 s9, s57
    s_add_u32 m0, s41, 0
    s_mov_b32 s49, 1572864
    buffer_load_dwordx4 v119, s[8:11], s49 offen nt lds
    s_add_u32 m0, s41, 1024
    s_mov_b32 s49, 1589248
    buffer_load_dwordx4 v120, s[8:11], s49 offen nt lds
    s_add_u32 m0, s41, 2048
    s_mov_b32 s49, 1638400
    buffer_load_dwordx4 v119, s[8:11], s49 offen nt lds
    s_add_u32 m0, s41, 3072
    s_mov_b32 s49, 1654784
    buffer_load_dwordx4 v120, s[8:11], s49 offen nt lds
    s_mov_b32 s44, 0x05040100
    s_mov_b32 s45, 0x07060302
    v_add_u32 v0, s100, v2
    v_perm_b32 v80, v25, v24, s44
    v_perm_b32 v82, v27, v26, s44
    v_perm_b32 v81, v25, v24, s45
    v_perm_b32 v83, v27, v26, s45
    ds_write_b128 v0, v[80:83] offset:0
    v_perm_b32 v84, v29, v28, s44
    v_perm_b32 v86, v31, v30, s44
    v_perm_b32 v85, v29, v28, s45
    v_perm_b32 v87, v31, v30, s45
    ds_write_b128 v0, v[84:87] offset:4096
    s_cmp_lg_u32 s15, 0
    s_cbranch_scc1 L_ch_noarr
    s_getreg_b32 s47, hwreg(HW_REG_XCC_ID)
    s_and_b32 s47, s47, 7
    s_lshl_b32 s47, s47, 3
    s_lshl_b64 s[44:45], 1, s47
    v_mov_b32 v24, s44
    v_mov_b32 v25, s45
    s_mov_b64 exec, 1
    global_atomic_add_x2 v17, v[24:25], s[12:13]
    s_mov_b64 exec, -1
L_ch_noarr:
    ds_read_b64_tr_b16 a[80:81], v123 offset:4096
    ds_read_b64_tr_b16 a[88:89], v124 offset:4096
    ds_read_b64_tr_b16 a[82:83], v123 offset:38912
    ds_read_b64_tr_b16 a[90:91], v124 offset:38912
    ds_read_b64_tr_b16 a[84:85], v125 offset:4096
    ds_read_b64_tr_b16 a[92:93], v126 offset:4096
    ds_read_b64_tr_b16 a[86:87], v125 offset:38912
    ds_read_b64_tr_b16 a[94:95], v126 offset:38912
    s_waitcnt lgkmcnt(0)
    s_waitcnt vmcnt(12)
    s_barrier
    s_mov_b32 s8, s56
    s_mov_b32 s9, s57
    s_add_u32 m0, s41, 4096
    s_mov_b32 s49, 2621440
    buffer_load_dwordx4 v119, s[8:11], s49 offen nt lds
    s_add_u32 m0, s41, 5120
    s_mov_b32 s49, 2637824
    buffer_load_dwordx4 v120, s[8:11], s49 offen nt lds
    s_add_u32 m0, s41, 6144
    s_mov_b32 s49, 2686976
    buffer_load_dwordx4 v119, s[8:11], s49 offen nt lds
    s_add_u32 m0, s41, 7168
    s_mov_b32 s49, 2703360
    buffer_load_dwordx4 v120, s[8:11], s49 offen nt lds
    ds_read_b64_tr_b16 a[96:97], v123 offset:8192
    ds_read_b64_tr_b16 a[104:105], v124 offset:8192
    ds_read_b64_tr_b16 a[98:99], v123 offset:43008
    ds_read_b64_tr_b16 a[106:107], v124 offset:43008
    ds_read_b64_tr_b16 a[100:101], v125 offset:8192
    ds_read_b64_tr_b16 a[108:109], v126 offset:8192
    ds_read_b64_tr_b16 a[102:103], v125 offset:43008
    ds_read_b64_tr_b16 a[110:111], v126 offset:43008
    s_waitcnt lgkmcnt(0)
    s_waitcnt vmcnt(12)
    s_barrier
    s_mov_b32 s8, s56
    s_mov_b32 s9, s57
    s_add_u32 m0, s41, 8192
    s_mov_b32 s49, 3670016
    buffer_load_dwordx4 v119, s[8:11], s49 offen nt lds
    s_add_u32 m0, s41, 9216
    s_mov_b32 s49, 3686400
    buffer_load_dwordx4 v120, s[8:11], s49 offen nt lds
    s_add_u32 m0, s41, 10240
    s_mov_b32 s49, 3735552
    buffer_load_dwordx4 v119, s[8:11], s49 offen nt lds
    s_add_u32 m0, s41, 11264
    s_mov_b32 s49, 3751936
    buffer_load_dwordx4 v120, s[8:11], s49 offen nt lds
    ds_read_b64_tr_b16 a[112:113], v123 offset:12288
    ds_read_b64_tr_b16 a[120:121], v124 offset:12288
    ds_read_b64_tr_b16 a[114:115], v123 offset:47104
    ds_read_b64_tr_b16 a[122:123], v124 offset:47104
    ds_read_b64_tr_b16 a[116:117], v125 offset:12288
    ds_read_b64_tr_b16 a[124:125], v126 offset:12288
    ds_read_b64_tr_b16 a[118:119], v125 offset:47104
    ds_read_b64_tr_b16 a[126:127], v126 offset:47104
    s_waitcnt lgkmcnt(0)
    s_waitcnt vmcnt(12)
    s_barrier
    s_mov_b32 s8, s58
    s_mov_b32 s9, s59
    s_add_u32 m0, s41, 12288
    s_mov_b32 s49, 0
    buffer_load_dwordx4 v119, s[8:11], s49 offen nt lds
    s_add_u32 m0, s41, 13312
    s_mov_b32 s49, 16384
    buffer_load_dwordx4 v120, s[8:11], s49 offen nt lds
    s_add_u32 m0, s41, 14336
    s_mov_b32 s49, 65536
    buffer_load_dwordx4 v119, s[8:11], s49 offen nt lds
    s_add_u32 m0, s41, 15360
    s_mov_b32 s49, 81920
    buffer_load_dwordx4 v120, s[8:11], s49 offen nt lds
    ds_read_b64_tr_b16 a[128:129], v123 offset:16384
    ds_read_b64_tr_b16 a[136:137], v124 offset:16384
    ds_read_b64_tr_b16 a[130:131], v123 offset:51200
    ds_read_b64_tr_b16 a[138:139], v124 offset:51200
    ds_read_b64_tr_b16 a[132:133], v125 offset:16384
    ds_read_b64_tr_b16 a[140:141], v126 offset:16384
    ds_read_b64_tr_b16 a[134:135], v125 offset:51200
    ds_read_b64_tr_b16 a[142:143], v126 offset:51200
    s_waitcnt lgkmcnt(0)
    s_waitcnt vmcnt(12)
    s_barrier
    s_mov_b32 s8, s58
    s_mov_b32 s9, s59
    s_add_u32 m0, s41, 16384
    s_mov_b32 s49, 1048576
    buffer_load_dwordx4 v119, s[8:11], s49 offen nt lds
    s_add_u32 m0, s41, 17408
    s_mov_b32 s49, 1064960
    buffer_load_dwordx4 v120, s[8:11], s49 offen nt lds
    s_add_u32 m0, s41, 18432
    s_mov_b32 s49, 1114112
    buffer_load_dwordx4 v119, s[8:11], s49 offen nt lds
    s_add_u32 m0, s41, 19456
    s_mov_b32 s49, 1130496
    buffer_load_dwordx4 v120, s[8:11], s49 offen nt lds
    ds_read_b64_tr_b16 a[144:145], v123 offset:0
    ds_read_b64_tr_b16 a[152:153], v124 offset:0
    ds_read_b64_tr_b16 a[146:147], v123 offset:34816
    ds_read_b64_tr_b16 a[154:155], v124 offset:34816
    ds_read_b64_tr_b16 a[148:149], v125 offset:0
    ds_read_b64_tr_b16 a[156:157], v126 offset:0
    ds_read_b64_tr_b16 a[150:151], v125 offset:34816
    ds_read_b64_tr_b16 a[158:159], v126 offset:34816
    s_waitcnt lgkmcnt(0)
    s_waitcnt vmcnt(12)
    s_barrier
    s_mov_b32 s8, s58
    s_mov_b32 s9, s59
    s_add_u32 m0, s41, 0
    s_mov_b32 s49, 2097152
    buffer_load_dwordx4 v119, s[8:11], s49 offen nt lds
    s_add_u32 m0, s41, 1024
    s_mov_b32 s49, 2113536
    buffer_load_dwordx4 v120, s[8:11], s49 offen nt lds
    s_add_u32 m0, s41, 2048
    s_mov_b32 s49, 2162688
    buffer_load_dwordx4 v119, s[8:11], s49 offen nt lds
    s_add_u32 m0, s41, 3072
    s_mov_b32 s49, 2179072
    buffer_load_dwordx4 v120, s[8:11], s49 offen nt lds
    ds_read_b64_tr_b16 a[160:161], v123 offset:4096
    ds_read_b64_tr_b16 a[168:169], v124 offset:4096
    ds_read_b64_tr_b16 a[162:163], v123 offset:38912
    ds_read_b64_tr_b16 a[170:171], v124 offset:38912
    ds_read_b64_tr_b16 a[164:165], v125 offset:4096
    ds_read_b64_tr_b16 a[172:173], v126 offset:4096
    ds_read_b64_tr_b16 a[166:167], v125 offset:38912
    ds_read_b64_tr_b16 a[174:175], v126 offset:38912
    s_waitcnt lgkmcnt(0)
    v_mov_b32 v0, 136
    global_load_dword v20, v0, s[12:13] sc1
    s_waitcnt vmcnt(13)
    s_barrier
    s_mov_b32 s8, s58
    s_mov_b32 s9, s59
    s_add_u32 m0, s41, 4096
    s_mov_b32 s49, 3145728
    buffer_load_dwordx4 v119, s[8:11], s49 offen nt lds
    s_add_u32 m0, s41, 5120
    s_mov_b32 s49, 3162112
    buffer_load_dwordx4 v120, s[8:11], s49 offen nt lds
    s_add_u32 m0, s41, 6144
    s_mov_b32 s49, 3211264
    buffer_load_dwordx4 v119, s[8:11], s49 offen nt lds
    s_add_u32 m0, s41, 7168
    s_mov_b32 s49, 3227648
    buffer_load_dwordx4 v120, s[8:11], s49 offen nt lds
    ds_read_b64_tr_b16 a[176:177], v123 offset:8192
    ds_read_b64_tr_b16 a[184:185], v124 offset:8192
    ds_read_b64_tr_b16 a[178:179], v123 offset:43008
    ds_read_b64_tr_b16 a[186:187], v124 offset:43008
    ds_read_b64_tr_b16 a[180:181], v125 offset:8192
    ds_read_b64_tr_b16 a[188:189], v126 offset:8192
    ds_read_b64_tr_b16 a[182:183], v125 offset:43008
    ds_read_b64_tr_b16 a[190:191], v126 offset:43008
    s_waitcnt lgkmcnt(0)
    s_waitcnt vmcnt(13)
    s_barrier
    s_mov_b32 s8, s58
    s_mov_b32 s9, s59
    s_add_u32 m0, s41, 8192
    s_mov_b32 s49, 524288
    buffer_load_dwordx4 v119, s[8:11], s49 offen nt lds
    s_add_u32 m0, s41, 9216
    s_mov_b32 s49, 540672
    buffer_load_dwordx4 v120, s[8:11], s49 offen nt lds
    s_add_u32 m0, s41, 10240
    s_mov_b32 s49, 589824
    buffer_load_dwordx4 v119, s[8:11], s49 offen nt lds
    s_add_u32 m0, s41, 11264
    s_mov_b32 s49, 606208
    buffer_load_dwordx4 v120, s[8:11], s49 offen nt lds
    ds_read_b64_tr_b16 a[192:193], v123 offset:12288
    ds_read_b64_tr_b16 a[200:201], v124 offset:12288
    ds_read_b64_tr_b16 a[194:195], v123 offset:47104
    ds_read_b64_tr_b16 a[202:203], v124 offset:47104
    ds_read_b64_tr_b16 a[196:197], v125 offset:12288
    ds_read_b64_tr_b16 a[204:205], v126 offset:12288
    ds_read_b64_tr_b16 a[198:199], v125 offset:47104
    ds_read_b64_tr_b16 a[206:207], v126 offset:47104
    s_waitcnt lgkmcnt(0)
    s_waitcnt vmcnt(13)
    s_barrier
    s_mov_b32 s8, s58
    s_mov_b32 s9, s59
    s_add_u32 m0, s41, 12288
    s_mov_b32 s49, 1572864
    buffer_load_dwordx4 v119, s[8:11], s49 offen nt lds
    s_add_u32 m0, s41, 13312
    s_mov_b32 s49, 1589248
    buffer_load_dwordx4 v120, s[8:11], s49 offen nt lds
    s_add_u32 m0, s41, 14336
    s_mov_b32 s49, 1638400
    buffer_load_dwordx4 v119, s[8:11], s49 offen nt lds
    s_add_u32 m0, s41, 15360
    s_mov_b32 s49, 1654784
    buffer_load_dwordx4 v120, s[8:11], s49 offen nt lds
    ds_read_b64_tr_b16 a[208:209], v123 offset:16384
    ds_read_b64_tr_b16 a[216:217], v124 offset:16384
    ds_read_b64_tr_b16 a[210:211], v123 offset:51200
    ds_read_b64_tr_b16 a[218:219], v124 offset:51200
    ds_read_b64_tr_b16 a[212:213], v125 offset:16384
    ds_read_b64_tr_b16 a[220:221], v126 offset:16384
    ds_read_b64_tr_b16 a[214:215], v125 offset:51200
    ds_read_b64_tr_b16 a[222:223], v126 offset:51200
    s_waitcnt lgkmcnt(0)
    global_load_dwordx2 v[24:25], v17, s[12:13] sc1
    s_waitcnt vmcnt(14)
    s_barrier
    s_mov_b32 s8, s58
    s_mov_b32 s9, s59
    s_add_u32 m0, s41, 16384
    s_mov_b32 s49, 2621440
    buffer_load_dwordx4 v119, s[8:11], s49 offen nt lds
    s_add_u32 m0, s41, 17408
    s_mov_b32 s49, 2637824
    buffer_load_dwordx4 v120, s[8:11], s49 offen nt lds
    s_add_u32 m0, s41, 18432
    s_mov_b32 s49, 2686976
    buffer_load_dwordx4 v119, s[8:11], s49 offen nt lds
    s_add_u32 m0, s41, 19456
    s_mov_b32 s49, 2703360
    buffer_load_dwordx4 v120, s[8:11], s49 offen nt lds
    ds_read_b64_tr_b16 a[224:225], v123 offset:0
    ds_read_b64_tr_b16 a[232:233], v124 offset:0
    ds_read_b64_tr_b16 a[226:227], v123 offset:34816
    ds_read_b64_tr_b16 a[234:235], v124 offset:34816
    ds_read_b64_tr_b16 a[228:229], v125 offset:0
    ds_read_b64_tr_b16 a[236:237], v126 offset:0
    ds_read_b64_tr_b16 a[230:231], v125 offset:34816
    ds_read_b64_tr_b16 a[238:239], v126 offset:34816
    s_waitcnt lgkmcnt(0)
    s_waitcnt vmcnt(13)
    s_barrier
    s_mov_b32 s8, s58
    s_mov_b32 s9, s59
    s_add_u32 m0, s41, 0
    s_mov_b32 s49, 3670016
    buffer_load_dwordx4 v119, s[8:11], s49 offen nt lds
    s_add_u32 m0, s41, 1024
    s_mov_b32 s49, 3686400
    buffer_load_dwordx4 v120, s[8:11], s49 offen nt lds
    s_add_u32 m0, s41, 2048
    s_mov_b32 s49, 3735552
    buffer_load_dwordx4 v119, s[8:11], s49 offen nt lds
    s_add_u32 m0, s41, 3072
    s_mov_b32 s49, 3751936
    buffer_load_dwordx4 v120, s[8:11], s49 offen nt lds
    ds_read_b64_tr_b16 a[240:241], v123 offset:4096
    ds_read_b64_tr_b16 a[248:249], v124 offset:4096
    ds_read_b64_tr_b16 a[242:243], v123 offset:38912
    ds_read_b64_tr_b16 a[250:251], v124 offset:38912
    ds_read_b64_tr_b16 a[244:245], v125 offset:4096
    ds_read_b64_tr_b16 a[252:253], v126 offset:4096
    ds_read_b64_tr_b16 a[246:247], v125 offset:38912
    ds_read_b64_tr_b16 a[254:255], v126 offset:38912
    s_waitcnt lgkmcnt(0)
    s_waitcnt vmcnt(13)
    s_barrier
    s_mov_b32 s8, s54
    s_mov_b32 s9, s55
    s_add_u32 m0, s41, 4096
    s_mov_b32 s49, 524288
    buffer_load_dwordx4 v119, s[8:11], s49 offen nt lds
    s_add_u32 m0, s41, 5120
    s_mov_b32 s49, 540672
    buffer_load_dwordx4 v120, s[8:11], s49 offen nt lds
    s_add_u32 m0, s41, 6144
    s_mov_b32 s49, 589824
    buffer_load_dwordx4 v119, s[8:11], s49 offen nt lds
    s_add_u32 m0, s41, 7168
    s_mov_b32 s49, 606208
    buffer_load_dwordx4 v120, s[8:11], s49 offen nt lds
    ds_read_b64_tr_b16 v[128:129], v123 offset:8192
    ds_read_b64_tr_b16 v[136:137], v124 offset:8192
    ds_read_b64_tr_b16 v[130:131], v123 offset:43008
    ds_read_b64_tr_b16 v[138:139], v124 offset:43008
    ds_read_b64_tr_b16 v[132:133], v125 offset:8192
    ds_read_b64_tr_b16 v[140:141], v126 offset:8192
    ds_read_b64_tr_b16 v[134:135], v125 offset:43008
    ds_read_b64_tr_b16 v[142:143], v126 offset:43008
    s_waitcnt lgkmcnt(0)
    s_waitcnt vmcnt(13)
    s_barrier
    s_mov_b32 s8, s54
    s_mov_b32 s9, s55
    s_add_u32 m0, s41, 8192
    s_mov_b32 s49, 1572864
    buffer_load_dwordx4 v119, s[8:11], s49 offen nt lds
    s_add_u32 m0, s41, 9216
    s_mov_b32 s49, 1589248
    buffer_load_dwordx4 v120, s[8:11], s49 offen nt lds
    s_add_u32 m0, s41, 10240
    s_mov_b32 s49, 1638400
    buffer_load_dwordx4 v119, s[8:11], s49 offen nt lds
    s_add_u32 m0, s41, 11264
    s_mov_b32 s49, 1654784
    buffer_load_dwordx4 v120, s[8:11], s49 offen nt lds
    ds_read_b64_tr_b16 v[144:145], v123 offset:12288
    ds_read_b64_tr_b16 v[152:153], v124 offset:12288
    ds_read_b64_tr_b16 v[146:147], v123 offset:47104
    ds_read_b64_tr_b16 v[154:155], v124 offset:47104
    ds_read_b64_tr_b16 v[148:149], v125 offset:12288
    ds_read_b64_tr_b16 v[156:157], v126 offset:12288
    ds_read_b64_tr_b16 v[150:151], v125 offset:47104
    ds_read_b64_tr_b16 v[158:159], v126 offset:47104
    s_waitcnt lgkmcnt(0)
    s_waitcnt vmcnt(12)
    s_barrier
    s_mov_b32 s8, s54
    s_mov_b32 s9, s55
    s_add_u32 m0, s41, 12288
    s_mov_b32 s49, 2621440
    buffer_load_dwordx4 v119, s[8:11], s49 offen nt lds
    s_add_u32 m0, s41, 13312
    s_mov_b32 s49, 2637824
    buffer_load_dwordx4 v120, s[8:11], s49 offen nt lds
    s_add_u32 m0, s41, 14336
    s_mov_b32 s49, 2686976
    buffer_load_dwordx4 v119, s[8:11], s49 offen nt lds
    s_add_u32 m0, s41, 15360
    s_mov_b32 s49, 2703360
    buffer_load_dwordx4 v120, s[8:11], s49 offen nt lds
    ds_read_b64_tr_b16 v[160:161], v123 offset:16384
    ds_read_b64_tr_b16 v[168:169], v124 offset:16384
    ds_read_b64_tr_b16 v[162:163], v123 offset:51200
    ds_read_b64_tr_b16 v[170:171], v124 offset:51200
    ds_read_b64_tr_b16 v[164:165], v125 offset:16384
    ds_read_b64_tr_b16 v[172:173], v126 offset:16384
    ds_read_b64_tr_b16 v[166:167], v125 offset:51200
    ds_read_b64_tr_b16 v[174:175], v126 offset:51200
    s_waitcnt lgkmcnt(0)
    s_waitcnt vmcnt(12)
    s_barrier
    s_mov_b32 s8, s54
    s_mov_b32 s9, s55
    s_add_u32 m0, s41, 16384
    s_mov_b32 s49, 3670016
    buffer_load_dwordx4 v119, s[8:11], s49 offen nt lds
    s_add_u32 m0, s41, 17408
    s_mov_b32 s49, 3686400
    buffer_load_dwordx4 v120, s[8:11], s49 offen nt lds
    s_add_u32 m0, s41, 18432
    s_mov_b32 s49, 3735552
    buffer_load_dwordx4 v119, s[8:11], s49 offen nt lds
    s_add_u32 m0, s41, 19456
    s_mov_b32 s49, 3751936
    buffer_load_dwordx4 v120, s[8:11], s49 offen nt lds
    ds_read_b64_tr_b16 v[176:177], v123 offset:0
    ds_read_b64_tr_b16 v[184:185], v124 offset:0
    ds_read_b64_tr_b16 v[178:179], v123 offset:34816
    ds_read_b64_tr_b16 v[186:187], v124 offset:34816
    ds_read_b64_tr_b16 v[180:181], v125 offset:0
    ds_read_b64_tr_b16 v[188:189], v126 offset:0
    ds_read_b64_tr_b16 v[182:183], v125 offset:34816
    ds_read_b64_tr_b16 v[190:191], v126 offset:34816
    s_waitcnt lgkmcnt(0)
    s_and_b32 s46, s14, 3
    s_mov_b32 s47, 0x40000000
    s_cmp_eq_u32 s46, 0
    s_cselect_b32 s47, 3154176, s47
    s_cmp_eq_u32 s46, 2
    s_cselect_b32 s47, 2105088, s47
    s_cmp_eq_u32 s46, 3
    s_cselect_b32 s47, 1056256, s47
    s_mov_b32 s8, s54
    s_mov_b32 s9, s55
    s_add_u32 s49, s47, 4294959104
    buffer_load_dwordx4 v[48:51], v119, s[8:11], s49 offen
    s_add_u32 s49, s47, 8192
    buffer_load_dwordx4 v[48:51], v119, s[8:11], s49 offen
    s_add_u32 s49, s47, 57344
    buffer_load_dwordx4 v[48:51], v119, s[8:11], s49 offen
    s_add_u32 s49, s47, 73728
    buffer_load_dwordx4 v[48:51], v119, s[8:11], s49 offen
    s_waitcnt vmcnt(16)
    s_barrier
    s_mov_b32 s8, s54
    s_mov_b32 s9, s55
    s_add_u32 m0, s41, 0
    s_mov_b32 s49, 0
    buffer_load_dwordx4 v119, s[8:11], s49 offen nt lds
    s_add_u32 m0, s41, 1024
    s_mov_b32 s49, 16384
    buffer_load_dwordx4 v120, s[8:11], s49 offen nt lds
    s_add_u32 m0, s41, 2048
    s_mov_b32 s49, 65536
    buffer_load_dwordx4 v119, s[8:11], s49 offen nt lds
    s_add_u32 m0, s41, 3072
    s_mov_b32 s49, 81920
    buffer_load_dwordx4 v120, s[8:11], s49 offen nt lds
    ds_read_b64_tr_b16 a[0:1], v123 offset:4096
    ds_read_b64_tr_b16 a[8:9], v124 offset:4096
    ds_read_b64_tr_b16 a[2:3], v123 offset:38912
    ds_read_b64_tr_b16 a[10:11], v124 offset:38912
    ds_read_b64_tr_b16 a[4:5], v125 offset:4096
    ds_read_b64_tr_b16 a[12:13], v126 offset:4096
    ds_read_b64_tr_b16 a[6:7], v125 offset:38912
    ds_read_b64_tr_b16 a[14:15], v126 offset:38912
    s_waitcnt lgkmcnt(0)
    s_waitcnt vmcnt(16)
    s_barrier
    s_mov_b32 s8, s54
    s_mov_b32 s9, s55
    s_add_u32 m0, s41, 4096
    s_mov_b32 s49, 1048576
    buffer_load_dwordx4 v119, s[8:11], s49 offen nt lds
    s_add_u32 m0, s41, 5120
    s_mov_b32 s49, 1064960
    buffer_load_dwordx4 v120, s[8:11], s49 offen nt lds
    s_add_u32 m0, s41, 6144
    s_mov_b32 s49, 1114112
    buffer_load_dwordx4 v119, s[8:11], s49 offen nt lds
    s_add_u32 m0, s41, 7168
    s_mov_b32 s49, 1130496
    buffer_load_dwordx4 v120, s[8:11], s49 offen nt lds
    ds_read_b64_tr_b16 a[16:17], v123 offset:8192
    ds_read_b64_tr_b16 a[24:25], v124 offset:8192
    ds_read_b64_tr_b16 a[18:19], v123 offset:43008
    ds_read_b64_tr_b16 a[26:27], v124 offset:43008
    ds_read_b64_tr_b16 a[20:21], v125 offset:8192
    ds_read_b64_tr_b16 a[28:29], v126 offset:8192
    ds_read_b64_tr_b16 a[22:23], v125 offset:43008
    ds_read_b64_tr_b16 a[30:31], v126 offset:43008
    s_waitcnt lgkmcnt(0)
    s_waitcnt vmcnt(16)
    s_barrier
    s_mov_b32 s8, s54
    s_mov_b32 s9, s55
    s_add_u32 m0, s41, 8192
    s_mov_b32 s49, 2097152
    buffer_load_dwordx4 v119, s[8:11], s49 offen nt lds
    s_add_u32 m0, s41, 9216
    s_mov_b32 s49, 2113536
    buffer_load_dwordx4 v120, s[8:11], s49 offen nt lds
    s_add_u32 m0, s41, 10240
    s_mov_b32 s49, 2162688
    buffer_load_dwordx4 v119, s[8:11], s49 offen nt lds
    s_add_u32 m0, s41, 11264
    s_mov_b32 s49, 2179072
    buffer_load_dwordx4 v120, s[8:11], s49 offen nt lds
    ds_read_b64_tr_b16 a[32:33], v123 offset:12288
    ds_read_b64_tr_b16 a[40:41], v124 offset:12288
    ds_read_b64_tr_b16 a[34:35], v123 offset:47104
    ds_read_b64_tr_b16 a[42:43], v124 offset:47104
    ds_read_b64_tr_b16 a[36:37], v125 offset:12288
    ds_read_b64_tr_b16 a[44:45], v126 offset:12288
    ds_read_b64_tr_b16 a[38:39], v125 offset:47104
    ds_read_b64_tr_b16 a[46:47], v126 offset:47104
    s_waitcnt lgkmcnt(0)
    s_waitcnt vmcnt(16)
    s_barrier
    s_mov_b32 s8, s54
    s_mov_b32 s9, s55
    s_add_u32 m0, s41, 12288
    s_mov_b32 s49, 3145728
    buffer_load_dwordx4 v119, s[8:11], s49 offen nt lds
    s_add_u32 m0, s41, 13312
    s_mov_b32 s49, 3162112
    buffer_load_dwordx4 v120, s[8:11], s49 offen nt lds
    s_add_u32 m0, s41, 14336
    s_mov_b32 s49, 3211264
    buffer_load_dwordx4 v119, s[8:11], s49 offen nt lds
    s_add_u32 m0, s41, 15360
    s_mov_b32 s49, 3227648
    buffer_load_dwordx4 v120, s[8:11], s49 offen nt lds
    ds_read_b64_tr_b16 a[48:49], v123 offset:16384
    ds_read_b64_tr_b16 a[56:57], v124 offset:16384
    ds_read_b64_tr_b16 a[50:51], v123 offset:51200
    ds_read_b64_tr_b16 a[58:59], v124 offset:51200
    ds_read_b64_tr_b16 a[52:53], v125 offset:16384
    ds_read_b64_tr_b16 a[60:61], v126 offset:16384
    ds_read_b64_tr_b16 a[54:55], v125 offset:51200
    ds_read_b64_tr_b16 a[62:63], v126 offset:51200
    s_waitcnt lgkmcnt(0)
    s_waitcnt vmcnt(12)
    s_barrier
    s_mov_b32 s8, s60
    s_mov_b32 s9, s61
    s_add_u32 m0, s41, 16384
    s_add_u32 s49, s67, 0
    buffer_load_dwordx4 v118, s[8:11], s49 offen nt lds
    s_add_u32 m0, s41, 17408
    s_add_u32 s49, s67, 2048
    buffer_load_dwordx4 v118, s[8:11], s49 offen nt lds
    s_add_u32 m0, s41, 18432
    s_add_u32 s49, s67, 8192
    buffer_load_dwordx4 v118, s[8:11], s49 offen nt lds
    s_add_u32 m0, s41, 19456
    s_add_u32 s49, s67, 10240
    buffer_load_dwordx4 v118, s[8:11], s49 offen nt lds
    ds_read_b64_tr_b16 v[64:65], v123 offset:0
    ds_read_b64_tr_b16 v[72:73], v124 offset:0
    ds_read_b64_tr_b16 v[66:67], v123 offset:34816
    ds_read_b64_tr_b16 v[74:75], v124 offset:34816
    ds_read_b64_tr_b16 v[68:69], v125 offset:0
    ds_read_b64_tr_b16 v[76:77], v126 offset:0
    ds_read_b64_tr_b16 v[70:71], v125 offset:34816
    ds_read_b64_tr_b16 v[78:79], v126 offset:34816
    s_waitcnt lgkmcnt(0)
    s_waitcnt vmcnt(12)
    s_barrier
    ds_write_b128 v3, v[64:67] offset:0
    ds_write_b128 v3, v[68:71] offset:1024
    ds_write_b128 v3, v[72:75] offset:2048
    ds_write_b128 v3, v[76:79] offset:3072
    ds_read_b64_tr_b16 v[32:33], v123 offset:4096
    ds_read_b64_tr_b16 v[40:41], v124 offset:4096
    ds_read_b64_tr_b16 v[34:35], v123 offset:38912
    ds_read_b64_tr_b16 v[42:43], v124 offset:38912
    ds_read_b64_tr_b16 v[36:37], v125 offset:4096
    ds_read_b64_tr_b16 v[44:45], v126 offset:4096
    ds_read_b64_tr_b16 v[38:39], v125 offset:38912
    ds_read_b64_tr_b16 v[46:47], v126 offset:38912
    s_waitcnt lgkmcnt(0)
    s_waitcnt vmcnt(48)
L_ch_hs:
    v_readfirstlane_b32 s44, v24
    v_readfirstlane_b32 s45, v25
    s_add_u32 s96, s96, 1
    s_cmp_gt_u32 s96, 0x200000
    s_cbranch_scc1 L_ch_hsdone
    s_add_u32 s46, s44, s45
    s_lshr_b32 s47, s46, 16
    s_add_u32 s46, s46, s47
    s_lshr_b32 s47, s46, 8
    s_add_u32 s46, s46, s47
    s_and_b32 s46, s46, 0xff
    s_cmp_ge_u32 s46, 32
    s_cbranch_scc1 L_ch_hsdone
    global_load_dwordx2 v[24:25], v17, s[12:13] sc1
    s_waitcnt vmcnt(0)
    s_branch L_ch_hs
L_ch_hsdone:
    s_or_b32 s44, s44, s45
    s_and_b32 s44, s44, 0x20202020
    s_waitcnt vmcnt(61)
L_ch_iw:
    v_cmp_eq_u32 vcc, 0, v20
    s_cbranch_vccz L_ch_iwx
    s_add_u32 s96, s96, 1
    s_cmp_gt_u32 s96, 0x200000
    s_cbranch_scc1 L_ch_iwx
    global_load_dword v20, v0, s[12:13] sc1
    s_waitcnt vmcnt(0)
    s_branch L_ch_iw
L_ch_iwx:
    v_lshrrev_b32 v0, 2, v2
    v_and_b32 v0, 4, v0
    buffer_load_dword v11, v0, s[4:7], s38 offen sc1
    s_lshl_b32 s47, s15, 18
    s_add_u32 s47, s47, s30
    s_add_u32 s48, s47, 4096
    s_lshl_b32 s46, s14, 10
    s_add_u32 s46, s46, 80740352
    buffer_load_dwordx4 v[20:23], v2, s[4:7], s46 offen sc1
    buffer_load_dwordx4 v[20:23], v2, s[4:7], s47 offen offset:0 sc1
    buffer_load_dwordx4 v[20:23], v2, s[4:7], s47 offen offset:1024 sc1
    buffer_load_dwordx4 v[20:23], v2, s[4:7], s47 offen offset:2048 sc1
    buffer_load_dwordx4 v[20:23], v2, s[4:7], s47 offen offset:3072 sc1
    buffer_load_dwordx4 v[20:23], v2, s[4:7], s48 offen offset:0 sc1
    buffer_load_dwordx4 v[20:23], v2, s[4:7], s48 offen offset:1024 sc1
    s_waitcnt vmcnt(16)
    s_barrier
    ds_write_b128 v3, v[32:35] offset:4096
    ds_write_b128 v3, v[36:39] offset:5120
    ds_write_b128 v3, v[40:43] offset:6144
    ds_write_b128 v3, v[44:47] offset:7168
    ds_read_b64_tr_b16 v[80:81], v123 offset:8192
    ds_read_b64_tr_b16 v[88:89], v124 offset:8192
    ds_read_b64_tr_b16 v[82:83], v123 offset:43008
    ds_read_b64_tr_b16 v[90:91], v124 offset:43008
    ds_read_b64_tr_b16 v[84:85], v125 offset:8192
    ds_read_b64_tr_b16 v[92:93], v126 offset:8192
    ds_read_b64_tr_b16 v[86:87], v125 offset:43008
    ds_read_b64_tr_b16 v[94:95], v126 offset:43008
    s_waitcnt lgkmcnt(0)
    s_waitcnt vmcnt(12)
    s_barrier
    ds_write_b128 v3, v[80:83] offset:8192
    ds_write_b128 v3, v[84:87] offset:9216
    ds_write_b128 v3, v[88:91] offset:10240
    ds_write_b128 v3, v[92:95] offset:11264
    ds_read_b64_tr_b16 v[96:97], v123 offset:12288
    ds_read_b64_tr_b16 v[104:105], v124 offset:12288
    ds_read_b64_tr_b16 v[98:99], v123 offset:47104
    ds_read_b64_tr_b16 v[106:107], v124 offset:47104
    ds_read_b64_tr_b16 v[100:101], v125 offset:12288
    ds_read_b64_tr_b16 v[108:109], v126 offset:12288
    ds_read_b64_tr_b16 v[102:103], v125 offset:47104
    ds_read_b64_tr_b16 v[110:111], v126 offset:47104
    s_waitcnt lgkmcnt(0)
    s_waitcnt vmcnt(8)
    s_barrier
    ds_write_b128 v3, v[96:99] offset:12288
    ds_write_b128 v3, v[100:103] offset:13312
    ds_write_b128 v3, v[104:107] offset:14336
    ds_write_b128 v3, v[108:111] offset:15360
    ds_read_b64_tr_b16 v[48:49], v121 offset:16384
    ds_read_b64_tr_b16 v[56:57], v122 offset:16384
    ds_read_b64_tr_b16 v[50:51], v121 offset:17408
    ds_read_b64_tr_b16 v[58:59], v122 offset:17408
    ds_read_b64_tr_b16 v[52:53], v121 offset:18432
    ds_read_b64_tr_b16 v[60:61], v122 offset:18432
    ds_read_b64_tr_b16 v[54:55], v121 offset:19456
    ds_read_b64_tr_b16 v[62:63], v122 offset:19456
    s_waitcnt lgkmcnt(0)
    ds_write_b128 v3, v[48:51] offset:16384
    ds_write_b128 v3, v[52:55] offset:17408
    ds_write_b128 v3, v[56:59] offset:18432
    ds_write_b128 v3, v[60:63] offset:19456
    s_waitcnt vmcnt(7)
    v_lshrrev_b32 v0, 2, v2
    v_and_b32 v0, 4, v0
    s_add_u32 s45, s16, 1
    s_min_u32 s45, s45, 63
    s_lshl_b32 s45, s45, 2
L_ch_k0c:
    v_lshl_add_u32 v11, v11, 3, v0
    v_cmp_ge_u32 vcc, s45, v11
    s_cbranch_vccnz L_ch_k0w
L_ch_k0x:
    s_branch L_ch_k0y
L_ch_k0w:
    s_add_u32 s96, s96, 1
    s_cmp_gt_u32 s96, 0x200000
    s_cbranch_scc1 L_ch_k0x
    buffer_load_dword v11, v0, s[4:7], s38 offen sc1
    s_waitcnt vmcnt(0)
    s_branch L_ch_k0c
L_ch_k0y:
    s_mov_b32 m0, s37
    s_nop 0
    buffer_load_dwordx4 v2, s[4:7], s18 offen offset:0 sc1 lds
    buffer_load_dwordx4 v2, s[4:7], s18 offen offset:1024 sc1 lds
    s_mov_b32 m0, s39
    s_nop 0
    buffer_load_dwordx4 v2, s[4:7], s19 offen offset:0 sc1 lds
    buffer_load_dwordx4 v2, s[4:7], s19 offen offset:1024 sc1 lds
    buffer_load_dwordx4 v[112:115], v2, s[4:7], s48 offen offset:2048 sc1
    buffer_load_dwordx4 v[112:115], v2, s[4:7], s48 offen offset:3072 sc1
    v_lshrrev_b32 v0, 2, v2
    v_and_b32 v0, 4, v0
    buffer_load_dword v11, v0, s[4:7], s38 offen sc1
    v_mov_b64 v[24:25], 0
    v_mov_b64 v[26:27], 0
    v_mov_b64 v[28:29], 0
    v_mov_b64 v[30:31], 0
    s_add_u32 s18, s18, 16384
    s_add_u32 s19, s19, 16384
    buffer_load_dwordx4 v[112:115], v2, s[4:7], s18 offen sc1
    s_mov_b32 s21, 79691776
    s_mov_b32 s90, 79757312
    s_mov_b32 s22, 79822848
    s_mov_b32 s91, 79888384
    s_add_u32 s25, s26, 524288
    s_and_b32 s46, s14, 1
    s_xor_b32 s46, s46, 0
    s_lshl_b32 s52, s46, 11
    s_add_u32 s46, s14, 0
    s_and_b32 s46, s46, 3
    s_lshl_b32 s56, s46, 10
    s_and_b32 s46, s14, 1
    s_xor_b32 s46, s46, 1
    s_lshl_b32 s53, s46, 11
    s_add_u32 s46, s14, 1
    s_and_b32 s46, s46, 3
    s_lshl_b32 s57, s46, 10
    s_and_b32 s46, s14, 1
    s_xor_b32 s46, s46, 2
    s_lshl_b32 s54, s46, 11
    s_add_u32 s46, s14, 2
    s_and_b32 s46, s46, 3
    s_lshl_b32 s58, s46, 10
    s_and_b32 s46, s14, 1
    s_xor_b32 s46, s46, 3
    s_lshl_b32 s55, s46, 11
    s_add_u32 s46, s14, 3
    s_and_b32 s46, s46, 3
    s_lshl_b32 s59, s46, 10
    s_waitcnt lgkmcnt(0)
    s_cmp_eq_u32 s44, 0
    s_cbranch_scc1 L_ch_S0
    s_branch L_ch_F0
.p2align 6
    s_nop 0
    s_nop 0
    s_nop 0
    s_nop 0
    s_nop 0
    s_nop 0
    s_nop 0
L_ch_F0:
    s_waitcnt vmcnt(8) lgkmcnt(0)
    s_barrier
    ds_read_b128 v[48:51], v2 offset:0
    ds_read_b128 v[52:55], v2 offset:1024
    ds_read_b128 v[56:59], v2 offset:2048
    ds_read_b128 v[60:63], v2 offset:3072
L_ch_F0_re:
    buffer_load_dwordx4 v[116:119], v2, s[4:7], s18 offen offset:1024 sc1
    s_waitcnt lgkmcnt(3)
    v_smfmac_f32_16x16x64_bf16 v[24:27], v[48:51], v[64:71], v1
    v_smfmac_f32_16x16x64_bf16 v[28:31], v[48:51], v[72:79], v1
    s_waitcnt lgkmcnt(2)
    v_smfmac_f32_16x16x64_bf16 v[24:27], v[52:55], v[32:39], v1
    buffer_load_dwordx4 v[120:123], v2, s[4:7], s19 offen offset:0 sc1
    v_smfmac_f32_16x16x64_bf16 v[28:31], v[52:55], v[40:47], v1
    s_waitcnt lgkmcnt(1)
    v_smfmac_f32_16x16x64_bf16 v[24:27], v[56:59], v[80:87], v1
    v_smfmac_f32_16x16x64_bf16 v[28:31], v[56:59], v[88:95], v1
    s_waitcnt lgkmcnt(0)
    v_mfma_f32_4x4x4_16b_bf16 v[32:35], v[18:19], v[18:19], 0
    v_smfmac_f32_16x16x64_bf16 v[24:27], v[60:63], v[96:103], v1
    buffer_load_dwordx4 v[124:127], v2, s[4:7], s19 offen offset:1024 sc1
    v_smfmac_f32_16x16x64_bf16 v[28:31], v[60:63], v[104:111], v1
    s_nop 0
    v_smfmac_f32_16x16x64_bf16 v[32:35], v[48:51], a[64:71], v1
    v_mov_b64 v[36:37], 0
    v_smfmac_f32_16x16x64_bf16 v[32:35], v[52:55], a[80:87], v1
    s_waitcnt vmcnt(7)
    v_mov_b64 v[38:39], 0
    v_smfmac_f32_16x16x64_bf16 v[32:35], v[56:59], a[96:103], v1
    s_barrier
    v_smfmac_f32_16x16x64_bf16 v[32:35], v[60:63], a[112:119], v1
    ds_read_b128 v[64:67], v2 offset:4096
    v_mov_b64 v[40:41], 0
    v_smfmac_f32_16x16x64_bf16 v[36:39], v[48:51], a[72:79], v1
    ds_read_b128 v[68:71], v2 offset:5120
    v_mov_b64 v[42:43], 0
    v_smfmac_f32_16x16x64_bf16 v[36:39], v[52:55], a[88:95], v1
    ds_read_b128 v[72:75], v2 offset:6144
    v_mov_b64 v[44:45], 0
    v_smfmac_f32_16x16x64_bf16 v[36:39], v[56:59], a[104:111], v1
    ds_read_b128 v[76:79], v2 offset:7168
    v_mov_b64 v[46:47], 0
    v_smfmac_f32_16x16x64_bf16 v[36:39], v[60:63], a[120:127], v1
    ds_read_b128 v[80:83], v2 offset:16384
    s_waitcnt lgkmcnt(4)
    v_smfmac_f32_16x16x64_bf16 v[24:27], v[64:67], a[0:7], v1
    ds_read_b128 v[96:99], v2 offset:20480
    s_waitcnt lgkmcnt(4)
    v_smfmac_f32_16x16x64_bf16 v[24:27], v[68:71], a[16:23], v1
    ds_read_b128 v[84:87], v2 offset:17408
    s_waitcnt lgkmcnt(4)
    v_smfmac_f32_16x16x64_bf16 v[24:27], v[72:75], a[32:39], v1
    ds_read_b128 v[100:103], v2 offset:21504
    s_waitcnt lgkmcnt(4)
    v_smfmac_f32_16x16x64_bf16 v[24:27], v[76:79], a[48:55], v1
    s_nop 0
    v_smfmac_f32_16x16x64_bf16 v[28:31], v[64:67], a[8:15], v1
    ds_read_b128 v[88:91], v2 offset:18432
    v_mov_b64 v[12:13], s[92:93]
    v_smfmac_f32_16x16x64_bf16 v[28:31], v[68:71], a[24:31], v1
    ds_read_b128 v[92:95], v2 offset:19456
    v_mov_b64 v[14:15], s[92:93]
    v_smfmac_f32_16x16x64_bf16 v[28:31], v[72:75], a[40:47], v1
    ds_read_b128 v[104:107], v2 offset:22528
    v_add_f32 v24, v24, v25
    v_smfmac_f32_16x16x64_bf16 v[28:31], v[76:79], a[56:63], v1
    ds_read_b128 v[108:111], v2 offset:23552
    v_add_f32 v26, v26, v27
    v_smfmac_f32_16x16x64_bf16 v[32:35], v[64:67], a[128:135], v1
    s_nop 1
    v_cmp_u_f32 vcc, v24, v26
    v_smfmac_f32_16x16x64_bf16 v[32:35], v[68:71], a[144:151], v1
    s_nop 0
    v_add_f32 v28, v28, v29
    v_smfmac_f32_16x16x64_bf16 v[32:35], v[72:75], a[160:167], v1
    s_cbranch_vccnz L_ch_F0_r2
L_ch_F0_r2x:
    v_add_f32 v30, v30, v31
    v_smfmac_f32_16x16x64_bf16 v[32:35], v[76:79], a[176:183], v1
    s_nop 1
    v_cvt_pk_bf16_f32 v25, v24, v28
    v_smfmac_f32_16x16x64_bf16 v[36:39], v[64:67], a[136:143], v1
    v_cvt_pk_bf16_f32 v27, v26, v30
    v_smfmac_f32_16x16x64_bf16 v[36:39], v[68:71], a[152:159], v1
    ds_write2_b32 v4, v25, v27 offset0:0 offset1:4
    v_smfmac_f32_16x16x64_bf16 v[36:39], v[72:75], a[168:175], v1
    v_add_f32 v32, v32, v33
    v_smfmac_f32_16x16x64_bf16 v[36:39], v[76:79], a[184:191], v1
    v_add_f32 v34, v34, v35
    v_smfmac_f32_16x16x64_bf16 v[40:43], v[48:51], a[192:199], v1
    s_nop 2
    v_smfmac_f32_16x16x64_bf16 v[44:47], v[48:51], a[200:207], v1
    s_waitcnt lgkmcnt(0)
    s_barrier
    v_add_f32 v36, v36, v37
    v_smfmac_f32_16x16x64_bf16 v[40:43], v[52:55], a[208:215], v1
    ds_read_b128 v[48:51], v5 offset:8192
    v_add_f32 v38, v38, v39
    v_smfmac_f32_16x16x64_bf16 v[44:47], v[52:55], a[216:223], v1
    ds_read_b128 v[52:55], v5 offset:8704
    v_cvt_pk_bf16_f32 v21, v32, v36
    v_smfmac_f32_16x16x64_bf16 v[40:43], v[56:59], a[224:231], v1
    v_cvt_pk_bf16_f32 v23, v34, v38
    v_smfmac_f32_16x16x64_bf16 v[44:47], v[56:59], a[232:239], v1
    ds_write2_b32 v6, v21, v23 offset0:0 offset1:8
    v_smfmac_f32_16x16x64_bf16 v[40:43], v[60:63], a[240:247], v1
    ds_read_b128 v[56:59], v5 offset:9216
    v_mov_b64 v[32:33], 0
    v_smfmac_f32_16x16x64_bf16 v[44:47], v[60:63], a[248:255], v1
    ds_read_b128 v[60:63], v5 offset:9728
    s_waitcnt lgkmcnt(3)
    v_mfma_f32_16x16x32_bf16 v[24:27], v[80:83], v[48:51], 0
    v_mov_b64 v[34:35], 0
    v_mfma_f32_16x16x32_bf16 v[28:31], v[96:99], v[48:51], 0
    v_mfma_f32_16x16x32_bf16 v[24:27], v[84:87], v[52:55], v[24:27]
    s_waitcnt lgkmcnt(2)
    s_barrier
    v_mfma_f32_16x16x32_bf16 v[28:31], v[100:103], v[52:55], v[28:31]
    ds_read_b128 v[80:83], v2 offset:10240
    s_waitcnt lgkmcnt(1)
    v_mfma_f32_16x16x32_bf16 v[24:27], v[88:91], v[56:59], v[24:27]
    ds_read_b128 v[96:99], v2 offset:11264
    v_mfma_f32_16x16x32_bf16 v[24:27], v[92:95], v[60:63], v[24:27]
    ds_read_b128 v[84:87], v3 offset:32768
    v_mfma_f32_16x16x32_bf16 v[28:31], v[104:107], v[56:59], v[28:31]
    ds_read_b128 v[100:103], v3 offset:33792
    v_mfma_f32_16x16x32_bf16 v[28:31], v[108:111], v[60:63], v[28:31]
    s_add_u32 s35, s35, 8192
    s_and_b32 s35, s35, 0x7fff
    v_smfmac_f32_16x16x64_bf16 v[40:43], v[64:67], v[128:135], v1
    s_waitcnt lgkmcnt(2)
    s_add_u32 s31, s35, 80740352
    v_max3_f32 v16, v24, v25, v26
    v_smfmac_f32_16x16x64_bf16 v[32:35], v[80:83], v[48:55], v1
    s_add_u32 s33, s32, s35
    s_add_u32 s25, s26, s27
    v_max3_f32 v16, v16, v27, v28
    v_smfmac_f32_16x16x64_bf16 v[32:35], v[96:99], v[56:63], v1
    ds_read_b128 v[80:83], v3 offset:20480
    v_max3_f32 v16, v16, v29, v30
    v_smfmac_f32_16x16x64_bf16 v[40:43], v[68:71], v[144:151], v1
    ds_read_b128 v[96:99], v3 offset:24576
    s_add_u32 s27, s27, 262144
    v_smfmac_f32_16x16x64_bf16 v[40:43], v[72:75], v[160:167], v1
    s_and_b32 s27, s27, 0xfffff
    s_add_u32 s16, s16, 1
    v_add_f32 v32, v32, v33
    v_add_f32 v33, v34, v35
    v_smfmac_f32_16x16x64_bf16 v[40:43], v[76:79], v[176:183], v1
    v_max3_f32 v16, v16, v31, v32
    v_max_f32 v35, v16, v33
    v_max_f32 v16, v16, v33
    v_smfmac_f32_16x16x64_bf16 v[44:47], v[64:67], v[136:143], v1
    ds_read_b128 v[88:91], v3 offset:16384
    v_permlane32_swap_b32 v16, v35
    v_smfmac_f32_16x16x64_bf16 v[44:47], v[68:71], v[152:159], v1
    ds_read_b128 v[92:95], v3 offset:17408
    v_max_f32 v0, v16, v35
    v_max_f32 v16, v16, v35
    v_smfmac_f32_16x16x64_bf16 v[44:47], v[72:75], v[168:175], v1
    ds_read_b128 v[104:107], v3 offset:18432
    v_permlane16_swap_b32 v16, v0
    v_smfmac_f32_16x16x64_bf16 v[44:47], v[76:79], v[184:191], v1
    ds_read_b128 v[108:111], v3 offset:19456
    v_max_f32 v16, v16, v0
    v_mul_f32 v0, s17, v16
    v_add_f32 v40, v40, v41
    v_add_f32 v42, v42, v43
    v_pk_fma_f32 v[32:33], v[32:33], s[94:95], v[0:1] op_sel_hi:[1,1,0] neg_lo:[0,0,1] neg_hi:[0,0,1]
    v_pk_fma_f32 v[24:25], v[24:25], s[94:95], v[0:1] op_sel_hi:[1,1,0] neg_lo:[0,0,1] neg_hi:[0,0,1]
    v_pk_fma_f32 v[26:27], v[26:27], s[94:95], v[0:1] op_sel_hi:[1,1,0] neg_lo:[0,0,1] neg_hi:[0,0,1]
    v_pk_fma_f32 v[28:29], v[28:29], s[94:95], v[0:1] op_sel_hi:[1,1,0] neg_lo:[0,0,1] neg_hi:[0,0,1]
    v_pk_fma_f32 v[30:31], v[30:31], s[94:95], v[0:1] op_sel_hi:[1,1,0] neg_lo:[0,0,1] neg_hi:[0,0,1]
    v_mfma_f32_32x32x8_bf16 v[48:63], v[18:19], v[18:19], 0
    s_add_u32 s18, s18, 16384
    v_exp_f32 v32, v32
    v_exp_f32 v33, v33
    v_add_f32 v44, v44, v45
    v_add_f32 v46, v46, v47
    v_cvt_pk_bf16_f32 v20, v40, v42
    v_cvt_pk_bf16_f32 v22, v44, v46
    v_cvt_pk_bf16_f32 v16, v32, v33
    v_exp_f32 v24, v24
    v_exp_f32 v25, v25
    v_mfma_f32_16x16x16_bf16 v[40:43], v[20:21], v[16:17], 0
    s_add_u32 s19, s19, 16384
    v_exp_f32 v26, v26
    v_mfma_f32_16x16x16_bf16 v[44:47], v[22:23], v[16:17], 0
    s_add_u32 s21, s27, 79691776
    v_exp_f32 v27, v27
    v_mfma_f32_16x16x16_bf16 v[32:35], v[12:13], v[16:17], 0
    s_waitcnt lgkmcnt(6)
    v_exp_f32 v28, v28
    v_exp_f32 v29, v29
    v_exp_f32 v30, v30
    v_exp_f32 v31, v31
    v_cvt_pk_bf16_f32 v36, v24, v25
    v_cvt_pk_bf16_f32 v37, v26, v27
    v_cvt_pk_bf16_f32 v38, v28, v29
    v_cvt_pk_bf16_f32 v39, v30, v31
    v_xor_b32 v25, 512, v8
    v_xor_b32 v26, 1024, v8
    v_mfma_f32_16x16x32_bf16 v[32:35], v[12:15], v[36:39], v[32:35]
    s_nop 1
    v_xor_b32 v27, 1536, v8
    v_mfma_f32_16x16x32_bf16 v[40:43], v[84:87], v[36:39], v[40:43]
    s_add_u32 s28, s31, 4096
    v_mov_b64 v[12:13], -1
    v_mov_b64 v[14:15], -1
    v_mfma_f32_16x16x32_bf16 v[44:47], v[100:103], v[36:39], v[44:47]
    s_mov_b32 m0, 0
    v_rcp_f32 v0, v32
    s_add_u32 s22, s27, 79822848
    s_add_u32 s23, s30, s27
    v_pk_mul_f32 v[40:41], v[40:41], v[0:1] op_sel_hi:[1,0]
    v_pk_mul_f32 v[42:43], v[42:43], v[0:1] op_sel_hi:[1,0]
    v_cvt_pk_bf16_f32 v64, v40, v41
    v_cvt_pk_bf16_f32 v65, v42, v43
    v_pk_mul_f32 v[44:45], v[44:45], v[0:1] op_sel_hi:[1,0]
    v_pk_mul_f32 v[46:47], v[46:47], v[0:1] op_sel_hi:[1,0]
    v_cvt_pk_bf16_f32 v66, v44, v45
    v_cvt_pk_bf16_f32 v67, v46, v47
    v_cndmask_b32 v28, v64, v66, s[88:89]
    v_cndmask_b32 v29, v65, v67, s[88:89]
    ds_write_b64 v7, v[28:29] offset:12288
    buffer_store_dwordx4 v[12:15], v2, s[4:7], s25 offen offset:1024
    s_waitcnt lgkmcnt(0)
    s_barrier
    ds_read_b128 v[68:71], v25 offset:12288
    v_smfmac_f32_16x16x64_bf16 v[48:51], v[64:67], v[192:199], v1
    ds_read_b128 v[72:75], v26 offset:12288
    s_add_u32 s24, s23, 4096
    v_smfmac_f32_16x16x64_bf16 v[52:55], v[64:67], v[200:207], v1
    ds_read_b128 v[76:79], v27 offset:12288
    s_xor_b32 s34, s33, 16384
    v_smfmac_f32_16x16x64_bf16 v[56:59], v[64:67], v[240:247], v1
    ds_read_b128 v[84:87], v3 offset:21504
    v_smfmac_f32_16x16x64_bf16 v[60:63], v[64:67], v[248:255], v1
    ds_read_b128 v[100:103], v3 offset:25600
    s_waitcnt lgkmcnt(4)
    v_smfmac_f32_16x16x64_bf16 v[48:51], v[68:71], v[208:215], v1
    ds_read_b128 v[32:35], v3 offset:28672
    s_waitcnt lgkmcnt(4)
    v_smfmac_f32_16x16x64_bf16 v[48:51], v[72:75], v[224:231], v1
    ds_read_b128 v[36:39], v3 offset:29696
    s_waitcnt lgkmcnt(4)
    v_smfmac_f32_16x16x64_bf16 v[48:51], v[76:79], v[88:95], v1
    ds_read_b128 v[40:43], v3 offset:22528
    s_add_u32 s90, s21, 65536
    v_smfmac_f32_16x16x64_bf16 v[52:55], v[68:71], v[216:223], v1
    ds_read_b128 v[44:47], v3 offset:23552
    s_add_u32 s91, s22, 65536
    v_smfmac_f32_16x16x64_bf16 v[52:55], v[72:75], v[232:239], v1
    ds_read_b128 v[24:27], v3 offset:26624
    s_waitcnt lgkmcnt(3)
    v_cvt_pk_bf16_f32 v48, v48, v50
    v_cvt_pk_bf16_f32 v49, v49, v51
    v_smfmac_f32_16x16x64_bf16 v[52:55], v[76:79], v[104:111], v1
    buffer_store_dwordx2 v[48:49], v9, s[4:7], s21 offen
    v_smfmac_f32_16x16x64_bf16 v[56:59], v[68:71], v[80:87], v1
    ds_read_b128 v[28:31], v3 offset:27648
    ds_read_b128 v[88:91], v3 offset:30720
    v_smfmac_f32_16x16x64_bf16 v[56:59], v[72:75], v[96:103], v1
    ds_read_b128 v[92:95], v3 offset:31744
    s_waitcnt lgkmcnt(4)
    s_cmp_lg_u32 s15, 0
    v_cvt_pk_bf16_f32 v52, v52, v54
    v_cvt_pk_bf16_f32 v53, v53, v55
    v_smfmac_f32_16x16x64_bf16 v[56:59], v[76:79], v[32:39], v1
    buffer_store_dwordx2 v[52:53], v9, s[4:7], s90 offen
    v_smfmac_f32_16x16x64_bf16 v[60:63], v[68:71], v[40:47], v1
    s_waitcnt lgkmcnt(2)
    s_nop 1
    v_smfmac_f32_16x16x64_bf16 v[60:63], v[72:75], v[24:31], v1
    s_waitcnt lgkmcnt(0)
    s_nop 0
    v_cvt_pk_bf16_f32 v56, v56, v58
    v_cvt_pk_bf16_f32 v57, v57, v59
    v_smfmac_f32_16x16x64_bf16 v[60:63], v[76:79], v[88:95], v1
    buffer_store_dwordx2 v[56:57], v9, s[4:7], s22 offen
    s_nop 6
    v_cvt_pk_bf16_f32 v60, v60, v62
    v_cvt_pk_bf16_f32 v61, v61, v63
    buffer_store_dwordx2 v[60:61], v9, s[4:7], s91 offen
    s_barrier
    s_cbranch_scc1 L_ch_F0_w
    ds_read_b128 v[28:31], v2 offset:14336
    v_mov_b32 v50, s16
    s_bitcmp1_b32 s14, 3
    s_cbranch_scc0 L_ch_F0_q
    s_nop 2
    s_nop 2
    s_nop 2
L_ch_F0_q:
    s_cmp_lt_u32 s14, 16
    s_cbranch_scc1 L_ch_F0_e
    s_nop 3
    s_nop 3
    s_nop 3
    s_nop 3
    s_nop 3
    s_nop 3
    s_nop 3
    buffer_load_dwordx4 v[80:83], v2, s[4:7], s23 offen offset:0 sc1
    buffer_load_dwordx4 v[84:87], v2, s[4:7], s23 offen offset:1024 sc1
    s_nop 3
    s_nop 3
    s_nop 3
    s_nop 3
    buffer_load_dwordx4 v[80:83], v2, s[4:7], s23 offen offset:0 sc1
    buffer_load_dwordx4 v[84:87], v2, s[4:7], s23 offen offset:1024 sc1
    buffer_load_dwordx4 v[88:91], v2, s[4:7], s23 offen offset:2048 sc1
    buffer_load_dwordx4 v[92:95], v2, s[4:7], s23 offen offset:3072 sc1
    buffer_load_dwordx4 v[96:99], v2, s[4:7], s24 offen offset:0 sc1
    buffer_load_dwordx4 v[100:103], v2, s[4:7], s24 offen offset:1024 sc1
    buffer_load_dwordx4 v[104:107], v2, s[4:7], s24 offen offset:2048 sc1
    buffer_load_dwordx4 v[108:111], v2, s[4:7], s24 offen offset:3072 sc1
    ds_read_b128 v[64:67], v3 offset:0
    ds_read_b128 v[68:71], v3 offset:1024
    ds_read_b128 v[72:75], v3 offset:2048
    ds_read_b128 v[76:79], v3 offset:3072
    ds_read_b128 v[32:35], v3 offset:4096
    ds_read_b128 v[36:39], v3 offset:5120
    ds_read_b128 v[40:43], v3 offset:6144
    ds_read_b128 v[44:47], v3 offset:7168
    v_mov_b64 v[24:25], 0
    v_mov_b64 v[26:27], 0
    s_waitcnt lgkmcnt(8)
L_ch_F0_p1:
    s_waitcnt vmcnt(8)
    v_cmp_u_f32 vcc, v80, v84
    s_mov_b64 exec, s[50:51]
    s_cbranch_vccnz L_ch_F0_cb
L_ch_F0_cbx:
    buffer_store_dword v50, v2, s[4:7], s98 offen
    s_mov_b64 exec, -1
    s_barrier
L_ch_F0_p2:
    s_waitcnt vmcnt(7)
    v_smfmac_f32_16x16x64_bf16 v[24:27], v[28:31], v[80:87], v1
    s_waitcnt vmcnt(5)
    v_smfmac_f32_16x16x64_bf16 v[24:27], v[28:31], v[88:95], v1
    s_waitcnt vmcnt(3)
    v_smfmac_f32_16x16x64_bf16 v[24:27], v[28:31], v[96:103], v1
    s_waitcnt vmcnt(1)
    v_smfmac_f32_16x16x64_bf16 v[24:27], v[28:31], v[104:111], v1
    s_nop 7
    v_cvt_pk_bf16_f32 v48, v24, v25
    v_cvt_pk_bf16_f32 v49, v26, v27
    buffer_store_dwordx2 v[48:49], v10, s[4:7], s33 offen
    v_cmp_u_f32 vcc, v24, v25
    s_cbranch_vccnz L_ch_F0_r1
L_ch_F0_p1ok:
    v_add_u32 v0, s37, v2
    ds_write_b128 v0, v[112:115] offset:0
    ds_write_b128 v0, v[116:119] offset:1024
    ds_write_b128 v3, v[120:123] offset:32768
    ds_write_b128 v3, v[124:127] offset:33792
    ds_read_b128 v[80:83], v3 offset:8192
    ds_read_b128 v[84:87], v3 offset:9216
    ds_read_b128 v[88:91], v3 offset:10240
    ds_read_b128 v[92:95], v3 offset:11264
    ds_read_b128 v[96:99], v3 offset:12288
    v_mov_b64 v[24:25], 0
    ds_read_b128 v[100:103], v3 offset:13312
    v_mov_b64 v[26:27], 0
    ds_read_b128 v[104:107], v3 offset:14336
    v_mov_b64 v[28:29], 0
    ds_read_b128 v[108:111], v3 offset:15360
    v_mov_b64 v[30:31], 0
L_ch_F0_b1:
    s_barrier
    buffer_load_dwordx4 v[112:115], v2, s[4:7], s18 offen offset:0 sc1
    buffer_store_dwordx4 v[20:23], v2, s[4:7], s20 offen sc1
    buffer_store_dwordx4 v[12:15], v2, s[4:7], s25 offen offset:0
    s_add_u32 s20, s20, 4096
    s_cmp_lg_u32 s16, 63
    s_cbranch_scc1 L_ch_F0
    s_branch L_ch_fin
.p2align 6
L_ch_F0_w:
    s_cmp_eq_u32 s15, 1
    s_cbranch_scc1 L_ch_F0_fb
    s_cmp_lg_u32 s15, 3
    s_cbranch_scc1 L_ch_F0_w3
    buffer_store_dwordx2 v[12:13], v10, s[4:7], s34 offen
L_ch_F0_w3:
    s_barrier
    v_add_u32 v0, s37, v2
    s_waitcnt vmcnt(5)
    ds_write_b128 v0, v[112:115] offset:0
    ds_write_b128 v0, v[116:119] offset:1024
    ds_write_b128 v3, v[120:123] offset:32768
    ds_write_b128 v3, v[124:127] offset:33792
    ds_read_b128 v[64:67], v3 offset:0
    ds_read_b128 v[68:71], v3 offset:1024
    ds_read_b128 v[72:75], v3 offset:2048
    ds_read_b128 v[76:79], v3 offset:3072
    ds_read_b128 v[32:35], v3 offset:4096
    ds_read_b128 v[36:39], v3 offset:5120
    ds_read_b128 v[40:43], v3 offset:6144
    ds_read_b128 v[44:47], v3 offset:7168
    ds_read_b128 v[80:83], v3 offset:8192
    ds_read_b128 v[84:87], v3 offset:9216
    ds_read_b128 v[88:91], v3 offset:10240
    ds_read_b128 v[92:95], v3 offset:11264
    ds_read_b128 v[96:99], v3 offset:12288
    v_mov_b64 v[24:25], 0
    ds_read_b128 v[100:103], v3 offset:13312
    v_mov_b64 v[26:27], 0
    ds_read_b128 v[104:107], v3 offset:14336
    v_mov_b64 v[28:29], 0
    ds_read_b128 v[108:111], v3 offset:15360
    v_mov_b64 v[30:31], 0
    s_branch L_ch_F0_b1
.p2align 6
L_ch_F0_fb:
    ds_read_b128 v[64:67], v3 offset:0
    ds_read_b128 v[68:71], v3 offset:1024
    ds_read_b128 v[72:75], v3 offset:2048
    ds_read_b128 v[76:79], v3 offset:3072
    ds_read_b128 v[32:35], v3 offset:4096
    ds_read_b128 v[36:39], v3 offset:5120
    ds_read_b128 v[40:43], v3 offset:6144
    ds_read_b128 v[44:47], v3 offset:7168
    ds_read_b128 v[80:83], v3 offset:8192
    ds_read_b128 v[84:87], v3 offset:9216
    ds_read_b128 v[88:91], v3 offset:10240
    ds_read_b128 v[92:95], v3 offset:11264
    ds_read_b128 v[96:99], v3 offset:12288
    v_mov_b64 v[24:25], 0
    ds_read_b128 v[100:103], v3 offset:13312
    v_mov_b64 v[26:27], 0
    ds_read_b128 v[104:107], v3 offset:14336
    v_mov_b64 v[28:29], 0
    ds_read_b128 v[108:111], v3 offset:15360
    v_mov_b64 v[30:31], 0
    v_add_u32 v0, s37, v2
    s_waitcnt vmcnt(5)
    ds_write_b128 v0, v[112:115] offset:0
    ds_write_b128 v0, v[116:119] offset:1024
    ds_write_b128 v3, v[120:123] offset:32768
    ds_write_b128 v3, v[124:127] offset:33792
    v_lshrrev_b32 v0, 2, v2
    v_and_b32 v0, 4, v0
    s_add_u32 s45, s16, 1
    s_min_u32 s45, s45, 63
    s_lshl_b32 s45, s45, 2
L_ch_F0_kbc:
    v_lshl_add_u32 v11, v11, 3, v0
    v_cmp_ge_u32 vcc, s45, v11
    s_cbranch_vccnz L_ch_F0_kbw
L_ch_F0_kbx:
    v_mov_b32 v48, v0
    v_lshrrev_b32 v0, 2, v2
    v_and_b32 v0, 0x7c, v0
    s_barrier
    s_nop 3
    s_nop 3
    s_nop 3
    s_nop 3
    buffer_load_dword v16, v0, s[4:7], s99 offen sc1
    s_nop 7
    buffer_load_dword v16, v0, s[4:7], s99 offen sc1
    s_nop 7
    buffer_load_dword v16, v0, s[4:7], s99 offen sc1
    s_nop 7
    buffer_load_dword v16, v0, s[4:7], s99 offen sc1
    s_nop 7
    buffer_load_dword v16, v0, s[4:7], s99 offen sc1
    s_nop 7
L_ch_F0_fb2:
    buffer_load_dword v16, v0, s[4:7], s99 offen sc1
    s_waitcnt vmcnt(5)
    v_cmp_gt_u32 vcc, s16, v16
    s_cbranch_vccz L_ch_F0_fb3
    buffer_load_dword v16, v0, s[4:7], s99 offen sc1
    s_waitcnt vmcnt(5)
    v_cmp_gt_u32 vcc, s16, v16
    s_cbranch_vccz L_ch_F0_fb3
    buffer_load_dword v16, v0, s[4:7], s99 offen sc1
    s_waitcnt vmcnt(5)
    v_cmp_gt_u32 vcc, s16, v16
    s_cbranch_vccz L_ch_F0_fb3
    buffer_load_dword v16, v0, s[4:7], s99 offen sc1
    s_waitcnt vmcnt(5)
    v_cmp_gt_u32 vcc, s16, v16
    s_cbranch_vccz L_ch_F0_fb3
    buffer_load_dword v16, v0, s[4:7], s99 offen sc1
    s_waitcnt vmcnt(5)
    v_cmp_gt_u32 vcc, s16, v16
    s_cbranch_vccz L_ch_F0_fb3
    buffer_load_dword v16, v0, s[4:7], s99 offen sc1
    s_waitcnt vmcnt(5)
    v_cmp_gt_u32 vcc, s16, v16
    s_cbranch_vccz L_ch_F0_fb3
    buffer_load_dword v16, v0, s[4:7], s99 offen sc1
    s_waitcnt vmcnt(5)
    v_cmp_gt_u32 vcc, s16, v16
    s_cbranch_vccz L_ch_F0_fb3
    buffer_load_dword v16, v0, s[4:7], s99 offen sc1
    s_waitcnt vmcnt(5)
    v_cmp_gt_u32 vcc, s16, v16
    s_cbranch_vccz L_ch_F0_fb3
    s_add_u32 s96, s96, 1
    s_cmp_gt_u32 s96, 0x200000
    s_cbranch_scc0 L_ch_F0_fb2
    s_branch L_ch_F0_fb3
.p2align 6
L_ch_F0_fb3:
    buffer_load_dwordx4 v10, s[4:7], s31 offen offset:0 sc1 lds
    buffer_load_dwordx4 v10, s[4:7], s31 offen offset:1024 sc1 lds
    buffer_load_dwordx4 v10, s[4:7], s31 offen offset:2048 sc1 lds
    buffer_load_dwordx4 v10, s[4:7], s31 offen offset:3072 sc1 lds
    s_mov_b32 m0, 4096
    s_nop 3
    s_nop 3
    s_nop 0
    buffer_load_dwordx4 v10, s[4:7], s28 offen offset:0 sc1 lds
    buffer_load_dwordx4 v10, s[4:7], s28 offen offset:1024 sc1 lds
    buffer_load_dwordx4 v10, s[4:7], s28 offen offset:2048 sc1 lds
    buffer_load_dwordx4 v10, s[4:7], s28 offen offset:3072 sc1 lds
    s_barrier
    buffer_load_dwordx4 v[112:115], v2, s[4:7], s18 offen offset:0 sc1
    buffer_store_dwordx4 v[20:23], v2, s[4:7], s20 offen sc1
    buffer_store_dwordx4 v[12:15], v2, s[4:7], s25 offen offset:0
    buffer_load_dword v11, v48, s[4:7], s38 offen sc1
    s_add_u32 s20, s20, 4096
    s_cmp_lg_u32 s16, 63
    s_cbranch_scc1 L_ch_F0
    s_branch L_ch_fin
L_ch_F0_kbw:
    s_add_u32 s96, s96, 1
    s_cmp_gt_u32 s96, 0x200000
    s_cbranch_scc1 L_ch_F0_kbx
    buffer_load_dword v11, v0, s[4:7], s38 offen sc1
    s_waitcnt vmcnt(0)
    s_branch L_ch_F0_kbc
.p2align 6
L_ch_F0_e:
    s_nop 3
    s_nop 3
    s_nop 3
    s_nop 3
    buffer_load_dwordx4 v[80:83], v2, s[4:7], s23 offen offset:0 sc1
    buffer_load_dwordx4 v[84:87], v2, s[4:7], s23 offen offset:1024 sc1
    buffer_load_dwordx4 v[88:91], v2, s[4:7], s23 offen offset:2048 sc1
    buffer_load_dwordx4 v[92:95], v2, s[4:7], s23 offen offset:3072 sc1
    buffer_load_dwordx4 v[96:99], v2, s[4:7], s24 offen offset:0 sc1
    buffer_load_dwordx4 v[100:103], v2, s[4:7], s24 offen offset:1024 sc1
    buffer_load_dwordx4 v[104:107], v2, s[4:7], s24 offen offset:2048 sc1
    buffer_load_dwordx4 v[108:111], v2, s[4:7], s24 offen offset:3072 sc1
    ds_read_b128 v[64:67], v3 offset:0
    ds_read_b128 v[68:71], v3 offset:1024
    ds_read_b128 v[72:75], v3 offset:2048
    ds_read_b128 v[76:79], v3 offset:3072
    ds_read_b128 v[32:35], v3 offset:4096
    ds_read_b128 v[36:39], v3 offset:5120
    ds_read_b128 v[40:43], v3 offset:6144
    ds_read_b128 v[44:47], v3 offset:7168
    v_mov_b64 v[24:25], 0
    v_mov_b64 v[26:27], 0
    s_waitcnt lgkmcnt(8)
    s_branch L_ch_F0_cl
.p2align 6
L_ch_F0_cb:
    s_mov_b64 exec, -1
L_ch_F0_cl:
    s_waitcnt vmcnt(6)
    v_cmp_u_f32 vcc, v80, v84
    s_mov_b64 exec, s[50:51]
    s_cbranch_vccz L_ch_F0_cbx
L_ch_F0_r0:
    s_mov_b64 exec, -1
    s_add_u32 s36, s36, 0
L_ch_F0_r0l:
    buffer_load_dwordx4 v[80:83], v2, s[4:7], s23 offen offset:0 sc1
    buffer_load_dwordx4 v[84:87], v2, s[4:7], s23 offen offset:1024 sc1
    buffer_load_dwordx4 v[88:91], v2, s[4:7], s23 offen offset:2048 sc1
    buffer_load_dwordx4 v[92:95], v2, s[4:7], s23 offen offset:3072 sc1
    buffer_load_dwordx4 v[96:99], v2, s[4:7], s24 offen offset:0 sc1
    buffer_load_dwordx4 v[100:103], v2, s[4:7], s24 offen offset:1024 sc1
    buffer_load_dwordx4 v[104:107], v2, s[4:7], s24 offen offset:2048 sc1
    buffer_load_dwordx4 v[108:111], v2, s[4:7], s24 offen offset:3072 sc1
    s_add_u32 s36, s36, 1
    s_cmp_gt_u32 s36, 0x200000
    s_cbranch_scc1 L_ch_F0_r0g
    s_waitcnt vmcnt(6)
    v_cmp_u_f32 vcc, v80, v84
    s_cbranch_vccnz L_ch_F0_r0l
L_ch_F0_r0g:
    v_mov_b64 v[24:25], 0
    v_mov_b64 v[26:27], 0
    s_nop 0
    s_waitcnt vmcnt(6)
    v_smfmac_f32_16x16x64_bf16 v[24:27], v[28:31], v[80:87], v1
    s_waitcnt vmcnt(4)
    v_smfmac_f32_16x16x64_bf16 v[24:27], v[28:31], v[88:95], v1
    s_waitcnt vmcnt(2)
    v_smfmac_f32_16x16x64_bf16 v[24:27], v[28:31], v[96:103], v1
    s_waitcnt vmcnt(0)
    v_smfmac_f32_16x16x64_bf16 v[24:27], v[28:31], v[104:111], v1
    s_nop 7
    v_cmp_u_f32 vcc, v24, v25
    v_cvt_pk_bf16_f32 v48, v24, v25
    v_cvt_pk_bf16_f32 v49, v26, v27
    s_cbranch_scc1 L_ch_F0_r0e
    s_cbranch_vccnz L_ch_F0_r0l
L_ch_F0_r0e:
    buffer_store_dwordx2 v[48:49], v10, s[4:7], s33 offen
    s_mov_b64 exec, s[50:51]
    buffer_store_dword v50, v2, s[4:7], s98 offen
    s_mov_b64 exec, -1
    s_barrier
    s_branch L_ch_F0_p1ok
L_ch_F0_r1:
    v_add_u32 v50, -1, v50
    s_mov_b64 exec, s[50:51]
    buffer_store_dword v50, v2, s[4:7], s98 offen
    s_mov_b64 exec, -1
    v_add_u32 v50, 1, v50
    s_add_u32 s36, s36, 255
L_ch_F0_r1l:
    buffer_load_dwordx4 v[80:83], v2, s[4:7], s23 offen offset:0 sc1
    buffer_load_dwordx4 v[84:87], v2, s[4:7], s23 offen offset:1024 sc1
    buffer_load_dwordx4 v[88:91], v2, s[4:7], s23 offen offset:2048 sc1
    buffer_load_dwordx4 v[92:95], v2, s[4:7], s23 offen offset:3072 sc1
    buffer_load_dwordx4 v[96:99], v2, s[4:7], s24 offen offset:0 sc1
    buffer_load_dwordx4 v[100:103], v2, s[4:7], s24 offen offset:1024 sc1
    buffer_load_dwordx4 v[104:107], v2, s[4:7], s24 offen offset:2048 sc1
    buffer_load_dwordx4 v[108:111], v2, s[4:7], s24 offen offset:3072 sc1
    s_add_u32 s36, s36, 1
    s_cmp_gt_u32 s36, 0x200000
    s_cbranch_scc1 L_ch_F0_r1g
    s_waitcnt vmcnt(6)
    v_cmp_u_f32 vcc, v80, v84
    s_cbranch_vccnz L_ch_F0_r1l
L_ch_F0_r1g:
    v_mov_b64 v[24:25], 0
    v_mov_b64 v[26:27], 0
    s_nop 0
    s_waitcnt vmcnt(6)
    v_smfmac_f32_16x16x64_bf16 v[24:27], v[28:31], v[80:87], v1
    s_waitcnt vmcnt(4)
    v_smfmac_f32_16x16x64_bf16 v[24:27], v[28:31], v[88:95], v1
    s_waitcnt vmcnt(2)
    v_smfmac_f32_16x16x64_bf16 v[24:27], v[28:31], v[96:103], v1
    s_waitcnt vmcnt(0)
    v_smfmac_f32_16x16x64_bf16 v[24:27], v[28:31], v[104:111], v1
    s_nop 7
    v_cmp_u_f32 vcc, v24, v25
    v_cvt_pk_bf16_f32 v48, v24, v25
    v_cvt_pk_bf16_f32 v49, v26, v27
    s_cbranch_scc1 L_ch_F0_r1e
    s_cbranch_vccnz L_ch_F0_r1l
L_ch_F0_r1e:
    buffer_store_dwordx2 v[48:49], v10, s[4:7], s33 offen
    s_mov_b64 exec, s[50:51]
    buffer_store_dword v50, v2, s[4:7], s98 offen
    s_mov_b64 exec, -1
    s_branch L_ch_F0_p1ok
L_ch_F0_r2:
    s_add_u32 s29, s29, 1
    s_cmp_gt_u32 s29, 0x200000
    s_cbranch_scc1 L_ch_F0_r2x
    s_cmp_eq_u32 s16, 0
    s_cbranch_scc1 L_ch_F0_r2x
    s_mov_b32 m0, 0
    s_cmp_lg_u32 s15, 1
    s_waitcnt lgkmcnt(0)
    s_barrier
    s_cbranch_scc1 L_ch_F0_r2b
    buffer_load_dwordx4 v10, s[4:7], s31 offen offset:0 sc1 lds
    buffer_load_dwordx4 v10, s[4:7], s31 offen offset:1024 sc1 lds
    buffer_load_dwordx4 v10, s[4:7], s31 offen offset:2048 sc1 lds
    buffer_load_dwordx4 v10, s[4:7], s31 offen offset:3072 sc1 lds
    s_mov_b32 m0, 4096
    s_nop 0
    buffer_load_dwordx4 v10, s[4:7], s28 offen offset:0 sc1 lds
    buffer_load_dwordx4 v10, s[4:7], s28 offen offset:1024 sc1 lds
    buffer_load_dwordx4 v10, s[4:7], s28 offen offset:2048 sc1 lds
    buffer_load_dwordx4 v10, s[4:7], s28 offen offset:3072 sc1 lds
L_ch_F0_r2b:
    s_nop 7
    v_mov_b64 v[12:13], -1
    v_mov_b64 v[14:15], -1
    ds_read_b128 v[64:67], v3 offset:0
    ds_read_b128 v[68:71], v3 offset:1024
    ds_read_b128 v[72:75], v3 offset:2048
    ds_read_b128 v[76:79], v3 offset:3072
    ds_read_b128 v[32:35], v3 offset:4096
    ds_read_b128 v[36:39], v3 offset:5120
    ds_read_b128 v[40:43], v3 offset:6144
    ds_read_b128 v[44:47], v3 offset:7168
    ds_read_b128 v[80:83], v3 offset:8192
    ds_read_b128 v[84:87], v3 offset:9216
    ds_read_b128 v[88:91], v3 offset:10240
    ds_read_b128 v[92:95], v3 offset:11264
    ds_read_b128 v[96:99], v3 offset:12288
    ds_read_b128 v[100:103], v3 offset:13312
    ds_read_b128 v[104:107], v3 offset:14336
    ds_read_b128 v[108:111], v3 offset:15360
    v_mov_b64 v[24:25], 0
    v_mov_b64 v[26:27], 0
    v_mov_b64 v[28:29], 0
    v_mov_b64 v[30:31], 0
    s_waitcnt vmcnt(0) lgkmcnt(0)
    s_barrier
    ds_read_b128 v[48:51], v2 offset:0
    ds_read_b128 v[52:55], v2 offset:1024
    ds_read_b128 v[56:59], v2 offset:2048
    ds_read_b128 v[60:63], v2 offset:3072
    s_branch L_ch_F0_re
L_ch_S0:
    s_waitcnt vmcnt(8) lgkmcnt(0)
    s_barrier
    ds_read_b128 v[48:51], v2 offset:0
    ds_read_b128 v[52:55], v2 offset:1024
    ds_read_b128 v[56:59], v2 offset:2048
    ds_read_b128 v[60:63], v2 offset:3072
L_ch_S0_re:
    buffer_load_dwordx4 v[116:119], v2, s[4:7], s18 offen offset:1024 sc1
    s_waitcnt lgkmcnt(3)
    v_smfmac_f32_16x16x64_bf16 v[24:27], v[48:51], v[64:71], v1
    v_smfmac_f32_16x16x64_bf16 v[28:31], v[48:51], v[72:79], v1
    s_waitcnt lgkmcnt(2)
    v_smfmac_f32_16x16x64_bf16 v[24:27], v[52:55], v[32:39], v1
    buffer_load_dwordx4 v[120:123], v2, s[4:7], s19 offen offset:0 sc1
    v_smfmac_f32_16x16x64_bf16 v[28:31], v[52:55], v[40:47], v1
    s_waitcnt lgkmcnt(1)
    v_smfmac_f32_16x16x64_bf16 v[24:27], v[56:59], v[80:87], v1
    v_smfmac_f32_16x16x64_bf16 v[28:31], v[56:59], v[88:95], v1
    s_waitcnt lgkmcnt(0)
    v_mfma_f32_4x4x4_16b_bf16 v[32:35], v[18:19], v[18:19], 0
    v_smfmac_f32_16x16x64_bf16 v[24:27], v[60:63], v[96:103], v1
    buffer_load_dwordx4 v[124:127], v2, s[4:7], s19 offen offset:1024 sc1
    v_smfmac_f32_16x16x64_bf16 v[28:31], v[60:63], v[104:111], v1
    s_nop 0
    v_smfmac_f32_16x16x64_bf16 v[32:35], v[48:51], a[64:71], v1
    v_mov_b64 v[36:37], 0
    v_smfmac_f32_16x16x64_bf16 v[32:35], v[52:55], a[80:87], v1
    s_waitcnt vmcnt(7)
    v_mov_b64 v[38:39], 0
    v_smfmac_f32_16x16x64_bf16 v[32:35], v[56:59], a[96:103], v1
    s_barrier
    v_smfmac_f32_16x16x64_bf16 v[32:35], v[60:63], a[112:119], v1
    ds_read_b128 v[64:67], v2 offset:4096
    v_mov_b64 v[40:41], 0
    v_smfmac_f32_16x16x64_bf16 v[36:39], v[48:51], a[72:79], v1
    ds_read_b128 v[68:71], v2 offset:5120
    v_mov_b64 v[42:43], 0
    v_smfmac_f32_16x16x64_bf16 v[36:39], v[52:55], a[88:95], v1
    ds_read_b128 v[72:75], v2 offset:6144
    v_mov_b64 v[44:45], 0
    v_smfmac_f32_16x16x64_bf16 v[36:39], v[56:59], a[104:111], v1
    ds_read_b128 v[76:79], v2 offset:7168
    v_mov_b64 v[46:47], 0
    v_smfmac_f32_16x16x64_bf16 v[36:39], v[60:63], a[120:127], v1
    ds_read_b128 v[80:83], v2 offset:16384
    s_waitcnt lgkmcnt(4)
    v_smfmac_f32_16x16x64_bf16 v[24:27], v[64:67], a[0:7], v1
    ds_read_b128 v[96:99], v2 offset:20480
    s_waitcnt lgkmcnt(4)
    v_smfmac_f32_16x16x64_bf16 v[24:27], v[68:71], a[16:23], v1
    ds_read_b128 v[84:87], v2 offset:17408
    s_waitcnt lgkmcnt(4)
    v_smfmac_f32_16x16x64_bf16 v[24:27], v[72:75], a[32:39], v1
    ds_read_b128 v[100:103], v2 offset:21504
    s_waitcnt lgkmcnt(4)
    v_smfmac_f32_16x16x64_bf16 v[24:27], v[76:79], a[48:55], v1
    s_nop 0
    v_smfmac_f32_16x16x64_bf16 v[28:31], v[64:67], a[8:15], v1
    ds_read_b128 v[88:91], v2 offset:18432
    v_mov_b64 v[12:13], s[92:93]
    v_smfmac_f32_16x16x64_bf16 v[28:31], v[68:71], a[24:31], v1
    ds_read_b128 v[92:95], v2 offset:19456
    v_mov_b64 v[14:15], s[92:93]
    v_smfmac_f32_16x16x64_bf16 v[28:31], v[72:75], a[40:47], v1
    ds_read_b128 v[104:107], v2 offset:22528
    v_add_f32 v24, v24, v25
    v_smfmac_f32_16x16x64_bf16 v[28:31], v[76:79], a[56:63], v1
    ds_read_b128 v[108:111], v2 offset:23552
    v_add_f32 v26, v26, v27
    v_smfmac_f32_16x16x64_bf16 v[32:35], v[64:67], a[128:135], v1
    s_nop 1
    v_cmp_u_f32 vcc, v24, v26
    v_smfmac_f32_16x16x64_bf16 v[32:35], v[68:71], a[144:151], v1
    s_nop 0
    v_add_f32 v28, v28, v29
    v_smfmac_f32_16x16x64_bf16 v[32:35], v[72:75], a[160:167], v1
    s_cbranch_vccnz L_ch_S0_r2
L_ch_S0_r2x:
    v_add_f32 v30, v30, v31
    v_smfmac_f32_16x16x64_bf16 v[32:35], v[76:79], a[176:183], v1
    s_nop 1
    v_cvt_pk_bf16_f32 v25, v24, v28
    v_smfmac_f32_16x16x64_bf16 v[36:39], v[64:67], a[136:143], v1
    v_cvt_pk_bf16_f32 v27, v26, v30
    v_smfmac_f32_16x16x64_bf16 v[36:39], v[68:71], a[152:159], v1
    ds_write2_b32 v4, v25, v27 offset0:0 offset1:4
    v_smfmac_f32_16x16x64_bf16 v[36:39], v[72:75], a[168:175], v1
    v_add_f32 v32, v32, v33
    v_smfmac_f32_16x16x64_bf16 v[36:39], v[76:79], a[184:191], v1
    v_add_f32 v34, v34, v35
    v_smfmac_f32_16x16x64_bf16 v[40:43], v[48:51], a[192:199], v1
    s_nop 2
    v_smfmac_f32_16x16x64_bf16 v[44:47], v[48:51], a[200:207], v1
    s_waitcnt lgkmcnt(0)
    s_barrier
    v_add_f32 v36, v36, v37
    v_smfmac_f32_16x16x64_bf16 v[40:43], v[52:55], a[208:215], v1
    ds_read_b128 v[48:51], v5 offset:8192
    v_add_f32 v38, v38, v39
    v_smfmac_f32_16x16x64_bf16 v[44:47], v[52:55], a[216:223], v1
    ds_read_b128 v[52:55], v5 offset:8704
    v_cvt_pk_bf16_f32 v21, v32, v36
    v_smfmac_f32_16x16x64_bf16 v[40:43], v[56:59], a[224:231], v1
    v_cvt_pk_bf16_f32 v23, v34, v38
    v_smfmac_f32_16x16x64_bf16 v[44:47], v[56:59], a[232:239], v1
    ds_write2_b32 v6, v21, v23 offset0:0 offset1:8
    v_smfmac_f32_16x16x64_bf16 v[40:43], v[60:63], a[240:247], v1
    ds_read_b128 v[56:59], v5 offset:9216
    v_mov_b64 v[32:33], 0
    v_smfmac_f32_16x16x64_bf16 v[44:47], v[60:63], a[248:255], v1
    ds_read_b128 v[60:63], v5 offset:9728
    s_waitcnt lgkmcnt(3)
    v_mfma_f32_16x16x32_bf16 v[24:27], v[80:83], v[48:51], 0
    v_mov_b64 v[34:35], 0
    v_mfma_f32_16x16x32_bf16 v[28:31], v[96:99], v[48:51], 0
    v_mfma_f32_16x16x32_bf16 v[24:27], v[84:87], v[52:55], v[24:27]
    s_waitcnt lgkmcnt(2)
    s_barrier
    v_mfma_f32_16x16x32_bf16 v[28:31], v[100:103], v[52:55], v[28:31]
    ds_read_b128 v[80:83], v2 offset:10240
    s_waitcnt lgkmcnt(1)
    v_mfma_f32_16x16x32_bf16 v[24:27], v[88:91], v[56:59], v[24:27]
    ds_read_b128 v[96:99], v2 offset:11264
    v_mfma_f32_16x16x32_bf16 v[24:27], v[92:95], v[60:63], v[24:27]
    ds_read_b128 v[84:87], v3 offset:32768
    v_mfma_f32_16x16x32_bf16 v[28:31], v[104:107], v[56:59], v[28:31]
    ds_read_b128 v[100:103], v3 offset:33792
    v_mfma_f32_16x16x32_bf16 v[28:31], v[108:111], v[60:63], v[28:31]
    s_add_u32 s35, s35, 8192
    s_and_b32 s35, s35, 0x7fff
    v_smfmac_f32_16x16x64_bf16 v[40:43], v[64:67], v[128:135], v1
    s_waitcnt lgkmcnt(2)
    s_add_u32 s31, s35, 80740352
    v_max3_f32 v16, v24, v25, v26
    v_smfmac_f32_16x16x64_bf16 v[32:35], v[80:83], v[48:55], v1
    s_add_u32 s33, s32, s35
    s_add_u32 s25, s26, s27
    v_max3_f32 v16, v16, v27, v28
    v_smfmac_f32_16x16x64_bf16 v[32:35], v[96:99], v[56:63], v1
    ds_read_b128 v[80:83], v3 offset:20480
    v_max3_f32 v16, v16, v29, v30
    v_smfmac_f32_16x16x64_bf16 v[40:43], v[68:71], v[144:151], v1
    ds_read_b128 v[96:99], v3 offset:24576
    s_add_u32 s27, s27, 262144
    v_smfmac_f32_16x16x64_bf16 v[40:43], v[72:75], v[160:167], v1
    s_and_b32 s27, s27, 0xfffff
    s_add_u32 s16, s16, 1
    v_add_f32 v32, v32, v33
    v_add_f32 v33, v34, v35
    v_smfmac_f32_16x16x64_bf16 v[40:43], v[76:79], v[176:183], v1
    v_max3_f32 v16, v16, v31, v32
    v_max_f32 v35, v16, v33
    v_max_f32 v16, v16, v33
    v_smfmac_f32_16x16x64_bf16 v[44:47], v[64:67], v[136:143], v1
    ds_read_b128 v[88:91], v3 offset:16384
    v_permlane32_swap_b32 v16, v35
    v_smfmac_f32_16x16x64_bf16 v[44:47], v[68:71], v[152:159], v1
    ds_read_b128 v[92:95], v3 offset:17408
    v_max_f32 v0, v16, v35
    v_max_f32 v16, v16, v35
    v_smfmac_f32_16x16x64_bf16 v[44:47], v[72:75], v[168:175], v1
    ds_read_b128 v[104:107], v3 offset:18432
    v_permlane16_swap_b32 v16, v0
    v_smfmac_f32_16x16x64_bf16 v[44:47], v[76:79], v[184:191], v1
    ds_read_b128 v[108:111], v3 offset:19456
    v_max_f32 v16, v16, v0
    v_mul_f32 v0, s17, v16
    v_add_f32 v40, v40, v41
    v_add_f32 v42, v42, v43
    v_pk_fma_f32 v[32:33], v[32:33], s[94:95], v[0:1] op_sel_hi:[1,1,0] neg_lo:[0,0,1] neg_hi:[0,0,1]
    v_pk_fma_f32 v[24:25], v[24:25], s[94:95], v[0:1] op_sel_hi:[1,1,0] neg_lo:[0,0,1] neg_hi:[0,0,1]
    v_pk_fma_f32 v[26:27], v[26:27], s[94:95], v[0:1] op_sel_hi:[1,1,0] neg_lo:[0,0,1] neg_hi:[0,0,1]
    v_pk_fma_f32 v[28:29], v[28:29], s[94:95], v[0:1] op_sel_hi:[1,1,0] neg_lo:[0,0,1] neg_hi:[0,0,1]
    v_pk_fma_f32 v[30:31], v[30:31], s[94:95], v[0:1] op_sel_hi:[1,1,0] neg_lo:[0,0,1] neg_hi:[0,0,1]
    v_mfma_f32_32x32x8_bf16 v[48:63], v[18:19], v[18:19], 0
    s_add_u32 s18, s18, 16384
    v_exp_f32 v32, v32
    v_exp_f32 v33, v33
    v_add_f32 v44, v44, v45
    v_add_f32 v46, v46, v47
    v_cvt_pk_bf16_f32 v20, v40, v42
    v_cvt_pk_bf16_f32 v22, v44, v46
    v_cvt_pk_bf16_f32 v16, v32, v33
    v_exp_f32 v24, v24
    v_exp_f32 v25, v25
    v_mfma_f32_16x16x16_bf16 v[40:43], v[20:21], v[16:17], 0
    s_add_u32 s19, s19, 16384
    v_exp_f32 v26, v26
    v_mfma_f32_16x16x16_bf16 v[44:47], v[22:23], v[16:17], 0
    s_add_u32 s21, s27, 79691776
    v_exp_f32 v27, v27
    v_mfma_f32_16x16x16_bf16 v[32:35], v[12:13], v[16:17], 0
    s_waitcnt lgkmcnt(6)
    v_exp_f32 v28, v28
    v_exp_f32 v29, v29
    v_exp_f32 v30, v30
    v_exp_f32 v31, v31
    v_cvt_pk_bf16_f32 v36, v24, v25
    v_cvt_pk_bf16_f32 v37, v26, v27
    v_cvt_pk_bf16_f32 v38, v28, v29
    v_cvt_pk_bf16_f32 v39, v30, v31
    v_xor_b32 v25, 512, v8
    v_xor_b32 v26, 1024, v8
    v_mfma_f32_16x16x32_bf16 v[32:35], v[12:15], v[36:39], v[32:35]
    s_nop 1
    v_xor_b32 v27, 1536, v8
    v_mfma_f32_16x16x32_bf16 v[40:43], v[84:87], v[36:39], v[40:43]
    s_add_u32 s28, s31, 4096
    v_mov_b64 v[12:13], -1
    v_mov_b64 v[14:15], -1
    v_mfma_f32_16x16x32_bf16 v[44:47], v[100:103], v[36:39], v[44:47]
    s_mov_b32 m0, 0
    v_rcp_f32 v0, v32
    s_add_u32 s22, s27, 79822848
    s_add_u32 s23, s30, s27
    v_pk_mul_f32 v[40:41], v[40:41], v[0:1] op_sel_hi:[1,0]
    v_pk_mul_f32 v[42:43], v[42:43], v[0:1] op_sel_hi:[1,0]
    v_cvt_pk_bf16_f32 v64, v40, v41
    v_cvt_pk_bf16_f32 v65, v42, v43
    v_pk_mul_f32 v[44:45], v[44:45], v[0:1] op_sel_hi:[1,0]
    v_pk_mul_f32 v[46:47], v[46:47], v[0:1] op_sel_hi:[1,0]
    v_cvt_pk_bf16_f32 v66, v44, v45
    v_cvt_pk_bf16_f32 v67, v46, v47
    v_cndmask_b32 v28, v64, v66, s[88:89]
    v_cndmask_b32 v29, v65, v67, s[88:89]
    ds_write_b64 v7, v[28:29] offset:12288
    buffer_store_dwordx4 v[12:15], v2, s[4:7], s25 offen offset:1024 sc1
    s_waitcnt lgkmcnt(0)
    s_barrier
    ds_read_b128 v[68:71], v25 offset:12288
    v_smfmac_f32_16x16x64_bf16 v[48:51], v[64:67], v[192:199], v1
    ds_read_b128 v[72:75], v26 offset:12288
    s_add_u32 s24, s23, 4096
    v_smfmac_f32_16x16x64_bf16 v[52:55], v[64:67], v[200:207], v1
    ds_read_b128 v[76:79], v27 offset:12288
    s_xor_b32 s34, s33, 16384
    v_smfmac_f32_16x16x64_bf16 v[56:59], v[64:67], v[240:247], v1
    ds_read_b128 v[84:87], v3 offset:21504
    v_smfmac_f32_16x16x64_bf16 v[60:63], v[64:67], v[248:255], v1
    ds_read_b128 v[100:103], v3 offset:25600
    s_waitcnt lgkmcnt(4)
    v_smfmac_f32_16x16x64_bf16 v[48:51], v[68:71], v[208:215], v1
    ds_read_b128 v[32:35], v3 offset:28672
    s_waitcnt lgkmcnt(4)
    v_smfmac_f32_16x16x64_bf16 v[48:51], v[72:75], v[224:231], v1
    ds_read_b128 v[36:39], v3 offset:29696
    s_waitcnt lgkmcnt(4)
    v_smfmac_f32_16x16x64_bf16 v[48:51], v[76:79], v[88:95], v1
    ds_read_b128 v[40:43], v3 offset:22528
    s_add_u32 s90, s21, 65536
    v_smfmac_f32_16x16x64_bf16 v[52:55], v[68:71], v[216:223], v1
    ds_read_b128 v[44:47], v3 offset:23552
    s_add_u32 s91, s22, 65536
    v_smfmac_f32_16x16x64_bf16 v[52:55], v[72:75], v[232:239], v1
    ds_read_b128 v[24:27], v3 offset:26624
    s_waitcnt lgkmcnt(3)
    v_cvt_pk_bf16_f32 v48, v48, v50
    v_cvt_pk_bf16_f32 v49, v49, v51
    v_smfmac_f32_16x16x64_bf16 v[52:55], v[76:79], v[104:111], v1
    buffer_store_dwordx2 v[48:49], v9, s[4:7], s21 offen sc1
    v_smfmac_f32_16x16x64_bf16 v[56:59], v[68:71], v[80:87], v1
    ds_read_b128 v[28:31], v3 offset:27648
    ds_read_b128 v[88:91], v3 offset:30720
    v_smfmac_f32_16x16x64_bf16 v[56:59], v[72:75], v[96:103], v1
    ds_read_b128 v[92:95], v3 offset:31744
    s_waitcnt lgkmcnt(4)
    s_cmp_lg_u32 s15, 0
    v_cvt_pk_bf16_f32 v52, v52, v54
    v_cvt_pk_bf16_f32 v53, v53, v55
    v_smfmac_f32_16x16x64_bf16 v[56:59], v[76:79], v[32:39], v1
    buffer_store_dwordx2 v[52:53], v9, s[4:7], s90 offen sc1
    v_smfmac_f32_16x16x64_bf16 v[60:63], v[68:71], v[40:47], v1
    s_waitcnt lgkmcnt(2)
    s_nop 1
    v_smfmac_f32_16x16x64_bf16 v[60:63], v[72:75], v[24:31], v1
    s_waitcnt lgkmcnt(0)
    s_nop 0
    v_cvt_pk_bf16_f32 v56, v56, v58
    v_cvt_pk_bf16_f32 v57, v57, v59
    v_smfmac_f32_16x16x64_bf16 v[60:63], v[76:79], v[88:95], v1
    buffer_store_dwordx2 v[56:57], v9, s[4:7], s22 offen sc1
    s_nop 6
    v_cvt_pk_bf16_f32 v60, v60, v62
    v_cvt_pk_bf16_f32 v61, v61, v63
    buffer_store_dwordx2 v[60:61], v9, s[4:7], s91 offen sc1
    s_barrier
    s_cbranch_scc1 L_ch_S0_w
    ds_read_b128 v[28:31], v2 offset:14336
    v_mov_b32 v50, s16
    s_bitcmp1_b32 s14, 3
    s_cbranch_scc0 L_ch_S0_q
    s_nop 2
    s_nop 2
    s_nop 2
L_ch_S0_q:
    s_cmp_lt_u32 s14, 16
    s_cbranch_scc1 L_ch_S0_e
    s_nop 3
    s_nop 3
    s_nop 3
    s_nop 3
    s_nop 3
    s_nop 3
    s_nop 3
    buffer_load_dwordx4 v[80:83], v2, s[4:7], s23 offen offset:0 sc1
    buffer_load_dwordx4 v[84:87], v2, s[4:7], s23 offen offset:1024 sc1
    s_nop 3
    s_nop 3
    s_nop 3
    s_nop 3
    buffer_load_dwordx4 v[80:83], v2, s[4:7], s23 offen offset:0 sc1
    buffer_load_dwordx4 v[84:87], v2, s[4:7], s23 offen offset:1024 sc1
    buffer_load_dwordx4 v[88:91], v2, s[4:7], s23 offen offset:2048 sc1
    buffer_load_dwordx4 v[92:95], v2, s[4:7], s23 offen offset:3072 sc1
    buffer_load_dwordx4 v[96:99], v2, s[4:7], s24 offen offset:0 sc1
    buffer_load_dwordx4 v[100:103], v2, s[4:7], s24 offen offset:1024 sc1
    buffer_load_dwordx4 v[104:107], v2, s[4:7], s24 offen offset:2048 sc1
    buffer_load_dwordx4 v[108:111], v2, s[4:7], s24 offen offset:3072 sc1
    ds_read_b128 v[64:67], v3 offset:0
    ds_read_b128 v[68:71], v3 offset:1024
    ds_read_b128 v[72:75], v3 offset:2048
    ds_read_b128 v[76:79], v3 offset:3072
    ds_read_b128 v[32:35], v3 offset:4096
    ds_read_b128 v[36:39], v3 offset:5120
    ds_read_b128 v[40:43], v3 offset:6144
    ds_read_b128 v[44:47], v3 offset:7168
    v_mov_b64 v[24:25], 0
    v_mov_b64 v[26:27], 0
    s_waitcnt lgkmcnt(8)
L_ch_S0_p1:
    s_waitcnt vmcnt(8)
    v_cmp_u_f32 vcc, v80, v84
    s_mov_b64 exec, s[50:51]
    s_cbranch_vccnz L_ch_S0_cb
L_ch_S0_cbx:
    buffer_store_dword v50, v2, s[4:7], s98 offen sc1
    s_mov_b64 exec, -1
    s_barrier
L_ch_S0_p2:
    s_waitcnt vmcnt(7)
    v_smfmac_f32_16x16x64_bf16 v[24:27], v[28:31], v[80:87], v1
    s_waitcnt vmcnt(5)
    v_smfmac_f32_16x16x64_bf16 v[24:27], v[28:31], v[88:95], v1
    s_waitcnt vmcnt(3)
    v_smfmac_f32_16x16x64_bf16 v[24:27], v[28:31], v[96:103], v1
    s_waitcnt vmcnt(1)
    v_smfmac_f32_16x16x64_bf16 v[24:27], v[28:31], v[104:111], v1
    s_nop 7
    v_cvt_pk_bf16_f32 v48, v24, v25
    v_cvt_pk_bf16_f32 v49, v26, v27
    buffer_store_dwordx2 v[48:49], v10, s[4:7], s33 offen sc1
    v_cmp_u_f32 vcc, v24, v25
    s_cbranch_vccnz L_ch_S0_r1
L_ch_S0_p1ok:
    v_add_u32 v0, s37, v2
    ds_write_b128 v0, v[112:115] offset:0
    ds_write_b128 v0, v[116:119] offset:1024
    ds_write_b128 v3, v[120:123] offset:32768
    ds_write_b128 v3, v[124:127] offset:33792
    ds_read_b128 v[80:83], v3 offset:8192
    ds_read_b128 v[84:87], v3 offset:9216
    ds_read_b128 v[88:91], v3 offset:10240
    ds_read_b128 v[92:95], v3 offset:11264
    ds_read_b128 v[96:99], v3 offset:12288
    v_mov_b64 v[24:25], 0
    ds_read_b128 v[100:103], v3 offset:13312
    v_mov_b64 v[26:27], 0
    ds_read_b128 v[104:107], v3 offset:14336
    v_mov_b64 v[28:29], 0
    ds_read_b128 v[108:111], v3 offset:15360
    v_mov_b64 v[30:31], 0
L_ch_S0_b1:
    s_barrier
    buffer_load_dwordx4 v[112:115], v2, s[4:7], s18 offen offset:0 sc1
    buffer_store_dwordx4 v[20:23], v2, s[4:7], s20 offen sc1
    buffer_store_dwordx4 v[12:15], v2, s[4:7], s25 offen offset:0 sc1
    s_add_u32 s20, s20, 4096
    s_cmp_lg_u32 s16, 63
    s_cbranch_scc1 L_ch_S0
    s_branch L_ch_fin
L_ch_S0_w:
    s_cmp_eq_u32 s15, 1
    s_cbranch_scc1 L_ch_S0_fb
    s_cmp_lg_u32 s15, 3
    s_cbranch_scc1 L_ch_S0_w3
    buffer_store_dwordx2 v[12:13], v10, s[4:7], s34 offen sc1
L_ch_S0_w3:
    s_barrier
    v_add_u32 v0, s37, v2
    s_waitcnt vmcnt(5)
    ds_write_b128 v0, v[112:115] offset:0
    ds_write_b128 v0, v[116:119] offset:1024
    ds_write_b128 v3, v[120:123] offset:32768
    ds_write_b128 v3, v[124:127] offset:33792
    ds_read_b128 v[64:67], v3 offset:0
    ds_read_b128 v[68:71], v3 offset:1024
    ds_read_b128 v[72:75], v3 offset:2048
    ds_read_b128 v[76:79], v3 offset:3072
    ds_read_b128 v[32:35], v3 offset:4096
    ds_read_b128 v[36:39], v3 offset:5120
    ds_read_b128 v[40:43], v3 offset:6144
    ds_read_b128 v[44:47], v3 offset:7168
    ds_read_b128 v[80:83], v3 offset:8192
    ds_read_b128 v[84:87], v3 offset:9216
    ds_read_b128 v[88:91], v3 offset:10240
    ds_read_b128 v[92:95], v3 offset:11264
    ds_read_b128 v[96:99], v3 offset:12288
    v_mov_b64 v[24:25], 0
    ds_read_b128 v[100:103], v3 offset:13312
    v_mov_b64 v[26:27], 0
    ds_read_b128 v[104:107], v3 offset:14336
    v_mov_b64 v[28:29], 0
    ds_read_b128 v[108:111], v3 offset:15360
    v_mov_b64 v[30:31], 0
    s_branch L_ch_S0_b1
L_ch_S0_fb:
    ds_read_b128 v[64:67], v3 offset:0
    ds_read_b128 v[68:71], v3 offset:1024
    ds_read_b128 v[72:75], v3 offset:2048
    ds_read_b128 v[76:79], v3 offset:3072
    ds_read_b128 v[32:35], v3 offset:4096
    ds_read_b128 v[36:39], v3 offset:5120
    ds_read_b128 v[40:43], v3 offset:6144
    ds_read_b128 v[44:47], v3 offset:7168
    ds_read_b128 v[80:83], v3 offset:8192
    ds_read_b128 v[84:87], v3 offset:9216
    ds_read_b128 v[88:91], v3 offset:10240
    ds_read_b128 v[92:95], v3 offset:11264
    ds_read_b128 v[96:99], v3 offset:12288
    v_mov_b64 v[24:25], 0
    ds_read_b128 v[100:103], v3 offset:13312
    v_mov_b64 v[26:27], 0
    ds_read_b128 v[104:107], v3 offset:14336
    v_mov_b64 v[28:29], 0
    ds_read_b128 v[108:111], v3 offset:15360
    v_mov_b64 v[30:31], 0
    v_add_u32 v0, s37, v2
    s_waitcnt vmcnt(5)
    ds_write_b128 v0, v[112:115] offset:0
    ds_write_b128 v0, v[116:119] offset:1024
    ds_write_b128 v3, v[120:123] offset:32768
    ds_write_b128 v3, v[124:127] offset:33792
    v_lshrrev_b32 v0, 2, v2
    v_and_b32 v0, 4, v0
    s_add_u32 s45, s16, 1
    s_min_u32 s45, s45, 63
    s_lshl_b32 s45, s45, 2
L_ch_S0_kbc:
    v_lshl_add_u32 v11, v11, 3, v0
    v_cmp_ge_u32 vcc, s45, v11
    s_cbranch_vccnz L_ch_S0_kbw
L_ch_S0_kbx:
    v_mov_b32 v48, v0
    v_lshrrev_b32 v0, 2, v2
    v_and_b32 v0, 0x7c, v0
    s_barrier
    s_nop 3
    s_nop 3
    s_nop 3
    s_nop 3
    buffer_load_dword v16, v0, s[4:7], s99 offen sc1
    s_nop 7
    buffer_load_dword v16, v0, s[4:7], s99 offen sc1
    s_nop 7
    buffer_load_dword v16, v0, s[4:7], s99 offen sc1
    s_nop 7
    buffer_load_dword v16, v0, s[4:7], s99 offen sc1
    s_nop 7
    buffer_load_dword v16, v0, s[4:7], s99 offen sc1
    s_nop 7
L_ch_S0_fb2:
    buffer_load_dword v16, v0, s[4:7], s99 offen sc1
    s_waitcnt vmcnt(5)
    v_cmp_gt_u32 vcc, s16, v16
    s_cbranch_vccz L_ch_S0_fb3
    buffer_load_dword v16, v0, s[4:7], s99 offen sc1
    s_waitcnt vmcnt(5)
    v_cmp_gt_u32 vcc, s16, v16
    s_cbranch_vccz L_ch_S0_fb3
    buffer_load_dword v16, v0, s[4:7], s99 offen sc1
    s_waitcnt vmcnt(5)
    v_cmp_gt_u32 vcc, s16, v16
    s_cbranch_vccz L_ch_S0_fb3
    buffer_load_dword v16, v0, s[4:7], s99 offen sc1
    s_waitcnt vmcnt(5)
    v_cmp_gt_u32 vcc, s16, v16
    s_cbranch_vccz L_ch_S0_fb3
    buffer_load_dword v16, v0, s[4:7], s99 offen sc1
    s_waitcnt vmcnt(5)
    v_cmp_gt_u32 vcc, s16, v16
    s_cbranch_vccz L_ch_S0_fb3
    buffer_load_dword v16, v0, s[4:7], s99 offen sc1
    s_waitcnt vmcnt(5)
    v_cmp_gt_u32 vcc, s16, v16
    s_cbranch_vccz L_ch_S0_fb3
    buffer_load_dword v16, v0, s[4:7], s99 offen sc1
    s_waitcnt vmcnt(5)
    v_cmp_gt_u32 vcc, s16, v16
    s_cbranch_vccz L_ch_S0_fb3
    buffer_load_dword v16, v0, s[4:7], s99 offen sc1
    s_waitcnt vmcnt(5)
    v_cmp_gt_u32 vcc, s16, v16
    s_cbranch_vccz L_ch_S0_fb3
    s_add_u32 s96, s96, 1
    s_cmp_gt_u32 s96, 0x200000
    s_cbranch_scc0 L_ch_S0_fb2
L_ch_S0_fb3:
    buffer_load_dwordx4 v10, s[4:7], s31 offen offset:0 sc1 lds
    buffer_load_dwordx4 v10, s[4:7], s31 offen offset:1024 sc1 lds
    buffer_load_dwordx4 v10, s[4:7], s31 offen offset:2048 sc1 lds
    buffer_load_dwordx4 v10, s[4:7], s31 offen offset:3072 sc1 lds
    s_mov_b32 m0, 4096
    s_nop 3
    s_nop 3
    s_nop 0
    buffer_load_dwordx4 v10, s[4:7], s28 offen offset:0 sc1 lds
    buffer_load_dwordx4 v10, s[4:7], s28 offen offset:1024 sc1 lds
    buffer_load_dwordx4 v10, s[4:7], s28 offen offset:2048 sc1 lds
    buffer_load_dwordx4 v10, s[4:7], s28 offen offset:3072 sc1 lds
    s_barrier
    buffer_load_dwordx4 v[112:115], v2, s[4:7], s18 offen offset:0 sc1
    buffer_store_dwordx4 v[20:23], v2, s[4:7], s20 offen sc1
    buffer_store_dwordx4 v[12:15], v2, s[4:7], s25 offen offset:0 sc1
    buffer_load_dword v11, v48, s[4:7], s38 offen sc1
    s_add_u32 s20, s20, 4096
    s_cmp_lg_u32 s16, 63
    s_cbranch_scc1 L_ch_S0
    s_branch L_ch_fin
L_ch_S0_kbw:
    s_add_u32 s96, s96, 1
    s_cmp_gt_u32 s96, 0x200000
    s_cbranch_scc1 L_ch_S0_kbx
    buffer_load_dword v11, v0, s[4:7], s38 offen sc1
    s_waitcnt vmcnt(0)
    s_branch L_ch_S0_kbc
L_ch_S0_e:
    s_nop 3
    s_nop 3
    s_nop 3
    s_nop 3
    buffer_load_dwordx4 v[80:83], v2, s[4:7], s23 offen offset:0 sc1
    buffer_load_dwordx4 v[84:87], v2, s[4:7], s23 offen offset:1024 sc1
    buffer_load_dwordx4 v[88:91], v2, s[4:7], s23 offen offset:2048 sc1
    buffer_load_dwordx4 v[92:95], v2, s[4:7], s23 offen offset:3072 sc1
    buffer_load_dwordx4 v[96:99], v2, s[4:7], s24 offen offset:0 sc1
    buffer_load_dwordx4 v[100:103], v2, s[4:7], s24 offen offset:1024 sc1
    buffer_load_dwordx4 v[104:107], v2, s[4:7], s24 offen offset:2048 sc1
    buffer_load_dwordx4 v[108:111], v2, s[4:7], s24 offen offset:3072 sc1
    ds_read_b128 v[64:67], v3 offset:0
    ds_read_b128 v[68:71], v3 offset:1024
    ds_read_b128 v[72:75], v3 offset:2048
    ds_read_b128 v[76:79], v3 offset:3072
    ds_read_b128 v[32:35], v3 offset:4096
    ds_read_b128 v[36:39], v3 offset:5120
    ds_read_b128 v[40:43], v3 offset:6144
    ds_read_b128 v[44:47], v3 offset:7168
    v_mov_b64 v[24:25], 0
    v_mov_b64 v[26:27], 0
    s_waitcnt lgkmcnt(8)
    s_branch L_ch_S0_cl
L_ch_S0_cb:
    s_mov_b64 exec, -1
L_ch_S0_cl:
    s_waitcnt vmcnt(6)
    v_cmp_u_f32 vcc, v80, v84
    s_mov_b64 exec, s[50:51]
    s_cbranch_vccz L_ch_S0_cbx
L_ch_S0_r0:
    s_mov_b64 exec, -1
    s_add_u32 s36, s36, 0
L_ch_S0_r0l:
    buffer_load_dwordx4 v[80:83], v2, s[4:7], s23 offen offset:0 sc1
    buffer_load_dwordx4 v[84:87], v2, s[4:7], s23 offen offset:1024 sc1
    buffer_load_dwordx4 v[88:91], v2, s[4:7], s23 offen offset:2048 sc1
    buffer_load_dwordx4 v[92:95], v2, s[4:7], s23 offen offset:3072 sc1
    buffer_load_dwordx4 v[96:99], v2, s[4:7], s24 offen offset:0 sc1
    buffer_load_dwordx4 v[100:103], v2, s[4:7], s24 offen offset:1024 sc1
    buffer_load_dwordx4 v[104:107], v2, s[4:7], s24 offen offset:2048 sc1
    buffer_load_dwordx4 v[108:111], v2, s[4:7], s24 offen offset:3072 sc1
    s_add_u32 s36, s36, 1
    s_cmp_gt_u32 s36, 0x200000
    s_cbranch_scc1 L_ch_S0_r0g
    s_waitcnt vmcnt(6)
    v_cmp_u_f32 vcc, v80, v84
    s_cbranch_vccnz L_ch_S0_r0l
L_ch_S0_r0g:
    v_mov_b64 v[24:25], 0
    v_mov_b64 v[26:27], 0
    s_nop 0
    s_waitcnt vmcnt(6)
    v_smfmac_f32_16x16x64_bf16 v[24:27], v[28:31], v[80:87], v1
    s_waitcnt vmcnt(4)
    v_smfmac_f32_16x16x64_bf16 v[24:27], v[28:31], v[88:95], v1
    s_waitcnt vmcnt(2)
    v_smfmac_f32_16x16x64_bf16 v[24:27], v[28:31], v[96:103], v1
    s_waitcnt vmcnt(0)
    v_smfmac_f32_16x16x64_bf16 v[24:27], v[28:31], v[104:111], v1
    s_nop 7
    v_cmp_u_f32 vcc, v24, v25
    v_cvt_pk_bf16_f32 v48, v24, v25
    v_cvt_pk_bf16_f32 v49, v26, v27
    s_cbranch_scc1 L_ch_S0_r0e
    s_cbranch_vccnz L_ch_S0_r0l
L_ch_S0_r0e:
    buffer_store_dwordx2 v[48:49], v10, s[4:7], s33 offen sc1
    s_mov_b64 exec, s[50:51]
    buffer_store_dword v50, v2, s[4:7], s98 offen sc1
    s_mov_b64 exec, -1
    s_barrier
    s_branch L_ch_S0_p1ok
L_ch_S0_r1:
    v_add_u32 v50, -1, v50
    s_mov_b64 exec, s[50:51]
    buffer_store_dword v50, v2, s[4:7], s98 offen sc1
    s_mov_b64 exec, -1
    v_add_u32 v50, 1, v50
    s_add_u32 s36, s36, 255
L_ch_S0_r1l:
    buffer_load_dwordx4 v[80:83], v2, s[4:7], s23 offen offset:0 sc1
    buffer_load_dwordx4 v[84:87], v2, s[4:7], s23 offen offset:1024 sc1
    buffer_load_dwordx4 v[88:91], v2, s[4:7], s23 offen offset:2048 sc1
    buffer_load_dwordx4 v[92:95], v2, s[4:7], s23 offen offset:3072 sc1
    buffer_load_dwordx4 v[96:99], v2, s[4:7], s24 offen offset:0 sc1
    buffer_load_dwordx4 v[100:103], v2, s[4:7], s24 offen offset:1024 sc1
    buffer_load_dwordx4 v[104:107], v2, s[4:7], s24 offen offset:2048 sc1
    buffer_load_dwordx4 v[108:111], v2, s[4:7], s24 offen offset:3072 sc1
    s_add_u32 s36, s36, 1
    s_cmp_gt_u32 s36, 0x200000
    s_cbranch_scc1 L_ch_S0_r1g
    s_waitcnt vmcnt(6)
    v_cmp_u_f32 vcc, v80, v84
    s_cbranch_vccnz L_ch_S0_r1l
L_ch_S0_r1g:
    v_mov_b64 v[24:25], 0
    v_mov_b64 v[26:27], 0
    s_nop 0
    s_waitcnt vmcnt(6)
    v_smfmac_f32_16x16x64_bf16 v[24:27], v[28:31], v[80:87], v1
    s_waitcnt vmcnt(4)
    v_smfmac_f32_16x16x64_bf16 v[24:27], v[28:31], v[88:95], v1
    s_waitcnt vmcnt(2)
    v_smfmac_f32_16x16x64_bf16 v[24:27], v[28:31], v[96:103], v1
    s_waitcnt vmcnt(0)
    v_smfmac_f32_16x16x64_bf16 v[24:27], v[28:31], v[104:111], v1
    s_nop 7
    v_cmp_u_f32 vcc, v24, v25
    v_cvt_pk_bf16_f32 v48, v24, v25
    v_cvt_pk_bf16_f32 v49, v26, v27
    s_cbranch_scc1 L_ch_S0_r1e
    s_cbranch_vccnz L_ch_S0_r1l
L_ch_S0_r1e:
    buffer_store_dwordx2 v[48:49], v10, s[4:7], s33 offen sc1
    s_mov_b64 exec, s[50:51]
    buffer_store_dword v50, v2, s[4:7], s98 offen sc1
    s_mov_b64 exec, -1
    s_branch L_ch_S0_p1ok
L_ch_S0_r2:
    s_add_u32 s29, s29, 1
    s_cmp_gt_u32 s29, 0x200000
    s_cbranch_scc1 L_ch_S0_r2x
    s_cmp_eq_u32 s16, 0
    s_cbranch_scc1 L_ch_S0_r2x
    s_mov_b32 m0, 0
    s_cmp_lg_u32 s15, 1
    s_waitcnt lgkmcnt(0)
    s_barrier
    s_cbranch_scc1 L_ch_S0_r2b
    buffer_load_dwordx4 v10, s[4:7], s31 offen offset:0 sc1 lds
    buffer_load_dwordx4 v10, s[4:7], s31 offen offset:1024 sc1 lds
    buffer_load_dwordx4 v10, s[4:7], s31 offen offset:2048 sc1 lds
    buffer_load_dwordx4 v10, s[4:7], s31 offen offset:3072 sc1 lds
    s_mov_b32 m0, 4096
    s_nop 0
    buffer_load_dwordx4 v10, s[4:7], s28 offen offset:0 sc1 lds
    buffer_load_dwordx4 v10, s[4:7], s28 offen offset:1024 sc1 lds
    buffer_load_dwordx4 v10, s[4:7], s28 offen offset:2048 sc1 lds
    buffer_load_dwordx4 v10, s[4:7], s28 offen offset:3072 sc1 lds
L_ch_S0_r2b:
    s_nop 7
    v_mov_b64 v[12:13], -1
    v_mov_b64 v[14:15], -1
    ds_read_b128 v[64:67], v3 offset:0
    ds_read_b128 v[68:71], v3 offset:1024
    ds_read_b128 v[72:75], v3 offset:2048
    ds_read_b128 v[76:79], v3 offset:3072
    ds_read_b128 v[32:35], v3 offset:4096
    ds_read_b128 v[36:39], v3 offset:5120
    ds_read_b128 v[40:43], v3 offset:6144
    ds_read_b128 v[44:47], v3 offset:7168
    ds_read_b128 v[80:83], v3 offset:8192
    ds_read_b128 v[84:87], v3 offset:9216
    ds_read_b128 v[88:91], v3 offset:10240
    ds_read_b128 v[92:95], v3 offset:11264
    ds_read_b128 v[96:99], v3 offset:12288
    ds_read_b128 v[100:103], v3 offset:13312
    ds_read_b128 v[104:107], v3 offset:14336
    ds_read_b128 v[108:111], v3 offset:15360
    v_mov_b64 v[24:25], 0
    v_mov_b64 v[26:27], 0
    v_mov_b64 v[28:29], 0
    v_mov_b64 v[30:31], 0
    s_waitcnt vmcnt(0) lgkmcnt(0)
    s_barrier
    ds_read_b128 v[48:51], v2 offset:0
    ds_read_b128 v[52:55], v2 offset:1024
    ds_read_b128 v[56:59], v2 offset:2048
    ds_read_b128 v[60:63], v2 offset:3072
    s_branch L_ch_S0_re
L_ch_fin:
    s_waitcnt lgkmcnt(0)
    v_mov_b64 v[32:33], 0
    v_mov_b64 v[34:35], 0
    v_mov_b64 v[36:37], 0
    v_mov_b64 v[38:39], 0
    v_mov_b64 v[40:41], 0
    v_mov_b64 v[42:43], 0
    v_mov_b64 v[44:45], 0
    v_mov_b64 v[46:47], 0
    s_waitcnt vmcnt(4) lgkmcnt(0)
    s_barrier
L_ch_fin2:
    ds_read_b128 v[48:51], v2 offset:0
    ds_read_b128 v[52:55], v2 offset:1024
    ds_read_b128 v[56:59], v2 offset:2048
    ds_read_b128 v[60:63], v2 offset:3072
    ds_read_b128 v[64:67], v2 offset:4096
    ds_read_b128 v[68:71], v2 offset:5120
    ds_read_b128 v[72:75], v2 offset:6144
    ds_read_b128 v[76:79], v2 offset:7168
    s_waitcnt lgkmcnt(7)
    v_smfmac_f32_16x16x64_bf16 v[32:35], v[48:51], a[64:71], v1
    v_smfmac_f32_16x16x64_bf16 v[36:39], v[48:51], a[72:79], v1
    v_smfmac_f32_16x16x64_bf16 v[40:43], v[48:51], a[192:199], v1
    v_smfmac_f32_16x16x64_bf16 v[44:47], v[48:51], a[200:207], v1
    s_waitcnt lgkmcnt(6)
    v_smfmac_f32_16x16x64_bf16 v[32:35], v[52:55], a[80:87], v1
    v_smfmac_f32_16x16x64_bf16 v[36:39], v[52:55], a[88:95], v1
    v_smfmac_f32_16x16x64_bf16 v[40:43], v[52:55], a[208:215], v1
    v_smfmac_f32_16x16x64_bf16 v[44:47], v[52:55], a[216:223], v1
    s_waitcnt lgkmcnt(5)
    v_smfmac_f32_16x16x64_bf16 v[32:35], v[56:59], a[96:103], v1
    v_smfmac_f32_16x16x64_bf16 v[36:39], v[56:59], a[104:111], v1
    v_smfmac_f32_16x16x64_bf16 v[40:43], v[56:59], a[224:231], v1
    v_smfmac_f32_16x16x64_bf16 v[44:47], v[56:59], a[232:239], v1
    s_waitcnt lgkmcnt(4)
    v_smfmac_f32_16x16x64_bf16 v[32:35], v[60:63], a[112:119], v1
    v_smfmac_f32_16x16x64_bf16 v[36:39], v[60:63], a[120:127], v1
    v_smfmac_f32_16x16x64_bf16 v[40:43], v[60:63], a[240:247], v1
    v_smfmac_f32_16x16x64_bf16 v[44:47], v[60:63], a[248:255], v1
    s_waitcnt lgkmcnt(3)
    v_smfmac_f32_16x16x64_bf16 v[32:35], v[64:67], a[128:135], v1
    v_smfmac_f32_16x16x64_bf16 v[36:39], v[64:67], a[136:143], v1
    v_smfmac_f32_16x16x64_bf16 v[40:43], v[64:67], v[128:135], v1
    v_smfmac_f32_16x16x64_bf16 v[44:47], v[64:67], v[136:143], v1
    s_waitcnt lgkmcnt(2)
    v_smfmac_f32_16x16x64_bf16 v[32:35], v[68:71], a[144:151], v1
    v_smfmac_f32_16x16x64_bf16 v[36:39], v[68:71], a[152:159], v1
    v_smfmac_f32_16x16x64_bf16 v[40:43], v[68:71], v[144:151], v1
    v_smfmac_f32_16x16x64_bf16 v[44:47], v[68:71], v[152:159], v1
    s_waitcnt lgkmcnt(1)
    v_smfmac_f32_16x16x64_bf16 v[32:35], v[72:75], a[160:167], v1
    v_smfmac_f32_16x16x64_bf16 v[36:39], v[72:75], a[168:175], v1
    v_smfmac_f32_16x16x64_bf16 v[40:43], v[72:75], v[160:167], v1
    v_smfmac_f32_16x16x64_bf16 v[44:47], v[72:75], v[168:175], v1
    s_waitcnt lgkmcnt(0)
    v_smfmac_f32_16x16x64_bf16 v[32:35], v[76:79], a[176:183], v1
    v_smfmac_f32_16x16x64_bf16 v[36:39], v[76:79], a[184:191], v1
    v_smfmac_f32_16x16x64_bf16 v[40:43], v[76:79], v[176:183], v1
    v_smfmac_f32_16x16x64_bf16 v[44:47], v[76:79], v[184:191], v1
    s_nop 4
    v_add_f32 v32, v32, v33
    v_add_f32 v34, v34, v35
    v_add_f32 v36, v36, v37
    v_add_f32 v38, v38, v39
    v_add_f32 v40, v40, v41
    v_add_f32 v42, v42, v43
    v_add_f32 v44, v44, v45
    v_add_f32 v46, v46, v47
    v_cmp_u_f32 vcc, v32, v34
    v_cvt_pk_bf16_f32 v21, v32, v36
    v_cvt_pk_bf16_f32 v23, v34, v38
    v_cvt_pk_bf16_f32 v20, v40, v42
    v_cvt_pk_bf16_f32 v22, v44, v46
    s_cbranch_vccz L_ch_last
    s_add_u32 s29, s29, 1
    s_cmp_gt_u32 s29, 0x200000
    s_cbranch_scc1 L_ch_last
    s_mov_b32 m0, 0
    s_cmp_lg_u32 s15, 1
    s_barrier
    s_cbranch_scc1 L_ch_fin3
    buffer_load_dwordx4 v10, s[4:7], s31 offen offset:0 sc1 lds
    buffer_load_dwordx4 v10, s[4:7], s31 offen offset:1024 sc1 lds
    buffer_load_dwordx4 v10, s[4:7], s31 offen offset:2048 sc1 lds
    buffer_load_dwordx4 v10, s[4:7], s31 offen offset:3072 sc1 lds
    s_mov_b32 m0, 4096
    s_nop 0
    buffer_load_dwordx4 v10, s[4:7], s28 offen offset:0 sc1 lds
    buffer_load_dwordx4 v10, s[4:7], s28 offen offset:1024 sc1 lds
    buffer_load_dwordx4 v10, s[4:7], s28 offen offset:2048 sc1 lds
    buffer_load_dwordx4 v10, s[4:7], s28 offen offset:3072 sc1 lds
L_ch_fin3:
    v_mov_b64 v[32:33], 0
    v_mov_b64 v[34:35], 0
    v_mov_b64 v[36:37], 0
    v_mov_b64 v[38:39], 0
    v_mov_b64 v[40:41], 0
    v_mov_b64 v[42:43], 0
    v_mov_b64 v[44:45], 0
    v_mov_b64 v[46:47], 0
    s_waitcnt vmcnt(0)
    s_barrier
    s_branch L_ch_fin2
L_ch_last:
    buffer_store_dwordx4 v[20:23], v2, s[4:7], s20 offen sc1
L_exit:
    s_endpgm
L_restart:
    s_waitcnt vmcnt(0) lgkmcnt(0)
    s_barrier
    s_lshl_b32 s3, s15, 6
    v_mbcnt_lo_u32_b32 v0, -1, 0
    v_mbcnt_hi_u32_b32 v0, -1, v0
    v_add_u32 v0, s3, v0
    s_branch L_disp
L_bulk:
    s_lshl_b32 s3, s3, 2
    s_lshr_b32 s3, 0x36125040, s3
    s_and_b32 s3, s3, 15
    s_lshl_b32 s3, s3, 5
    s_lshr_b32 s14, s2, 3
    s_add_u32 s14, s14, s3
    s_lshr_b32 s21, s14, 1
    s_and_b32 s22, s14, 1
    s_sub_u32 s39, s14, 64
    s_load_dwordx16 s[52:67], s[0:1], 0
    s_load_dwordx8 s[68:75], s[0:1], 64
    s_load_dwordx2 s[76:77], s[0:1], 96
    s_load_dwordx2 s[12:13], s[0:1], 104
    s_load_dwordx2 s[4:5], s[0:1], 112
    v_lshrrev_b32 v1, 6, v0
    v_and_b32 v0, 63, v0
    v_readfirstlane_b32 s15, v1
    s_mov_b32 s6, 268435456
    s_mov_b32 s7, 0x20000
    s_mov_b32 s11, 0x20000
    s_mov_b32 s16, 0xffff0000
    s_mov_b32 s17, 0
    v_and_b32 v1, 15, v0
    v_lshrrev_b32 v2, 4, v0
    v_lshlrev_b32 v3, 4, v0
    s_waitcnt lgkmcnt(0)
    s_cmp_ge_u32 s14, 64
    s_cbranch_scc1 L_grp
    v_lshlrev_b32 v120, 1, v2
    v_xor_b32 v120, v120, v1
    v_lshlrev_b32 v120, 4, v120
    v_lshl_add_u32 v112, v2, 13, v120
    s_lshr_b32 s40, s15, 1
    s_lshl_b32 s40, s40, 18
    s_and_b32 s41, s15, 1
    s_lshl_b32 s41, s41, 15
    s_add_u32 s40, s40, s41
    s_lshl_b32 s41, s21, 8
    s_add_u32 s40, s40, s41
    v_add_u32 v112, s40, v112
    v_xor_b32 v113, 128, v112
    s_lshl_b32 s24, s15, 12
    s_add_u32 s24, s24, 32768
    v_lshrrev_b32 v118, 2, v1
    v_and_b32 v119, 3, v1
    v_and_b32 v120, 1, v2
    v_lshl_add_u32 v120, v120, 2, v118
    s_lshl_b32 s40, s15, 1
    v_xor_b32 v120, s40, v120
    v_lshlrev_b32 v114, 10, v2
    v_lshl_add_u32 v114, v118, 8, v114
    v_lshl_add_u32 v114, v120, 5, v114
    v_lshl_add_u32 v114, v119, 3, v114
    v_add_u32 v114, 32768, v114
    v_xor_b32 v115, 32, v114
    v_add_u32 v116, 65536, v114
    v_add_u32 v117, 65536, v115
    s_mov_b32 s32, s22
    s_mov_b32 s27, 0
    s_mov_b32 s33, 0
    v_lshlrev_b32 v7, 3, v0
    v_mov_b32 v9, 136
    s_mov_b32 s8, s58
    s_mov_b32 s9, s59
    s_mov_b32 s10, 4194304
    s_add_u32 m0, s24, 0
    s_mov_b32 s47, 0
    buffer_load_dwordx4 v112, s[8:11], s47 offen lds
    s_add_u32 m0, s24, 1024
    s_mov_b32 s47, 65536
    buffer_load_dwordx4 v113, s[8:11], s47 offen lds
    s_add_u32 m0, s24, 2048
    s_mov_b32 s47, 131072
    buffer_load_dwordx4 v112, s[8:11], s47 offen lds
    s_add_u32 m0, s24, 3072
    s_mov_b32 s47, 196608
    buffer_load_dwordx4 v113, s[8:11], s47 offen lds
    s_mov_b32 s8, s58
    s_mov_b32 s9, s59
    s_mov_b32 s10, 4194304
    s_add_u32 m0, s24, 16384
    s_mov_b32 s47, 524288
    buffer_load_dwordx4 v112, s[8:11], s47 offen lds
    s_add_u32 m0, s24, 17408
    s_mov_b32 s47, 589824
    buffer_load_dwordx4 v113, s[8:11], s47 offen lds
    s_add_u32 m0, s24, 18432
    s_mov_b32 s47, 655360
    buffer_load_dwordx4 v112, s[8:11], s47 offen lds
    s_add_u32 m0, s24, 19456
    s_mov_b32 s47, 720896
    buffer_load_dwordx4 v113, s[8:11], s47 offen lds
    s_mov_b32 s8, s58
    s_mov_b32 s9, s59
    s_mov_b32 s10, 4194304
    s_add_u32 m0, s24, 32768
    s_mov_b32 s47, 1048576
    buffer_load_dwordx4 v112, s[8:11], s47 offen lds
    s_add_u32 m0, s24, 33792
    s_mov_b32 s47, 1114112
    buffer_load_dwordx4 v113, s[8:11], s47 offen lds
    s_add_u32 m0, s24, 34816
    s_mov_b32 s47, 1179648
    buffer_load_dwordx4 v112, s[8:11], s47 offen lds
    s_add_u32 m0, s24, 35840
    s_mov_b32 s47, 1245184
    buffer_load_dwordx4 v113, s[8:11], s47 offen lds
    s_mov_b32 s8, s58
    s_mov_b32 s9, s59
    s_mov_b32 s10, 4194304
    s_add_u32 m0, s24, 49152
    s_mov_b32 s47, 1572864
    buffer_load_dwordx4 v112, s[8:11], s47 offen lds
    s_add_u32 m0, s24, 50176
    s_mov_b32 s47, 1638400
    buffer_load_dwordx4 v113, s[8:11], s47 offen lds
    s_add_u32 m0, s24, 51200
    s_mov_b32 s47, 1703936
    buffer_load_dwordx4 v112, s[8:11], s47 offen lds
    s_add_u32 m0, s24, 52224
    s_mov_b32 s47, 1769472
    buffer_load_dwordx4 v113, s[8:11], s47 offen lds
    s_mov_b32 s8, s58
    s_mov_b32 s9, s59
    s_mov_b32 s10, 4194304
    s_add_u32 m0, s24, 65536
    s_mov_b32 s47, 2097152
    buffer_load_dwordx4 v112, s[8:11], s47 offen lds
    s_add_u32 m0, s24, 66560
    s_mov_b32 s47, 2162688
    buffer_load_dwordx4 v113, s[8:11], s47 offen lds
    s_add_u32 m0, s24, 67584
    s_mov_b32 s47, 2228224
    buffer_load_dwordx4 v112, s[8:11], s47 offen lds
    s_add_u32 m0, s24, 68608
    s_mov_b32 s47, 2293760
    buffer_load_dwordx4 v113, s[8:11], s47 offen lds
    s_mov_b32 s8, s58
    s_mov_b32 s9, s59
    s_mov_b32 s10, 4194304
    s_add_u32 m0, s24, 81920
    s_mov_b32 s47, 2621440
    buffer_load_dwordx4 v112, s[8:11], s47 offen lds
    s_add_u32 m0, s24, 82944
    s_mov_b32 s47, 2686976
    buffer_load_dwordx4 v113, s[8:11], s47 offen lds
    s_add_u32 m0, s24, 83968
    s_mov_b32 s47, 2752512
    buffer_load_dwordx4 v112, s[8:11], s47 offen lds
    s_add_u32 m0, s24, 84992
    s_mov_b32 s47, 2818048
    buffer_load_dwordx4 v113, s[8:11], s47 offen lds
    s_mov_b32 s8, s58
    s_mov_b32 s9, s59
    s_mov_b32 s10, 4194304
    s_add_u32 m0, s24, 98304
    s_mov_b32 s47, 3145728
    buffer_load_dwordx4 v112, s[8:11], s47 offen lds
    s_add_u32 m0, s24, 99328
    s_mov_b32 s47, 3211264
    buffer_load_dwordx4 v113, s[8:11], s47 offen lds
    s_add_u32 m0, s24, 100352
    s_mov_b32 s47, 3276800
    buffer_load_dwordx4 v112, s[8:11], s47 offen lds
    s_add_u32 m0, s24, 101376
    s_mov_b32 s47, 3342336
    buffer_load_dwordx4 v113, s[8:11], s47 offen lds
    s_waitcnt vmcnt(24)
    s_barrier
    s_mov_b32 s8, s58
    s_mov_b32 s9, s59
    s_mov_b32 s10, 4194304
    s_add_u32 m0, s24, 114688
    s_mov_b32 s47, 3670016
    buffer_load_dwordx4 v112, s[8:11], s47 offen lds
    s_add_u32 m0, s24, 115712
    s_mov_b32 s47, 3735552
    buffer_load_dwordx4 v113, s[8:11], s47 offen lds
    s_add_u32 m0, s24, 116736
    s_mov_b32 s47, 3801088
    buffer_load_dwordx4 v112, s[8:11], s47 offen lds
    s_add_u32 m0, s24, 117760
    s_mov_b32 s47, 3866624
    buffer_load_dwordx4 v113, s[8:11], s47 offen lds
    ds_read_b64_tr_b16 a[0:1], v114 offset:0
    ds_read_b64_tr_b16 a[64:65], v115 offset:0
    ds_read_b64_tr_b16 a[2:3], v114 offset:4096
    ds_read_b64_tr_b16 a[66:67], v115 offset:4096
    ds_read_b64_tr_b16 a[4:5], v114 offset:8192
    ds_read_b64_tr_b16 a[68:69], v115 offset:8192
    ds_read_b64_tr_b16 a[6:7], v114 offset:12288
    ds_read_b64_tr_b16 a[70:71], v115 offset:12288
    s_waitcnt lgkmcnt(0)
    s_waitcnt vmcnt(24)
    s_barrier
    s_mov_b32 s8, s60
    s_mov_b32 s9, s61
    s_mov_b32 s10, 4194304
    s_add_u32 m0, s24, 0
    s_mov_b32 s47, 0
    buffer_load_dwordx4 v112, s[8:11], s47 offen lds
    s_add_u32 m0, s24, 1024
    s_mov_b32 s47, 65536
    buffer_load_dwordx4 v113, s[8:11], s47 offen lds
    s_add_u32 m0, s24, 2048
    s_mov_b32 s47, 131072
    buffer_load_dwordx4 v112, s[8:11], s47 offen lds
    s_add_u32 m0, s24, 3072
    s_mov_b32 s47, 196608
    buffer_load_dwordx4 v113, s[8:11], s47 offen lds
    ds_read_b64_tr_b16 a[8:9], v114 offset:16384
    ds_read_b64_tr_b16 a[72:73], v115 offset:16384
    ds_read_b64_tr_b16 a[10:11], v114 offset:20480
    ds_read_b64_tr_b16 a[74:75], v115 offset:20480
    ds_read_b64_tr_b16 a[12:13], v114 offset:24576
    ds_read_b64_tr_b16 a[76:77], v115 offset:24576
    ds_read_b64_tr_b16 a[14:15], v114 offset:28672
    ds_read_b64_tr_b16 a[78:79], v115 offset:28672
    s_waitcnt lgkmcnt(0)
    s_waitcnt vmcnt(24)
    s_barrier
    s_mov_b32 s8, s60
    s_mov_b32 s9, s61
    s_mov_b32 s10, 4194304
    s_add_u32 m0, s24, 16384
    s_mov_b32 s47, 524288
    buffer_load_dwordx4 v112, s[8:11], s47 offen lds
    s_add_u32 m0, s24, 17408
    s_mov_b32 s47, 589824
    buffer_load_dwordx4 v113, s[8:11], s47 offen lds
    s_add_u32 m0, s24, 18432
    s_mov_b32 s47, 655360
    buffer_load_dwordx4 v112, s[8:11], s47 offen lds
    s_add_u32 m0, s24, 19456
    s_mov_b32 s47, 720896
    buffer_load_dwordx4 v113, s[8:11], s47 offen lds
    ds_read_b64_tr_b16 a[16:17], v114 offset:32768
    ds_read_b64_tr_b16 a[80:81], v115 offset:32768
    ds_read_b64_tr_b16 a[18:19], v114 offset:36864
    ds_read_b64_tr_b16 a[82:83], v115 offset:36864
    ds_read_b64_tr_b16 a[20:21], v114 offset:40960
    ds_read_b64_tr_b16 a[84:85], v115 offset:40960
    ds_read_b64_tr_b16 a[22:23], v114 offset:45056
    ds_read_b64_tr_b16 a[86:87], v115 offset:45056
    s_waitcnt lgkmcnt(0)
    s_waitcnt vmcnt(24)
    s_barrier
    s_mov_b32 s8, s60
    s_mov_b32 s9, s61
    s_mov_b32 s10, 4194304
    s_add_u32 m0, s24, 32768
    s_mov_b32 s47, 1048576
    buffer_load_dwordx4 v112, s[8:11], s47 offen lds
    s_add_u32 m0, s24, 33792
    s_mov_b32 s47, 1114112
    buffer_load_dwordx4 v113, s[8:11], s47 offen lds
    s_add_u32 m0, s24, 34816
    s_mov_b32 s47, 1179648
    buffer_load_dwordx4 v112, s[8:11], s47 offen lds
    s_add_u32 m0, s24, 35840
    s_mov_b32 s47, 1245184
    buffer_load_dwordx4 v113, s[8:11], s47 offen lds
    ds_read_b64_tr_b16 a[24:25], v114 offset:49152
    ds_read_b64_tr_b16 a[88:89], v115 offset:49152
    ds_read_b64_tr_b16 a[26:27], v114 offset:53248
    ds_read_b64_tr_b16 a[90:91], v115 offset:53248
    ds_read_b64_tr_b16 a[28:29], v114 offset:57344
    ds_read_b64_tr_b16 a[92:93], v115 offset:57344
    ds_read_b64_tr_b16 a[30:31], v114 offset:61440
    ds_read_b64_tr_b16 a[94:95], v115 offset:61440
    s_waitcnt lgkmcnt(0)
    s_waitcnt vmcnt(24)
    s_barrier
    s_mov_b32 s8, s60
    s_mov_b32 s9, s61
    s_mov_b32 s10, 4194304
    s_add_u32 m0, s24, 49152
    s_mov_b32 s47, 1572864
    buffer_load_dwordx4 v112, s[8:11], s47 offen lds
    s_add_u32 m0, s24, 50176
    s_mov_b32 s47, 1638400
    buffer_load_dwordx4 v113, s[8:11], s47 offen lds
    s_add_u32 m0, s24, 51200
    s_mov_b32 s47, 1703936
    buffer_load_dwordx4 v112, s[8:11], s47 offen lds
    s_add_u32 m0, s24, 52224
    s_mov_b32 s47, 1769472
    buffer_load_dwordx4 v113, s[8:11], s47 offen lds
    ds_read_b64_tr_b16 a[32:33], v116 offset:0
    ds_read_b64_tr_b16 a[96:97], v117 offset:0
    ds_read_b64_tr_b16 a[34:35], v116 offset:4096
    ds_read_b64_tr_b16 a[98:99], v117 offset:4096
    ds_read_b64_tr_b16 a[36:37], v116 offset:8192
    ds_read_b64_tr_b16 a[100:101], v117 offset:8192
    ds_read_b64_tr_b16 a[38:39], v116 offset:12288
    ds_read_b64_tr_b16 a[102:103], v117 offset:12288
    s_waitcnt lgkmcnt(0)
    s_waitcnt vmcnt(24)
    s_barrier
    s_mov_b32 s8, s60
    s_mov_b32 s9, s61
    s_mov_b32 s10, 4194304
    s_add_u32 m0, s24, 65536
    s_mov_b32 s47, 2097152
    buffer_load_dwordx4 v112, s[8:11], s47 offen lds
    s_add_u32 m0, s24, 66560
    s_mov_b32 s47, 2162688
    buffer_load_dwordx4 v113, s[8:11], s47 offen lds
    s_add_u32 m0, s24, 67584
    s_mov_b32 s47, 2228224
    buffer_load_dwordx4 v112, s[8:11], s47 offen lds
    s_add_u32 m0, s24, 68608
    s_mov_b32 s47, 2293760
    buffer_load_dwordx4 v113, s[8:11], s47 offen lds
    ds_read_b64_tr_b16 a[40:41], v116 offset:16384
    ds_read_b64_tr_b16 a[104:105], v117 offset:16384
    ds_read_b64_tr_b16 a[42:43], v116 offset:20480
    ds_read_b64_tr_b16 a[106:107], v117 offset:20480
    ds_read_b64_tr_b16 a[44:45], v116 offset:24576
    ds_read_b64_tr_b16 a[108:109], v117 offset:24576
    ds_read_b64_tr_b16 a[46:47], v116 offset:28672
    ds_read_b64_tr_b16 a[110:111], v117 offset:28672
    s_waitcnt lgkmcnt(0)
    s_waitcnt vmcnt(24)
    s_barrier
    s_mov_b32 s8, s60
    s_mov_b32 s9, s61
    s_mov_b32 s10, 4194304
    s_add_u32 m0, s24, 81920
    s_mov_b32 s47, 2621440
    buffer_load_dwordx4 v112, s[8:11], s47 offen lds
    s_add_u32 m0, s24, 82944
    s_mov_b32 s47, 2686976
    buffer_load_dwordx4 v113, s[8:11], s47 offen lds
    s_add_u32 m0, s24, 83968
    s_mov_b32 s47, 2752512
    buffer_load_dwordx4 v112, s[8:11], s47 offen lds
    s_add_u32 m0, s24, 84992
    s_mov_b32 s47, 2818048
    buffer_load_dwordx4 v113, s[8:11], s47 offen lds
    ds_read_b64_tr_b16 a[48:49], v116 offset:32768
    ds_read_b64_tr_b16 a[112:113], v117 offset:32768
    ds_read_b64_tr_b16 a[50:51], v116 offset:36864
    ds_read_b64_tr_b16 a[114:115], v117 offset:36864
    ds_read_b64_tr_b16 a[52:53], v116 offset:40960
    ds_read_b64_tr_b16 a[116:117], v117 offset:40960
    ds_read_b64_tr_b16 a[54:55], v116 offset:45056
    ds_read_b64_tr_b16 a[118:119], v117 offset:45056
    s_waitcnt lgkmcnt(0)
    s_waitcnt vmcnt(24)
    s_barrier
    s_mov_b32 s8, s60
    s_mov_b32 s9, s61
    s_mov_b32 s10, 4194304
    s_add_u32 m0, s24, 98304
    s_mov_b32 s47, 3145728
    buffer_load_dwordx4 v112, s[8:11], s47 offen lds
    s_add_u32 m0, s24, 99328
    s_mov_b32 s47, 3211264
    buffer_load_dwordx4 v113, s[8:11], s47 offen lds
    s_add_u32 m0, s24, 100352
    s_mov_b32 s47, 3276800
    buffer_load_dwordx4 v112, s[8:11], s47 offen lds
    s_add_u32 m0, s24, 101376
    s_mov_b32 s47, 3342336
    buffer_load_dwordx4 v113, s[8:11], s47 offen lds
    ds_read_b64_tr_b16 a[56:57], v116 offset:49152
    ds_read_b64_tr_b16 a[120:121], v117 offset:49152
    ds_read_b64_tr_b16 a[58:59], v116 offset:53248
    ds_read_b64_tr_b16 a[122:123], v117 offset:53248
    ds_read_b64_tr_b16 a[60:61], v116 offset:57344
    ds_read_b64_tr_b16 a[124:125], v117 offset:57344
    ds_read_b64_tr_b16 a[62:63], v116 offset:61440
    ds_read_b64_tr_b16 a[126:127], v117 offset:61440
    s_waitcnt lgkmcnt(0)
    s_waitcnt vmcnt(24)
    s_barrier
    s_mov_b32 s8, s60
    s_mov_b32 s9, s61
    s_mov_b32 s10, 4194304
    s_add_u32 m0, s24, 114688
    s_mov_b32 s47, 3670016
    buffer_load_dwordx4 v112, s[8:11], s47 offen lds
    s_add_u32 m0, s24, 115712
    s_mov_b32 s47, 3735552
    buffer_load_dwordx4 v113, s[8:11], s47 offen lds
    s_add_u32 m0, s24, 116736
    s_mov_b32 s47, 3801088
    buffer_load_dwordx4 v112, s[8:11], s47 offen lds
    s_add_u32 m0, s24, 117760
    s_mov_b32 s47, 3866624
    buffer_load_dwordx4 v113, s[8:11], s47 offen lds
    ds_read_b64_tr_b16 a[128:129], v114 offset:0
    ds_read_b64_tr_b16 a[192:193], v115 offset:0
    ds_read_b64_tr_b16 a[130:131], v114 offset:4096
    ds_read_b64_tr_b16 a[194:195], v115 offset:4096
    ds_read_b64_tr_b16 a[132:133], v114 offset:8192
    ds_read_b64_tr_b16 a[196:197], v115 offset:8192
    ds_read_b64_tr_b16 a[134:135], v114 offset:12288
    ds_read_b64_tr_b16 a[198:199], v115 offset:12288
    s_waitcnt lgkmcnt(0)
    s_waitcnt vmcnt(24)
    s_barrier
    s_mov_b32 s8, s56
    s_mov_b32 s9, s57
    s_mov_b32 s10, 4194304
    s_add_u32 m0, s24, 0
    s_mov_b32 s47, 0
    buffer_load_dwordx4 v112, s[8:11], s47 offen lds
    s_add_u32 m0, s24, 1024
    s_mov_b32 s47, 65536
    buffer_load_dwordx4 v113, s[8:11], s47 offen lds
    s_add_u32 m0, s24, 2048
    s_mov_b32 s47, 131072
    buffer_load_dwordx4 v112, s[8:11], s47 offen lds
    s_add_u32 m0, s24, 3072
    s_mov_b32 s47, 196608
    buffer_load_dwordx4 v113, s[8:11], s47 offen lds
    ds_read_b64_tr_b16 a[136:137], v114 offset:16384
    ds_read_b64_tr_b16 a[200:201], v115 offset:16384
    ds_read_b64_tr_b16 a[138:139], v114 offset:20480
    ds_read_b64_tr_b16 a[202:203], v115 offset:20480
    ds_read_b64_tr_b16 a[140:141], v114 offset:24576
    ds_read_b64_tr_b16 a[204:205], v115 offset:24576
    ds_read_b64_tr_b16 a[142:143], v114 offset:28672
    ds_read_b64_tr_b16 a[206:207], v115 offset:28672
    s_waitcnt lgkmcnt(0)
    s_waitcnt vmcnt(24)
    s_barrier
    s_mov_b32 s8, s56
    s_mov_b32 s9, s57
    s_mov_b32 s10, 4194304
    s_add_u32 m0, s24, 16384
    s_mov_b32 s47, 524288
    buffer_load_dwordx4 v112, s[8:11], s47 offen lds
    s_add_u32 m0, s24, 17408
    s_mov_b32 s47, 589824
    buffer_load_dwordx4 v113, s[8:11], s47 offen lds
    s_add_u32 m0, s24, 18432
    s_mov_b32 s47, 655360
    buffer_load_dwordx4 v112, s[8:11], s47 offen lds
    s_add_u32 m0, s24, 19456
    s_mov_b32 s47, 720896
    buffer_load_dwordx4 v113, s[8:11], s47 offen lds
    ds_read_b64_tr_b16 a[144:145], v114 offset:32768
    ds_read_b64_tr_b16 a[208:209], v115 offset:32768
    ds_read_b64_tr_b16 a[146:147], v114 offset:36864
    ds_read_b64_tr_b16 a[210:211], v115 offset:36864
    ds_read_b64_tr_b16 a[148:149], v114 offset:40960
    ds_read_b64_tr_b16 a[212:213], v115 offset:40960
    ds_read_b64_tr_b16 a[150:151], v114 offset:45056
    ds_read_b64_tr_b16 a[214:215], v115 offset:45056
    s_waitcnt lgkmcnt(0)
    s_waitcnt vmcnt(24)
    s_barrier
    s_mov_b32 s8, s56
    s_mov_b32 s9, s57
    s_mov_b32 s10, 4194304
    s_add_u32 m0, s24, 32768
    s_mov_b32 s47, 1048576
    buffer_load_dwordx4 v112, s[8:11], s47 offen lds
    s_add_u32 m0, s24, 33792
    s_mov_b32 s47, 1114112
    buffer_load_dwordx4 v113, s[8:11], s47 offen lds
    s_add_u32 m0, s24, 34816
    s_mov_b32 s47, 1179648
    buffer_load_dwordx4 v112, s[8:11], s47 offen lds
    s_add_u32 m0, s24, 35840
    s_mov_b32 s47, 1245184
    buffer_load_dwordx4 v113, s[8:11], s47 offen lds
    ds_read_b64_tr_b16 a[152:153], v114 offset:49152
    ds_read_b64_tr_b16 a[216:217], v115 offset:49152
    ds_read_b64_tr_b16 a[154:155], v114 offset:53248
    ds_read_b64_tr_b16 a[218:219], v115 offset:53248
    ds_read_b64_tr_b16 a[156:157], v114 offset:57344
    ds_read_b64_tr_b16 a[220:221], v115 offset:57344
    ds_read_b64_tr_b16 a[158:159], v114 offset:61440
    ds_read_b64_tr_b16 a[222:223], v115 offset:61440
    s_waitcnt lgkmcnt(0)
    s_waitcnt vmcnt(24)
    s_barrier
    s_mov_b32 s8, s56
    s_mov_b32 s9, s57
    s_mov_b32 s10, 4194304
    s_add_u32 m0, s24, 49152
    s_mov_b32 s47, 1572864
    buffer_load_dwordx4 v112, s[8:11], s47 offen lds
    s_add_u32 m0, s24, 50176
    s_mov_b32 s47, 1638400
    buffer_load_dwordx4 v113, s[8:11], s47 offen lds
    s_add_u32 m0, s24, 51200
    s_mov_b32 s47, 1703936
    buffer_load_dwordx4 v112, s[8:11], s47 offen lds
    s_add_u32 m0, s24, 52224
    s_mov_b32 s47, 1769472
    buffer_load_dwordx4 v113, s[8:11], s47 offen lds
    ds_read_b64_tr_b16 a[160:161], v116 offset:0
    ds_read_b64_tr_b16 a[224:225], v117 offset:0
    ds_read_b64_tr_b16 a[162:163], v116 offset:4096
    ds_read_b64_tr_b16 a[226:227], v117 offset:4096
    ds_read_b64_tr_b16 a[164:165], v116 offset:8192
    ds_read_b64_tr_b16 a[228:229], v117 offset:8192
    ds_read_b64_tr_b16 a[166:167], v116 offset:12288
    ds_read_b64_tr_b16 a[230:231], v117 offset:12288
    global_load_dwordx2 v[8:9], v9, s[12:13] sc1
    s_waitcnt lgkmcnt(0)
    s_waitcnt vmcnt(25)
    s_barrier
    s_mov_b32 s8, s56
    s_mov_b32 s9, s57
    s_mov_b32 s10, 4194304
    s_add_u32 m0, s24, 65536
    s_mov_b32 s47, 2097152
    buffer_load_dwordx4 v112, s[8:11], s47 offen lds
    s_add_u32 m0, s24, 66560
    s_mov_b32 s47, 2162688
    buffer_load_dwordx4 v113, s[8:11], s47 offen lds
    s_add_u32 m0, s24, 67584
    s_mov_b32 s47, 2228224
    buffer_load_dwordx4 v112, s[8:11], s47 offen lds
    s_add_u32 m0, s24, 68608
    s_mov_b32 s47, 2293760
    buffer_load_dwordx4 v113, s[8:11], s47 offen lds
    ds_read_b64_tr_b16 a[168:169], v116 offset:16384
    ds_read_b64_tr_b16 a[232:233], v117 offset:16384
    ds_read_b64_tr_b16 a[170:171], v116 offset:20480
    ds_read_b64_tr_b16 a[234:235], v117 offset:20480
    ds_read_b64_tr_b16 a[172:173], v116 offset:24576
    ds_read_b64_tr_b16 a[236:237], v117 offset:24576
    ds_read_b64_tr_b16 a[174:175], v116 offset:28672
    ds_read_b64_tr_b16 a[238:239], v117 offset:28672
    s_waitcnt lgkmcnt(0)
    s_waitcnt vmcnt(25)
    s_barrier
    s_mov_b32 s8, s56
    s_mov_b32 s9, s57
    s_mov_b32 s10, 4194304
    s_add_u32 m0, s24, 81920
    s_mov_b32 s47, 2621440
    buffer_load_dwordx4 v112, s[8:11], s47 offen lds
    s_add_u32 m0, s24, 82944
    s_mov_b32 s47, 2686976
    buffer_load_dwordx4 v113, s[8:11], s47 offen lds
    s_add_u32 m0, s24, 83968
    s_mov_b32 s47, 2752512
    buffer_load_dwordx4 v112, s[8:11], s47 offen lds
    s_add_u32 m0, s24, 84992
    s_mov_b32 s47, 2818048
    buffer_load_dwordx4 v113, s[8:11], s47 offen lds
    ds_read_b64_tr_b16 a[176:177], v116 offset:32768
    ds_read_b64_tr_b16 a[240:241], v117 offset:32768
    ds_read_b64_tr_b16 a[178:179], v116 offset:36864
    ds_read_b64_tr_b16 a[242:243], v117 offset:36864
    ds_read_b64_tr_b16 a[180:181], v116 offset:40960
    ds_read_b64_tr_b16 a[244:245], v117 offset:40960
    ds_read_b64_tr_b16 a[182:183], v116 offset:45056
    ds_read_b64_tr_b16 a[246:247], v117 offset:45056
    s_waitcnt lgkmcnt(0)
    s_waitcnt vmcnt(25)
    s_barrier
    s_mov_b32 s8, s56
    s_mov_b32 s9, s57
    s_mov_b32 s10, 4194304
    s_add_u32 m0, s24, 98304
    s_mov_b32 s47, 3145728
    buffer_load_dwordx4 v112, s[8:11], s47 offen lds
    s_add_u32 m0, s24, 99328
    s_mov_b32 s47, 3211264
    buffer_load_dwordx4 v113, s[8:11], s47 offen lds
    s_add_u32 m0, s24, 100352
    s_mov_b32 s47, 3276800
    buffer_load_dwordx4 v112, s[8:11], s47 offen lds
    s_add_u32 m0, s24, 101376
    s_mov_b32 s47, 3342336
    buffer_load_dwordx4 v113, s[8:11], s47 offen lds
    ds_read_b64_tr_b16 a[184:185], v116 offset:49152
    ds_read_b64_tr_b16 a[248:249], v117 offset:49152
    ds_read_b64_tr_b16 a[186:187], v116 offset:53248
    ds_read_b64_tr_b16 a[250:251], v117 offset:53248
    ds_read_b64_tr_b16 a[188:189], v116 offset:57344
    ds_read_b64_tr_b16 a[252:253], v117 offset:57344
    ds_read_b64_tr_b16 a[190:191], v116 offset:61440
    ds_read_b64_tr_b16 a[254:255], v117 offset:61440
    s_waitcnt lgkmcnt(0)
    s_waitcnt vmcnt(25)
    s_barrier
    s_mov_b32 s8, s56
    s_mov_b32 s9, s57
    s_mov_b32 s10, 4194304
    s_add_u32 m0, s24, 114688
    s_mov_b32 s47, 3670016
    buffer_load_dwordx4 v112, s[8:11], s47 offen lds
    s_add_u32 m0, s24, 115712
    s_mov_b32 s47, 3735552
    buffer_load_dwordx4 v113, s[8:11], s47 offen lds
    s_add_u32 m0, s24, 116736
    s_mov_b32 s47, 3801088
    buffer_load_dwordx4 v112, s[8:11], s47 offen lds
    s_add_u32 m0, s24, 117760
    s_mov_b32 s47, 3866624
    buffer_load_dwordx4 v113, s[8:11], s47 offen lds
    ds_read_b64_tr_b16 v[128:129], v114 offset:0
    ds_read_b64_tr_b16 v[192:193], v115 offset:0
    ds_read_b64_tr_b16 v[130:131], v114 offset:4096
    ds_read_b64_tr_b16 v[194:195], v115 offset:4096
    ds_read_b64_tr_b16 v[132:133], v114 offset:8192
    ds_read_b64_tr_b16 v[196:197], v115 offset:8192
    ds_read_b64_tr_b16 v[134:135], v114 offset:12288
    ds_read_b64_tr_b16 v[198:199], v115 offset:12288
    s_waitcnt lgkmcnt(0)
    s_waitcnt vmcnt(25)
    s_barrier
    ds_read_b64_tr_b16 v[136:137], v114 offset:16384
    ds_read_b64_tr_b16 v[200:201], v115 offset:16384
    ds_read_b64_tr_b16 v[138:139], v114 offset:20480
    ds_read_b64_tr_b16 v[202:203], v115 offset:20480
    ds_read_b64_tr_b16 v[140:141], v114 offset:24576
    ds_read_b64_tr_b16 v[204:205], v115 offset:24576
    ds_read_b64_tr_b16 v[142:143], v114 offset:28672
    ds_read_b64_tr_b16 v[206:207], v115 offset:28672
    s_waitcnt lgkmcnt(0)
    s_waitcnt vmcnt(21)
    s_barrier
    ds_read_b64_tr_b16 v[144:145], v114 offset:32768
    ds_read_b64_tr_b16 v[208:209], v115 offset:32768
    ds_read_b64_tr_b16 v[146:147], v114 offset:36864
    ds_read_b64_tr_b16 v[210:211], v115 offset:36864
    ds_read_b64_tr_b16 v[148:149], v114 offset:40960
    ds_read_b64_tr_b16 v[212:213], v115 offset:40960
    ds_read_b64_tr_b16 v[150:151], v114 offset:45056
    ds_read_b64_tr_b16 v[214:215], v115 offset:45056
    s_waitcnt lgkmcnt(0)
    s_waitcnt vmcnt(17)
    s_barrier
    ds_read_b64_tr_b16 v[152:153], v114 offset:49152
    ds_read_b64_tr_b16 v[216:217], v115 offset:49152
    ds_read_b64_tr_b16 v[154:155], v114 offset:53248
    ds_read_b64_tr_b16 v[218:219], v115 offset:53248
    ds_read_b64_tr_b16 v[156:157], v114 offset:57344
    ds_read_b64_tr_b16 v[220:221], v115 offset:57344
    ds_read_b64_tr_b16 v[158:159], v114 offset:61440
    ds_read_b64_tr_b16 v[222:223], v115 offset:61440
    s_waitcnt lgkmcnt(0)
    s_waitcnt vmcnt(12)
    s_barrier
    ds_read_b64_tr_b16 v[160:161], v116 offset:0
    ds_read_b64_tr_b16 v[224:225], v117 offset:0
    ds_read_b64_tr_b16 v[162:163], v116 offset:4096
    ds_read_b64_tr_b16 v[226:227], v117 offset:4096
    ds_read_b64_tr_b16 v[164:165], v116 offset:8192
    ds_read_b64_tr_b16 v[228:229], v117 offset:8192
    ds_read_b64_tr_b16 v[166:167], v116 offset:12288
    ds_read_b64_tr_b16 v[230:231], v117 offset:12288
    s_waitcnt vmcnt(16)
L_vfpa:
    v_readfirstlane_b32 s40, v9
    s_add_u32 s17, s17, 1
    s_cmp_gt_u32 s17, 0x200000
    s_cbranch_scc1 L_vxpa
    s_cmp_lg_u32 s40, 0
    s_cbranch_scc1 L_vgpa
    v_mov_b32 v9, 140
    global_load_dword v9, v9, s[12:13] sc1
    s_waitcnt vmcnt(0)
    s_branch L_vfpa
L_vgpa:
    s_sub_u32 s40, s40, 1
    s_and_b32 s40, s40, 7
    s_cmp_eq_u32 s40, s101
    s_cbranch_scc1 L_vxpa
    s_mov_b32 s101, s40
    s_branch L_restart
L_vxpa:
    v_cmp_eq_u32 vcc, 0, v8
    s_cbranch_vccz L_p1_ina
    v_mov_b32 v9, 136
L_po1:
    global_load_dword v8, v9, s[12:13] sc1
    s_add_u32 s17, s17, 1
    s_cmp_gt_u32 s17, 0x400000
    s_cbranch_scc1 L_pe1
    s_waitcnt vmcnt(0)
    v_cmp_gt_u32 vcc, 1, v8
    s_cbranch_vccnz L_po1
L_pe1:
    s_waitcnt vmcnt(0)
L_p1_ina:
    s_mov_b32 s40, 80871424
    buffer_load_dwordx2 v[8:9], v7, s[4:7], s40 offen sc1
    s_waitcnt lgkmcnt(0)
    s_waitcnt vmcnt(9)
    s_barrier
    ds_read_b64_tr_b16 v[168:169], v116 offset:16384
    ds_read_b64_tr_b16 v[232:233], v117 offset:16384
    ds_read_b64_tr_b16 v[170:171], v116 offset:20480
    ds_read_b64_tr_b16 v[234:235], v117 offset:20480
    ds_read_b64_tr_b16 v[172:173], v116 offset:24576
    ds_read_b64_tr_b16 v[236:237], v117 offset:24576
    ds_read_b64_tr_b16 v[174:175], v116 offset:28672
    ds_read_b64_tr_b16 v[238:239], v117 offset:28672
    s_waitcnt lgkmcnt(0)
    s_waitcnt vmcnt(5)
    s_barrier
    ds_read_b64_tr_b16 v[176:177], v116 offset:32768
    ds_read_b64_tr_b16 v[240:241], v117 offset:32768
    ds_read_b64_tr_b16 v[178:179], v116 offset:36864
    ds_read_b64_tr_b16 v[242:243], v117 offset:36864
    ds_read_b64_tr_b16 v[180:181], v116 offset:40960
    ds_read_b64_tr_b16 v[244:245], v117 offset:40960
    ds_read_b64_tr_b16 v[182:183], v116 offset:45056
    ds_read_b64_tr_b16 v[246:247], v117 offset:45056
    s_waitcnt lgkmcnt(0)
    s_waitcnt vmcnt(1)
    s_barrier
    ds_read_b64_tr_b16 v[184:185], v116 offset:49152
    ds_read_b64_tr_b16 v[248:249], v117 offset:49152
    ds_read_b64_tr_b16 v[186:187], v116 offset:53248
    ds_read_b64_tr_b16 v[250:251], v117 offset:53248
    ds_read_b64_tr_b16 v[188:189], v116 offset:57344
    ds_read_b64_tr_b16 v[252:253], v117 offset:57344
    ds_read_b64_tr_b16 v[190:191], v116 offset:61440
    ds_read_b64_tr_b16 v[254:255], v117 offset:61440
    s_waitcnt lgkmcnt(0)
    s_waitcnt vmcnt(0)
    s_barrier
    v_min_u32 v8, v8, v9
    v_cmp_gt_u32 vcc, 1, v8
    s_cbranch_vccz L_p1_hok
    s_mov_b32 s40, 80871424
L_po2:
    buffer_load_dwordx2 v[8:9], v7, s[4:7], s40 offen offset:0 sc1
    s_add_u32 s17, s17, 1
    s_cmp_gt_u32 s17, 0x400000
    s_cbranch_scc1 L_pe2
    s_waitcnt vmcnt(0)
    v_min_u32 v8, v8, v9
    v_cmp_gt_u32 vcc, 1, v8
    s_cbranch_vccnz L_po2
L_pe2:
    s_waitcnt vmcnt(0)
L_p1_hok:
    s_mov_b32 s23, s22
    s_mov_b32 s32, s22
    s_mov_b32 s27, 0
    s_mov_b32 s25, 0
    s_lshl_b32 s31, s21, 7
    s_lshl_b32 s40, s22, 2
    s_add_u32 s31, s31, s40
    s_add_u32 s31, s31, 80872448
    s_lshl_b32 s26, s32, 15
    s_lshl_b32 s40, s15, 13
    s_add_u32 s26, s26, s40
    s_add_u32 s26, s26, 77594624
    s_add_u32 m0, s27, s40
    s_add_u32 s41, s26, 4096
    buffer_load_dwordx4 v3, s[4:7], s26 offen offset:0 sc1 lds
    buffer_load_dwordx4 v3, s[4:7], s26 offen offset:1024 sc1 lds
    buffer_load_dwordx4 v3, s[4:7], s26 offen offset:2048 sc1 lds
    buffer_load_dwordx4 v3, s[4:7], s26 offen offset:3072 sc1 lds
    s_add_u32 m0, m0, 4096
    s_nop 0
    buffer_load_dwordx4 v3, s[4:7], s41 offen offset:0 sc1 lds
    buffer_load_dwordx4 v3, s[4:7], s41 offen offset:1024 sc1 lds
    buffer_load_dwordx4 v3, s[4:7], s41 offen offset:2048 sc1 lds
    buffer_load_dwordx4 v3, s[4:7], s41 offen offset:3072 sc1 lds
    v_mov_b32 v12, -1
    v_mov_b32 v13, -1
    v_mov_b32 v14, -1
    v_mov_b32 v15, -1
    s_waitcnt vmcnt(0)
L_p1_loop:
    s_waitcnt vmcnt(2)
    s_barrier
    s_cmp_lg_u32 s15, 0
    s_cbranch_scc1 L_p1_nf
    v_mov_b32 v7, s25
    s_mov_b64 exec, 1
    buffer_store_dword v7, off, s[4:7], s31 sc1
    s_mov_b64 exec, -1
L_p1_nf:
    s_cmp_ge_u32 s23, 64
    s_cbranch_scc1 L_p1_end
    v_add_u32 v4, s27, v3
    s_xor_b32 s27, s27, 32768
    s_add_u32 s32, s23, 2
    s_cmp_ge_u32 s32, 64
    s_cbranch_scc1 L_p1_nd
    s_lshl_b32 s26, s32, 15
    s_lshl_b32 s40, s15, 13
    s_add_u32 s26, s26, s40
    s_add_u32 s26, s26, 77594624
    s_add_u32 m0, s27, s40
    s_add_u32 s41, s26, 4096
    buffer_load_dwordx4 v3, s[4:7], s26 offen offset:0 sc1 lds
    buffer_load_dwordx4 v3, s[4:7], s26 offen offset:1024 sc1 lds
    buffer_load_dwordx4 v3, s[4:7], s26 offen offset:2048 sc1 lds
    buffer_load_dwordx4 v3, s[4:7], s26 offen offset:3072 sc1 lds
    s_add_u32 m0, m0, 4096
    s_nop 0
    buffer_load_dwordx4 v3, s[4:7], s41 offen offset:0 sc1 lds
    buffer_load_dwordx4 v3, s[4:7], s41 offen offset:1024 sc1 lds
    buffer_load_dwordx4 v3, s[4:7], s41 offen offset:2048 sc1 lds
    buffer_load_dwordx4 v3, s[4:7], s41 offen offset:3072 sc1 lds
L_p1_nd:
    ds_read_b128 v[64:67], v4 offset:0
    ds_read_b128 v[68:71], v4 offset:16384
    ds_read_b128 v[72:75], v4 offset:1024
    ds_read_b128 v[76:79], v4 offset:17408
    s_waitcnt lgkmcnt(3)
    v_mfma_f32_16x16x32_bf16 v[16:19], a[0:3], v[64:67], 0
    ds_read_b128 v[80:83], v4 offset:2048
    v_mfma_f32_16x16x32_bf16 v[24:27], a[64:67], v[64:67], 0
    v_mfma_f32_16x16x32_bf16 v[32:35], v[64:67], a[128:131], 0
    ds_read_b128 v[84:87], v4 offset:18432
    v_mfma_f32_16x16x32_bf16 v[40:43], v[64:67], a[192:195], 0
    s_waitcnt lgkmcnt(4)
    v_mfma_f32_16x16x32_bf16 v[20:23], a[0:3], v[68:71], 0
    s_lshl_b32 s40, s21, 6
    v_mfma_f32_16x16x32_bf16 v[28:31], a[64:67], v[68:71], 0
    s_add_u32 s40, s40, s23
    v_mfma_f32_16x16x32_bf16 v[36:39], v[68:71], a[128:131], 0
    v_mfma_f32_16x16x32_bf16 v[44:47], v[68:71], a[192:195], 0
    s_waitcnt lgkmcnt(3)
    v_mfma_f32_16x16x32_bf16 v[16:19], a[4:7], v[72:75], v[16:19]
    ds_read_b128 v[88:91], v4 offset:3072
    v_mfma_f32_16x16x32_bf16 v[24:27], a[68:71], v[72:75], v[24:27]
    v_mfma_f32_16x16x32_bf16 v[32:35], v[72:75], a[132:135], v[32:35]
    ds_read_b128 v[92:95], v4 offset:19456
    v_mfma_f32_16x16x32_bf16 v[40:43], v[72:75], a[196:199], v[40:43]
    s_waitcnt lgkmcnt(4)
    v_mfma_f32_16x16x32_bf16 v[20:23], a[4:7], v[76:79], v[20:23]
    s_lshl_b32 s41, s15, 10
    v_mfma_f32_16x16x32_bf16 v[28:31], a[68:71], v[76:79], v[28:31]
    s_lshl_b32 s28, s40, 14
    v_mfma_f32_16x16x32_bf16 v[36:39], v[76:79], a[132:135], v[36:39]
    v_mfma_f32_16x16x32_bf16 v[44:47], v[76:79], a[196:199], v[44:47]
    s_waitcnt lgkmcnt(3)
    v_mfma_f32_16x16x32_bf16 v[16:19], a[8:11], v[80:83], v[16:19]
    ds_read_b128 v[64:67], v4 offset:4096
    v_mfma_f32_16x16x32_bf16 v[24:27], a[72:75], v[80:83], v[24:27]
    v_mfma_f32_16x16x32_bf16 v[32:35], v[80:83], a[136:139], v[32:35]
    ds_read_b128 v[68:71], v4 offset:20480
    v_mfma_f32_16x16x32_bf16 v[40:43], v[80:83], a[200:203], v[40:43]
    s_waitcnt lgkmcnt(4)
    v_mfma_f32_16x16x32_bf16 v[20:23], a[8:11], v[84:87], v[20:23]
    s_add_u32 s29, s28, 8192
    v_mfma_f32_16x16x32_bf16 v[28:31], a[72:75], v[84:87], v[28:31]
    s_add_u32 s28, s28, s41
    v_mfma_f32_16x16x32_bf16 v[36:39], v[84:87], a[136:139], v[36:39]
    v_mfma_f32_16x16x32_bf16 v[44:47], v[84:87], a[200:203], v[44:47]
    s_waitcnt lgkmcnt(3)
    v_mfma_f32_16x16x32_bf16 v[16:19], a[12:15], v[88:91], v[16:19]
    ds_read_b128 v[72:75], v4 offset:5120
    v_mfma_f32_16x16x32_bf16 v[24:27], a[76:79], v[88:91], v[24:27]
    v_mfma_f32_16x16x32_bf16 v[32:35], v[88:91], a[140:143], v[32:35]
    ds_read_b128 v[76:79], v4 offset:21504
    v_mfma_f32_16x16x32_bf16 v[40:43], v[88:91], a[204:207], v[40:43]
    s_waitcnt lgkmcnt(4)
    v_mfma_f32_16x16x32_bf16 v[20:23], a[12:15], v[92:95], v[20:23]
    s_add_u32 s28, s28, 0
    v_mfma_f32_16x16x32_bf16 v[28:31], a[76:79], v[92:95], v[28:31]
    s_add_u32 s42, s28, 4096
    v_mfma_f32_16x16x32_bf16 v[36:39], v[92:95], a[140:143], v[36:39]
    v_mfma_f32_16x16x32_bf16 v[44:47], v[92:95], a[204:207], v[44:47]
    s_waitcnt lgkmcnt(3)
    v_mfma_f32_16x16x32_bf16 v[16:19], a[16:19], v[64:67], v[16:19]
    ds_read_b128 v[80:83], v4 offset:6144
    v_mfma_f32_16x16x32_bf16 v[24:27], a[80:83], v[64:67], v[24:27]
    v_mfma_f32_16x16x32_bf16 v[32:35], v[64:67], a[144:147], v[32:35]
    ds_read_b128 v[84:87], v4 offset:22528
    v_mfma_f32_16x16x32_bf16 v[40:43], v[64:67], a[208:211], v[40:43]
    s_waitcnt lgkmcnt(4)
    v_mfma_f32_16x16x32_bf16 v[20:23], a[16:19], v[68:71], v[20:23]
    s_lshl_b32 s30, s40, 13
    v_mfma_f32_16x16x32_bf16 v[28:31], a[80:83], v[68:71], v[28:31]
    s_add_u32 s30, s30, s41
    v_mfma_f32_16x16x32_bf16 v[36:39], v[68:71], a[144:147], v[36:39]
    v_mfma_f32_16x16x32_bf16 v[44:47], v[68:71], a[208:211], v[44:47]
    s_waitcnt lgkmcnt(3)
    v_mfma_f32_16x16x32_bf16 v[16:19], a[20:23], v[72:75], v[16:19]
    ds_read_b128 v[88:91], v4 offset:7168
    v_mfma_f32_16x16x32_bf16 v[24:27], a[84:87], v[72:75], v[24:27]
    v_mfma_f32_16x16x32_bf16 v[32:35], v[72:75], a[148:151], v[32:35]
    ds_read_b128 v[92:95], v4 offset:23552
    v_mfma_f32_16x16x32_bf16 v[40:43], v[72:75], a[212:215], v[40:43]
    s_waitcnt lgkmcnt(4)
    v_mfma_f32_16x16x32_bf16 v[20:23], a[20:23], v[76:79], v[20:23]
    s_add_u32 s30, s30, 33554432
    v_mfma_f32_16x16x32_bf16 v[28:31], a[84:87], v[76:79], v[28:31]
    s_add_u32 s43, s30, 4096
    v_mfma_f32_16x16x32_bf16 v[36:39], v[76:79], a[148:151], v[36:39]
    v_mfma_f32_16x16x32_bf16 v[44:47], v[76:79], a[212:215], v[44:47]
    s_waitcnt lgkmcnt(3)
    v_mfma_f32_16x16x32_bf16 v[16:19], a[24:27], v[80:83], v[16:19]
    ds_read_b128 v[64:67], v4 offset:8192
    v_mfma_f32_16x16x32_bf16 v[24:27], a[88:91], v[80:83], v[24:27]
    v_mfma_f32_16x16x32_bf16 v[32:35], v[80:83], a[152:155], v[32:35]
    ds_read_b128 v[68:71], v4 offset:24576
    v_mfma_f32_16x16x32_bf16 v[40:43], v[80:83], a[216:219], v[40:43]
    s_waitcnt lgkmcnt(4)
    v_mfma_f32_16x16x32_bf16 v[20:23], a[24:27], v[84:87], v[20:23]
    s_lshl_b32 s41, s15, 11
    v_mfma_f32_16x16x32_bf16 v[28:31], a[88:91], v[84:87], v[28:31]
    s_add_u32 s29, s29, s41
    v_mfma_f32_16x16x32_bf16 v[36:39], v[84:87], a[152:155], v[36:39]
    v_mfma_f32_16x16x32_bf16 v[44:47], v[84:87], a[216:219], v[44:47]
    s_waitcnt lgkmcnt(3)
    v_mfma_f32_16x16x32_bf16 v[16:19], a[28:31], v[88:91], v[16:19]
    ds_read_b128 v[72:75], v4 offset:9216
    v_mfma_f32_16x16x32_bf16 v[24:27], a[92:95], v[88:91], v[24:27]
    v_mfma_f32_16x16x32_bf16 v[32:35], v[88:91], a[156:159], v[32:35]
    ds_read_b128 v[76:79], v4 offset:25600
    v_mfma_f32_16x16x32_bf16 v[40:43], v[88:91], a[220:223], v[40:43]
    s_waitcnt lgkmcnt(4)
    v_mfma_f32_16x16x32_bf16 v[20:23], a[28:31], v[92:95], v[20:23]
    s_lshl_b32 s40, s40, 2
    v_mfma_f32_16x16x32_bf16 v[28:31], a[92:95], v[92:95], v[28:31]
    s_add_u32 s40, s40, s15
    v_mfma_f32_16x16x32_bf16 v[36:39], v[92:95], a[156:159], v[36:39]
    v_mfma_f32_16x16x32_bf16 v[44:47], v[92:95], a[220:223], v[44:47]
    s_waitcnt lgkmcnt(3)
    v_mfma_f32_16x16x32_bf16 v[16:19], a[32:35], v[64:67], v[16:19]
    ds_read_b128 v[80:83], v4 offset:10240
    v_mfma_f32_16x16x32_bf16 v[24:27], a[96:99], v[64:67], v[24:27]
    v_mfma_f32_16x16x32_bf16 v[32:35], v[64:67], a[160:163], v[32:35]
    ds_read_b128 v[84:87], v4 offset:26624
    v_mfma_f32_16x16x32_bf16 v[40:43], v[64:67], a[224:227], v[40:43]
    s_waitcnt lgkmcnt(4)
    v_mfma_f32_16x16x32_bf16 v[20:23], a[32:35], v[68:71], v[20:23]
    s_lshl_b32 s40, s40, 10
    v_mfma_f32_16x16x32_bf16 v[28:31], a[96:99], v[68:71], v[28:31]
    s_add_u32 s40, s40, 51380224
    v_mfma_f32_16x16x32_bf16 v[36:39], v[68:71], a[160:163], v[36:39]
    v_mfma_f32_16x16x32_bf16 v[44:47], v[68:71], a[224:227], v[44:47]
    s_waitcnt lgkmcnt(3)
    v_mfma_f32_16x16x32_bf16 v[16:19], a[36:39], v[72:75], v[16:19]
    ds_read_b128 v[88:91], v4 offset:11264
    v_mfma_f32_16x16x32_bf16 v[24:27], a[100:103], v[72:75], v[24:27]
    v_mfma_f32_16x16x32_bf16 v[32:35], v[72:75], a[164:167], v[32:35]
    ds_read_b128 v[92:95], v4 offset:27648
    v_mfma_f32_16x16x32_bf16 v[40:43], v[72:75], a[228:231], v[40:43]
    s_waitcnt lgkmcnt(4)
    v_mfma_f32_16x16x32_bf16 v[20:23], a[36:39], v[76:79], v[20:23]
    buffer_store_dwordx4 v[12:15], v3, s[4:7], s40 offen sc1
    v_mfma_f32_16x16x32_bf16 v[28:31], a[100:103], v[76:79], v[28:31]
    v_mfma_f32_16x16x32_bf16 v[36:39], v[76:79], a[164:167], v[36:39]
    v_mfma_f32_16x16x32_bf16 v[44:47], v[76:79], a[228:231], v[44:47]
    s_waitcnt lgkmcnt(3)
    v_mfma_f32_16x16x32_bf16 v[16:19], a[40:43], v[80:83], v[16:19]
    ds_read_b128 v[64:67], v4 offset:12288
    v_mfma_f32_16x16x32_bf16 v[24:27], a[104:107], v[80:83], v[24:27]
    v_mfma_f32_16x16x32_bf16 v[32:35], v[80:83], a[168:171], v[32:35]
    ds_read_b128 v[68:71], v4 offset:28672
    v_mfma_f32_16x16x32_bf16 v[40:43], v[80:83], a[232:235], v[40:43]
    s_waitcnt lgkmcnt(4)
    v_mfma_f32_16x16x32_bf16 v[20:23], a[40:43], v[84:87], v[20:23]
    v_mfma_f32_16x16x32_bf16 v[28:31], a[104:107], v[84:87], v[28:31]
    v_mfma_f32_16x16x32_bf16 v[36:39], v[84:87], a[168:171], v[36:39]
    v_mfma_f32_16x16x32_bf16 v[44:47], v[84:87], a[232:235], v[44:47]
    s_waitcnt lgkmcnt(3)
    v_mfma_f32_16x16x32_bf16 v[16:19], a[44:47], v[88:91], v[16:19]
    ds_read_b128 v[72:75], v4 offset:13312
    v_mfma_f32_16x16x32_bf16 v[24:27], a[108:111], v[88:91], v[24:27]
    v_mfma_f32_16x16x32_bf16 v[32:35], v[88:91], a[172:175], v[32:35]
    ds_read_b128 v[76:79], v4 offset:29696
    v_mfma_f32_16x16x32_bf16 v[40:43], v[88:91], a[236:239], v[40:43]
    s_waitcnt lgkmcnt(4)
    v_mfma_f32_16x16x32_bf16 v[20:23], a[44:47], v[92:95], v[20:23]
    v_mfma_f32_16x16x32_bf16 v[28:31], a[108:111], v[92:95], v[28:31]
    v_mfma_f32_16x16x32_bf16 v[36:39], v[92:95], a[172:175], v[36:39]
    v_mfma_f32_16x16x32_bf16 v[44:47], v[92:95], a[236:239], v[44:47]
    s_waitcnt lgkmcnt(3)
    v_mfma_f32_16x16x32_bf16 v[16:19], a[48:51], v[64:67], v[16:19]
    ds_read_b128 v[80:83], v4 offset:14336
    v_mfma_f32_16x16x32_bf16 v[24:27], a[112:115], v[64:67], v[24:27]
    v_mfma_f32_16x16x32_bf16 v[32:35], v[64:67], a[176:179], v[32:35]
    ds_read_b128 v[84:87], v4 offset:30720
    v_mfma_f32_16x16x32_bf16 v[40:43], v[64:67], a[240:243], v[40:43]
    s_waitcnt lgkmcnt(4)
    v_mfma_f32_16x16x32_bf16 v[20:23], a[48:51], v[68:71], v[20:23]
    v_mfma_f32_16x16x32_bf16 v[28:31], a[112:115], v[68:71], v[28:31]
    v_mfma_f32_16x16x32_bf16 v[36:39], v[68:71], a[176:179], v[36:39]
    v_mfma_f32_16x16x32_bf16 v[44:47], v[68:71], a[240:243], v[44:47]
    s_waitcnt lgkmcnt(3)
    v_mfma_f32_16x16x32_bf16 v[16:19], a[52:55], v[72:75], v[16:19]
    ds_read_b128 v[88:91], v4 offset:15360
    v_mfma_f32_16x16x32_bf16 v[24:27], a[116:119], v[72:75], v[24:27]
    v_mfma_f32_16x16x32_bf16 v[32:35], v[72:75], a[180:183], v[32:35]
    ds_read_b128 v[92:95], v4 offset:31744
    v_mfma_f32_16x16x32_bf16 v[40:43], v[72:75], a[244:247], v[40:43]
    s_waitcnt lgkmcnt(4)
    v_mfma_f32_16x16x32_bf16 v[20:23], a[52:55], v[76:79], v[20:23]
    v_mfma_f32_16x16x32_bf16 v[28:31], a[116:119], v[76:79], v[28:31]
    v_mfma_f32_16x16x32_bf16 v[36:39], v[76:79], a[180:183], v[36:39]
    v_mfma_f32_16x16x32_bf16 v[44:47], v[76:79], a[244:247], v[44:47]
    s_waitcnt lgkmcnt(3)
    v_mfma_f32_16x16x32_bf16 v[16:19], a[56:59], v[80:83], v[16:19]
    ds_read_b128 v[64:67], v4 offset:0
    v_mfma_f32_16x16x32_bf16 v[24:27], a[120:123], v[80:83], v[24:27]
    v_mfma_f32_16x16x32_bf16 v[32:35], v[80:83], a[184:187], v[32:35]
    ds_read_b128 v[68:71], v4 offset:16384
    v_mfma_f32_16x16x32_bf16 v[40:43], v[80:83], a[248:251], v[40:43]
    s_waitcnt lgkmcnt(4)
    v_mfma_f32_16x16x32_bf16 v[20:23], a[56:59], v[84:87], v[20:23]
    v_mfma_f32_16x16x32_bf16 v[28:31], a[120:123], v[84:87], v[28:31]
    v_mfma_f32_16x16x32_bf16 v[36:39], v[84:87], a[184:187], v[36:39]
    v_mfma_f32_16x16x32_bf16 v[44:47], v[84:87], a[248:251], v[44:47]
    s_waitcnt lgkmcnt(3)
    v_mfma_f32_16x16x32_bf16 v[16:19], a[60:63], v[88:91], v[16:19]
    ds_read_b128 v[72:75], v4 offset:1024
    v_mfma_f32_16x16x32_bf16 v[24:27], a[124:127], v[88:91], v[24:27]
    v_mfma_f32_16x16x32_bf16 v[32:35], v[88:91], a[188:191], v[32:35]
    ds_read_b128 v[76:79], v4 offset:17408
    v_mfma_f32_16x16x32_bf16 v[40:43], v[88:91], a[252:255], v[40:43]
    s_waitcnt lgkmcnt(4)
    v_mfma_f32_16x16x32_bf16 v[20:23], a[60:63], v[92:95], v[20:23]
    v_mfma_f32_16x16x32_bf16 v[28:31], a[124:127], v[92:95], v[28:31]
    v_mfma_f32_16x16x32_bf16 v[36:39], v[92:95], a[188:191], v[36:39]
    v_mfma_f32_16x16x32_bf16 v[44:47], v[92:95], a[252:255], v[44:47]
    s_waitcnt lgkmcnt(3)
    v_mfma_f32_16x16x32_bf16 v[48:51], v[128:131], v[64:67], 0
    ds_read_b128 v[80:83], v4 offset:2048
    v_mfma_f32_16x16x32_bf16 v[56:59], v[192:195], v[64:67], 0
    s_waitcnt lgkmcnt(3)
    v_mfma_f32_16x16x32_bf16 v[52:55], v[128:131], v[68:71], 0
    ds_read_b128 v[84:87], v4 offset:18432
    v_mfma_f32_16x16x32_bf16 v[60:63], v[192:195], v[68:71], 0
    s_waitcnt lgkmcnt(3)
    v_mfma_f32_16x16x32_bf16 v[48:51], v[132:135], v[72:75], v[48:51]
    ds_read_b128 v[88:91], v4 offset:3072
    v_mfma_f32_16x16x32_bf16 v[56:59], v[196:199], v[72:75], v[56:59]
    s_waitcnt lgkmcnt(3)
    v_mfma_f32_16x16x32_bf16 v[52:55], v[132:135], v[76:79], v[52:55]
    ds_read_b128 v[92:95], v4 offset:19456
    v_mfma_f32_16x16x32_bf16 v[60:63], v[196:199], v[76:79], v[60:63]
    s_waitcnt lgkmcnt(3)
    v_mfma_f32_16x16x32_bf16 v[48:51], v[136:139], v[80:83], v[48:51]
    ds_read_b128 v[64:67], v4 offset:4096
    v_mfma_f32_16x16x32_bf16 v[56:59], v[200:203], v[80:83], v[56:59]
    v_cvt_pk_bf16_f32 v96, v16, v24
    v_cvt_pk_bf16_f32 v97, v17, v25
    s_waitcnt lgkmcnt(3)
    v_mfma_f32_16x16x32_bf16 v[52:55], v[136:139], v[84:87], v[52:55]
    ds_read_b128 v[68:71], v4 offset:20480
    v_mfma_f32_16x16x32_bf16 v[60:63], v[200:203], v[84:87], v[60:63]
    v_cvt_pk_bf16_f32 v98, v18, v26
    v_cvt_pk_bf16_f32 v99, v19, v27
    s_waitcnt lgkmcnt(3)
    v_mfma_f32_16x16x32_bf16 v[48:51], v[140:143], v[88:91], v[48:51]
    ds_read_b128 v[72:75], v4 offset:5120
    v_mfma_f32_16x16x32_bf16 v[56:59], v[204:207], v[88:91], v[56:59]
    buffer_store_dwordx4 v[96:99], v3, s[4:7], s28 offen sc1
    v_cvt_pk_bf16_f32 v100, v20, v28
    s_waitcnt lgkmcnt(3)
    v_mfma_f32_16x16x32_bf16 v[52:55], v[140:143], v[92:95], v[52:55]
    ds_read_b128 v[76:79], v4 offset:21504
    v_mfma_f32_16x16x32_bf16 v[60:63], v[204:207], v[92:95], v[60:63]
    v_cvt_pk_bf16_f32 v101, v21, v29
    v_cvt_pk_bf16_f32 v102, v22, v30
    s_waitcnt lgkmcnt(3)
    v_mfma_f32_16x16x32_bf16 v[48:51], v[144:147], v[64:67], v[48:51]
    ds_read_b128 v[80:83], v4 offset:6144
    v_mfma_f32_16x16x32_bf16 v[56:59], v[208:211], v[64:67], v[56:59]
    v_cvt_pk_bf16_f32 v103, v23, v31
    buffer_store_dwordx4 v[100:103], v3, s[4:7], s42 offen sc1
    s_waitcnt lgkmcnt(3)
    v_mfma_f32_16x16x32_bf16 v[52:55], v[144:147], v[68:71], v[52:55]
    ds_read_b128 v[84:87], v4 offset:22528
    v_mfma_f32_16x16x32_bf16 v[60:63], v[208:211], v[68:71], v[60:63]
    v_cvt_pk_bf16_f32 v104, v32, v33
    v_cvt_pk_bf16_f32 v105, v34, v35
    s_waitcnt lgkmcnt(3)
    v_mfma_f32_16x16x32_bf16 v[48:51], v[148:151], v[72:75], v[48:51]
    ds_read_b128 v[88:91], v4 offset:7168
    v_mfma_f32_16x16x32_bf16 v[56:59], v[212:215], v[72:75], v[56:59]
    v_cvt_pk_bf16_f32 v106, v36, v37
    v_cvt_pk_bf16_f32 v107, v38, v39
    s_waitcnt lgkmcnt(3)
    v_mfma_f32_16x16x32_bf16 v[52:55], v[148:151], v[76:79], v[52:55]
    ds_read_b128 v[92:95], v4 offset:23552
    v_mfma_f32_16x16x32_bf16 v[60:63], v[212:215], v[76:79], v[60:63]
    buffer_store_dwordx4 v[104:107], v3, s[4:7], s29 offen offset:0 sc1
    v_cvt_pk_bf16_f32 v108, v40, v41
    s_waitcnt lgkmcnt(3)
    v_mfma_f32_16x16x32_bf16 v[48:51], v[152:155], v[80:83], v[48:51]
    ds_read_b128 v[64:67], v4 offset:8192
    v_mfma_f32_16x16x32_bf16 v[56:59], v[216:219], v[80:83], v[56:59]
    v_cvt_pk_bf16_f32 v109, v42, v43
    v_cvt_pk_bf16_f32 v110, v44, v45
    s_waitcnt lgkmcnt(3)
    v_mfma_f32_16x16x32_bf16 v[52:55], v[152:155], v[84:87], v[52:55]
    ds_read_b128 v[68:71], v4 offset:24576
    v_mfma_f32_16x16x32_bf16 v[60:63], v[216:219], v[84:87], v[60:63]
    v_cvt_pk_bf16_f32 v111, v46, v47
    buffer_store_dwordx4 v[108:111], v3, s[4:7], s29 offen offset:1024 sc1
    s_waitcnt lgkmcnt(3)
    v_mfma_f32_16x16x32_bf16 v[48:51], v[156:159], v[88:91], v[48:51]
    ds_read_b128 v[72:75], v4 offset:9216
    v_mfma_f32_16x16x32_bf16 v[56:59], v[220:223], v[88:91], v[56:59]
    s_waitcnt lgkmcnt(3)
    v_mfma_f32_16x16x32_bf16 v[52:55], v[156:159], v[92:95], v[52:55]
    ds_read_b128 v[76:79], v4 offset:25600
    v_mfma_f32_16x16x32_bf16 v[60:63], v[220:223], v[92:95], v[60:63]
    s_waitcnt lgkmcnt(3)
    v_mfma_f32_16x16x32_bf16 v[48:51], v[160:163], v[64:67], v[48:51]
    ds_read_b128 v[80:83], v4 offset:10240
    v_mfma_f32_16x16x32_bf16 v[56:59], v[224:227], v[64:67], v[56:59]
    s_waitcnt lgkmcnt(3)
    v_mfma_f32_16x16x32_bf16 v[52:55], v[160:163], v[68:71], v[52:55]
    ds_read_b128 v[84:87], v4 offset:26624
    v_mfma_f32_16x16x32_bf16 v[60:63], v[224:227], v[68:71], v[60:63]
    s_waitcnt lgkmcnt(3)
    v_mfma_f32_16x16x32_bf16 v[48:51], v[164:167], v[72:75], v[48:51]
    ds_read_b128 v[88:91], v4 offset:11264
    v_mfma_f32_16x16x32_bf16 v[56:59], v[228:231], v[72:75], v[56:59]
    s_waitcnt lgkmcnt(3)
    v_mfma_f32_16x16x32_bf16 v[52:55], v[164:167], v[76:79], v[52:55]
    ds_read_b128 v[92:95], v4 offset:27648
    v_mfma_f32_16x16x32_bf16 v[60:63], v[228:231], v[76:79], v[60:63]
    s_waitcnt lgkmcnt(3)
    v_mfma_f32_16x16x32_bf16 v[48:51], v[168:171], v[80:83], v[48:51]
    ds_read_b128 v[64:67], v4 offset:12288
    v_mfma_f32_16x16x32_bf16 v[56:59], v[232:235], v[80:83], v[56:59]
    s_waitcnt lgkmcnt(3)
    v_mfma_f32_16x16x32_bf16 v[52:55], v[168:171], v[84:87], v[52:55]
    ds_read_b128 v[68:71], v4 offset:28672
    v_mfma_f32_16x16x32_bf16 v[60:63], v[232:235], v[84:87], v[60:63]
    s_waitcnt lgkmcnt(3)
    v_mfma_f32_16x16x32_bf16 v[48:51], v[172:175], v[88:91], v[48:51]
    ds_read_b128 v[72:75], v4 offset:13312
    v_mfma_f32_16x16x32_bf16 v[56:59], v[236:239], v[88:91], v[56:59]
    s_waitcnt lgkmcnt(3)
    v_mfma_f32_16x16x32_bf16 v[52:55], v[172:175], v[92:95], v[52:55]
    ds_read_b128 v[76:79], v4 offset:29696
    v_mfma_f32_16x16x32_bf16 v[60:63], v[236:239], v[92:95], v[60:63]
    s_waitcnt lgkmcnt(3)
    v_mfma_f32_16x16x32_bf16 v[48:51], v[176:179], v[64:67], v[48:51]
    ds_read_b128 v[80:83], v4 offset:14336
    v_mfma_f32_16x16x32_bf16 v[56:59], v[240:243], v[64:67], v[56:59]
    s_waitcnt lgkmcnt(3)
    v_mfma_f32_16x16x32_bf16 v[52:55], v[176:179], v[68:71], v[52:55]
    ds_read_b128 v[84:87], v4 offset:30720
    v_mfma_f32_16x16x32_bf16 v[60:63], v[240:243], v[68:71], v[60:63]
    s_waitcnt lgkmcnt(3)
    v_mfma_f32_16x16x32_bf16 v[48:51], v[180:183], v[72:75], v[48:51]
    ds_read_b128 v[88:91], v4 offset:15360
    v_mfma_f32_16x16x32_bf16 v[56:59], v[244:247], v[72:75], v[56:59]
    s_waitcnt lgkmcnt(3)
    v_mfma_f32_16x16x32_bf16 v[52:55], v[180:183], v[76:79], v[52:55]
    ds_read_b128 v[92:95], v4 offset:31744
    v_mfma_f32_16x16x32_bf16 v[60:63], v[244:247], v[76:79], v[60:63]
    s_waitcnt lgkmcnt(3)
    v_mfma_f32_16x16x32_bf16 v[48:51], v[184:187], v[80:83], v[48:51]
    v_mfma_f32_16x16x32_bf16 v[56:59], v[248:251], v[80:83], v[56:59]
    s_waitcnt lgkmcnt(2)
    v_mfma_f32_16x16x32_bf16 v[52:55], v[184:187], v[84:87], v[52:55]
    v_mfma_f32_16x16x32_bf16 v[60:63], v[248:251], v[84:87], v[60:63]
    s_waitcnt lgkmcnt(1)
    v_mfma_f32_16x16x32_bf16 v[48:51], v[188:191], v[88:91], v[48:51]
    v_mfma_f32_16x16x32_bf16 v[56:59], v[252:255], v[88:91], v[56:59]
    s_waitcnt lgkmcnt(0)
    v_mfma_f32_16x16x32_bf16 v[52:55], v[188:191], v[92:95], v[52:55]
    v_mfma_f32_16x16x32_bf16 v[60:63], v[252:255], v[92:95], v[60:63]
    s_nop 4
    v_cvt_pk_bf16_f32 v112, v48, v56
    v_cvt_pk_bf16_f32 v113, v49, v57
    v_cvt_pk_bf16_f32 v114, v50, v58
    v_cvt_pk_bf16_f32 v115, v51, v59
    buffer_store_dwordx4 v[112:115], v3, s[4:7], s30 offen sc1
    v_cvt_pk_bf16_f32 v116, v52, v60
    v_cvt_pk_bf16_f32 v117, v53, v61
    v_cvt_pk_bf16_f32 v118, v54, v62
    v_cvt_pk_bf16_f32 v119, v55, v63
    buffer_store_dwordx4 v[116:119], v3, s[4:7], s43 offen sc1
    s_add_u32 s23, s23, 2
    s_add_u32 s25, s25, 1
    s_branch L_p1_loop
L_p1_end:
    s_waitcnt vmcnt(0)
    s_barrier
    s_cmp_lg_u32 s15, 0
    s_cbranch_scc1 L_p1_nf2
    v_mov_b32 v7, 33
    s_mov_b64 exec, 1
    buffer_store_dword v7, off, s[4:7], s31 sc1
    s_mov_b64 exec, -1
L_p1_nf2:
    s_branch L_p2
L_grp:
    s_cmp_ge_u32 s14, 96
    s_cbranch_scc1 L_ln
L_mod_top:
    v_lshrrev_b32 v4, 2, v0
    s_lshl_b32 s40, s15, 4
    v_add_u32 v4, s40, v4
    v_lshlrev_b32 v5, 1, v4
    v_mul_u32_u24 v4, 6144, v4
    v_and_b32 v6, 3, v0
    v_lshl_add_u32 v4, v6, 4, v4
    s_mov_b32 s8, s74
    s_mov_b32 s9, s75
    s_mov_b32 s10, 3145728
    global_load_ushort v48, v5, s[72:73] offset:0
    global_load_ushort v49, v5, s[72:73] offset:128
    global_load_ushort v50, v5, s[72:73] offset:256
    global_load_ushort v51, v5, s[72:73] offset:384
    global_load_ushort v52, v5, s[72:73] offset:512
    global_load_ushort v53, v5, s[72:73] offset:640
    global_load_ushort v54, v5, s[72:73] offset:768
    global_load_ushort v55, v5, s[72:73] offset:896
    s_lshl_b32 s40, s39, 6
    buffer_load_dwordx4 v[16:19], v4, s[8:11], s40 offen
    s_add_u32 s40, s40, 393216
    buffer_load_dwordx4 v[20:23], v4, s[8:11], s40 offen
    s_add_u32 s40, s40, 393216
    buffer_load_dwordx4 v[24:27], v4, s[8:11], s40 offen
    s_add_u32 s40, s40, 393216
    buffer_load_dwordx4 v[28:31], v4, s[8:11], s40 offen
    s_add_u32 s40, s40, 393216
    buffer_load_dwordx4 v[32:35], v4, s[8:11], s40 offen
    s_add_u32 s40, s40, 393216
    buffer_load_dwordx4 v[36:39], v4, s[8:11], s40 offen
    s_add_u32 s40, s40, 393216
    buffer_load_dwordx4 v[40:43], v4, s[8:11], s40 offen
    s_add_u32 s40, s40, 393216
    buffer_load_dwordx4 v[44:47], v4, s[8:11], s40 offen
    s_add_u32 s40, s40, 393216
    v_mov_b32 v10, 140
    global_load_dword v10, v10, s[12:13] sc1
    s_waitcnt vmcnt(16)
    v_lshlrev_b32 v48, 16, v48
    s_waitcnt vmcnt(15)
    v_lshlrev_b32 v49, 16, v49
    s_waitcnt vmcnt(14)
    v_lshlrev_b32 v50, 16, v50
    s_waitcnt vmcnt(13)
    v_lshlrev_b32 v51, 16, v51
    s_waitcnt vmcnt(12)
    v_lshlrev_b32 v52, 16, v52
    s_waitcnt vmcnt(11)
    v_lshlrev_b32 v53, 16, v53
    s_waitcnt vmcnt(10)
    v_lshlrev_b32 v54, 16, v54
    s_waitcnt vmcnt(9)
    v_lshlrev_b32 v55, 16, v55
    v_mul_f32 v56, 0xbfb8aa3b, v48
    v_mul_f32 v57, 0xbfb8aa3b, v49
    v_mul_f32 v58, 0xbfb8aa3b, v50
    v_mul_f32 v59, 0xbfb8aa3b, v51
    v_mul_f32 v60, 0xbfb8aa3b, v52
    v_mul_f32 v61, 0xbfb8aa3b, v53
    v_mul_f32 v62, 0xbfb8aa3b, v54
    v_mul_f32 v63, 0xbfb8aa3b, v55
    v_exp_f32 v56, v56
    v_exp_f32 v57, v57
    v_exp_f32 v58, v58
    v_exp_f32 v59, v59
    v_exp_f32 v60, v60
    v_exp_f32 v61, v61
    v_exp_f32 v62, v62
    v_exp_f32 v63, v63
    v_add_f32 v56, 1.0, v56
    v_add_f32 v57, 1.0, v57
    v_add_f32 v58, 1.0, v58
    v_add_f32 v59, 1.0, v59
    v_add_f32 v60, 1.0, v60
    v_add_f32 v61, 1.0, v61
    v_add_f32 v62, 1.0, v62
    v_add_f32 v63, 1.0, v63
    v_rcp_f32 v56, v56
    v_rcp_f32 v57, v57
    v_rcp_f32 v58, v58
    v_rcp_f32 v59, v59
    v_rcp_f32 v60, v60
    v_rcp_f32 v61, v61
    v_rcp_f32 v62, v62
    v_rcp_f32 v63, v63
    v_mul_f32 v48, v48, v56
    v_mul_f32 v49, v49, v57
    v_mul_f32 v50, v50, v58
    v_mul_f32 v51, v51, v59
    v_mul_f32 v52, v52, v60
    v_mul_f32 v53, v53, v61
    v_mul_f32 v54, v54, v62
    v_mul_f32 v55, v55, v63
    v_cvt_pk_bf16_f32 v6, v48, v49
    v_lshlrev_b32 v48, 16, v6
    v_and_b32 v49, s16, v6
    v_cvt_pk_bf16_f32 v6, v50, v51
    v_lshlrev_b32 v50, 16, v6
    v_and_b32 v51, s16, v6
    v_cvt_pk_bf16_f32 v6, v52, v53
    v_lshlrev_b32 v52, 16, v6
    v_and_b32 v53, s16, v6
    v_cvt_pk_bf16_f32 v6, v54, v55
    v_lshlrev_b32 v54, 16, v6
    v_and_b32 v55, s16, v6
    s_waitcnt vmcnt(8)
    v_and_b32 v9, s16, v16
    v_lshlrev_b32 v8, 16, v16
    v_mul_f32 v56, v48, v8
    v_mul_f32 v57, v48, v9
    v_and_b32 v9, s16, v17
    v_lshlrev_b32 v8, 16, v17
    v_mul_f32 v58, v48, v8
    v_mul_f32 v59, v48, v9
    v_and_b32 v9, s16, v18
    v_lshlrev_b32 v8, 16, v18
    v_mul_f32 v60, v48, v8
    v_mul_f32 v61, v48, v9
    v_and_b32 v9, s16, v19
    v_lshlrev_b32 v8, 16, v19
    v_mul_f32 v62, v48, v8
    v_mul_f32 v63, v48, v9
    s_waitcnt vmcnt(7)
    v_and_b32 v9, s16, v20
    v_lshlrev_b32 v8, 16, v20
    v_fmac_f32 v56, v49, v8
    v_fmac_f32 v57, v49, v9
    v_and_b32 v9, s16, v21
    v_lshlrev_b32 v8, 16, v21
    v_fmac_f32 v58, v49, v8
    v_fmac_f32 v59, v49, v9
    v_and_b32 v9, s16, v22
    v_lshlrev_b32 v8, 16, v22
    v_fmac_f32 v60, v49, v8
    v_fmac_f32 v61, v49, v9
    v_and_b32 v9, s16, v23
    v_lshlrev_b32 v8, 16, v23
    v_fmac_f32 v62, v49, v8
    v_fmac_f32 v63, v49, v9
    s_waitcnt vmcnt(6)
    v_and_b32 v9, s16, v24
    v_lshlrev_b32 v8, 16, v24
    v_fmac_f32 v56, v50, v8
    v_fmac_f32 v57, v50, v9
    v_and_b32 v9, s16, v25
    v_lshlrev_b32 v8, 16, v25
    v_fmac_f32 v58, v50, v8
    v_fmac_f32 v59, v50, v9
    v_and_b32 v9, s16, v26
    v_lshlrev_b32 v8, 16, v26
    v_fmac_f32 v60, v50, v8
    v_fmac_f32 v61, v50, v9
    v_and_b32 v9, s16, v27
    v_lshlrev_b32 v8, 16, v27
    v_fmac_f32 v62, v50, v8
    v_fmac_f32 v63, v50, v9
    s_waitcnt vmcnt(5)
    v_and_b32 v9, s16, v28
    v_lshlrev_b32 v8, 16, v28
    v_fmac_f32 v56, v51, v8
    v_fmac_f32 v57, v51, v9
    v_and_b32 v9, s16, v29
    v_lshlrev_b32 v8, 16, v29
    v_fmac_f32 v58, v51, v8
    v_fmac_f32 v59, v51, v9
    v_and_b32 v9, s16, v30
    v_lshlrev_b32 v8, 16, v30
    v_fmac_f32 v60, v51, v8
    v_fmac_f32 v61, v51, v9
    v_and_b32 v9, s16, v31
    v_lshlrev_b32 v8, 16, v31
    v_fmac_f32 v62, v51, v8
    v_fmac_f32 v63, v51, v9
    s_waitcnt vmcnt(4)
    v_and_b32 v9, s16, v32
    v_lshlrev_b32 v8, 16, v32
    v_fmac_f32 v56, v52, v8
    v_fmac_f32 v57, v52, v9
    v_and_b32 v9, s16, v33
    v_lshlrev_b32 v8, 16, v33
    v_fmac_f32 v58, v52, v8
    v_fmac_f32 v59, v52, v9
    v_and_b32 v9, s16, v34
    v_lshlrev_b32 v8, 16, v34
    v_fmac_f32 v60, v52, v8
    v_fmac_f32 v61, v52, v9
    v_and_b32 v9, s16, v35
    v_lshlrev_b32 v8, 16, v35
    v_fmac_f32 v62, v52, v8
    v_fmac_f32 v63, v52, v9
    s_waitcnt vmcnt(3)
    v_and_b32 v9, s16, v36
    v_lshlrev_b32 v8, 16, v36
    v_fmac_f32 v56, v53, v8
    v_fmac_f32 v57, v53, v9
    v_and_b32 v9, s16, v37
    v_lshlrev_b32 v8, 16, v37
    v_fmac_f32 v58, v53, v8
    v_fmac_f32 v59, v53, v9
    v_and_b32 v9, s16, v38
    v_lshlrev_b32 v8, 16, v38
    v_fmac_f32 v60, v53, v8
    v_fmac_f32 v61, v53, v9
    v_and_b32 v9, s16, v39
    v_lshlrev_b32 v8, 16, v39
    v_fmac_f32 v62, v53, v8
    v_fmac_f32 v63, v53, v9
    s_waitcnt vmcnt(2)
    v_and_b32 v9, s16, v40
    v_lshlrev_b32 v8, 16, v40
    v_fmac_f32 v56, v54, v8
    v_fmac_f32 v57, v54, v9
    v_and_b32 v9, s16, v41
    v_lshlrev_b32 v8, 16, v41
    v_fmac_f32 v58, v54, v8
    v_fmac_f32 v59, v54, v9
    v_and_b32 v9, s16, v42
    v_lshlrev_b32 v8, 16, v42
    v_fmac_f32 v60, v54, v8
    v_fmac_f32 v61, v54, v9
    v_and_b32 v9, s16, v43
    v_lshlrev_b32 v8, 16, v43
    v_fmac_f32 v62, v54, v8
    v_fmac_f32 v63, v54, v9
    s_waitcnt vmcnt(1)
    v_and_b32 v9, s16, v44
    v_lshlrev_b32 v8, 16, v44
    v_fmac_f32 v56, v55, v8
    v_fmac_f32 v57, v55, v9
    v_and_b32 v9, s16, v45
    v_lshlrev_b32 v8, 16, v45
    v_fmac_f32 v58, v55, v8
    v_fmac_f32 v59, v55, v9
    v_and_b32 v9, s16, v46
    v_lshlrev_b32 v8, 16, v46
    v_fmac_f32 v60, v55, v8
    v_fmac_f32 v61, v55, v9
    v_and_b32 v9, s16, v47
    v_lshlrev_b32 v8, 16, v47
    v_fmac_f32 v62, v55, v8
    v_fmac_f32 v63, v55, v9
    v_add_f32_dpp v56, v56, v56 row_ror:4 row_mask:0xf bank_mask:0xf
    v_add_f32_dpp v57, v57, v57 row_ror:4 row_mask:0xf bank_mask:0xf
    v_add_f32_dpp v58, v58, v58 row_ror:4 row_mask:0xf bank_mask:0xf
    v_add_f32_dpp v59, v59, v59 row_ror:4 row_mask:0xf bank_mask:0xf
    v_add_f32_dpp v60, v60, v60 row_ror:4 row_mask:0xf bank_mask:0xf
    v_add_f32_dpp v61, v61, v61 row_ror:4 row_mask:0xf bank_mask:0xf
    v_add_f32_dpp v62, v62, v62 row_ror:4 row_mask:0xf bank_mask:0xf
    v_add_f32_dpp v63, v63, v63 row_ror:4 row_mask:0xf bank_mask:0xf
    v_add_f32_dpp v56, v56, v56 row_ror:8 row_mask:0xf bank_mask:0xf
    v_add_f32_dpp v57, v57, v57 row_ror:8 row_mask:0xf bank_mask:0xf
    v_add_f32_dpp v58, v58, v58 row_ror:8 row_mask:0xf bank_mask:0xf
    v_add_f32_dpp v59, v59, v59 row_ror:8 row_mask:0xf bank_mask:0xf
    v_add_f32_dpp v60, v60, v60 row_ror:8 row_mask:0xf bank_mask:0xf
    v_add_f32_dpp v61, v61, v61 row_ror:8 row_mask:0xf bank_mask:0xf
    v_add_f32_dpp v62, v62, v62 row_ror:8 row_mask:0xf bank_mask:0xf
    v_add_f32_dpp v63, v63, v63 row_ror:8 row_mask:0xf bank_mask:0xf
L_vfm:
    s_waitcnt vmcnt(0)
    v_readfirstlane_b32 s40, v10
    s_add_u32 s17, s17, 1
    s_cmp_gt_u32 s17, 0x200000
    s_cbranch_scc1 L_vxm
    s_cmp_lg_u32 s40, 0
    s_cbranch_scc1 L_vgm
    v_mov_b32 v10, 140
    global_load_dword v10, v10, s[12:13] sc1
    s_waitcnt vmcnt(0)
    s_branch L_vfm
L_vgm:
    s_sub_u32 s40, s40, 1
    s_and_b32 s40, s40, 7
    s_cmp_eq_u32 s40, s101
    s_cbranch_scc1 L_vxm
    s_mov_b32 s101, s40
    s_branch L_restart
L_vxm:
    s_lshl_b32 s40, s15, 9
    v_and_b32 v6, 3, v0
    v_lshlrev_b32 v6, 5, v6
    v_lshl_add_u32 v6, v2, 7, v6
    v_add_u32 v6, s40, v6
    ds_write_b128 v6, v[56:59]
    ds_write_b128 v6, v[60:63] offset:16
    s_waitcnt lgkmcnt(0)
    s_barrier
    s_cmp_lg_u32 s15, 0
    s_cbranch_scc1 L_mod_end
    v_and_b32 v4, 31, v0
    v_lshrrev_b32 v5, 5, v0
    v_lshlrev_b32 v6, 2, v4
    v_lshl_add_u32 v6, v5, 10, v6
    ds_read_b32 v56, v6 offset:0
    ds_read_b32 v57, v6 offset:128
    ds_read_b32 v58, v6 offset:256
    ds_read_b32 v59, v6 offset:384
    ds_read_b32 v60, v6 offset:512
    ds_read_b32 v61, v6 offset:640
    ds_read_b32 v62, v6 offset:768
    ds_read_b32 v63, v6 offset:896
    s_waitcnt lgkmcnt(6)
    v_add_f32 v56, v56, v57
    s_waitcnt lgkmcnt(5)
    v_add_f32 v56, v56, v58
    s_waitcnt lgkmcnt(4)
    v_add_f32 v56, v56, v59
    s_waitcnt lgkmcnt(3)
    v_add_f32 v56, v56, v60
    s_waitcnt lgkmcnt(2)
    v_add_f32 v56, v56, v61
    s_waitcnt lgkmcnt(1)
    v_add_f32 v56, v56, v62
    s_waitcnt lgkmcnt(0)
    v_add_f32 v56, v56, v63
    v_mov_b32 v6, v56
    s_nop 1
    v_permlane32_swap_b32 v56, v6
    v_add_f32 v56, v56, v6
    v_cvt_pk_bf16_f32 v56, v56, v56
    v_lshlrev_b32 v4, 1, v4
    s_lshl_b32 s40, s39, 6
    s_add_u32 s40, s40, 81788928
    buffer_store_short v56, v4, s[4:7], s40 offen sc1
    s_waitcnt vmcnt(0)
    s_cmp_lt_u32 s39, 32
    s_cselect_b32 s40, 0, 4
    v_mov_b32 v4, s40
    v_mov_b32 v5, 1
    s_mov_b64 exec, 1
    global_atomic_add v4, v5, s[12:13] offset:128
    s_mov_b64 exec, -1
L_mod_end:
    s_barrier
    s_cmp_ge_u32 s39, 32
    s_cbranch_scc1 L_mod_np
    v_lshlrev_b32 v99, 10, v2
    v_lshl_add_u32 v99, v1, 4, v99
    s_lshl_b32 s43, s39, 2
    s_add_u32 s43, s43, s15
    s_lshl_b32 s43, s43, 12
    s_mov_b32 s8, s58
    s_mov_b32 s9, s59
    s_mov_b32 s10, 4194304
    s_add_u32 s44, s43, 0
    buffer_load_dwordx4 v[100:103], v99, s[8:11], s44 offen offset:256
    s_add_u32 s44, s43, 524288
    buffer_load_dwordx4 v[100:103], v99, s[8:11], s44 offen offset:256
    s_add_u32 s44, s43, 1048576
    buffer_load_dwordx4 v[100:103], v99, s[8:11], s44 offen offset:256
    s_add_u32 s44, s43, 1572864
    buffer_load_dwordx4 v[100:103], v99, s[8:11], s44 offen offset:256
    s_add_u32 s44, s43, 2097152
    buffer_load_dwordx4 v[100:103], v99, s[8:11], s44 offen offset:256
    s_add_u32 s44, s43, 2621440
    buffer_load_dwordx4 v[100:103], v99, s[8:11], s44 offen offset:256
    s_add_u32 s44, s43, 3145728
    buffer_load_dwordx4 v[100:103], v99, s[8:11], s44 offen offset:256
    s_add_u32 s44, s43, 3670016
    buffer_load_dwordx4 v[100:103], v99, s[8:11], s44 offen offset:256
    s_mov_b32 s8, s60
    s_mov_b32 s9, s61
    s_mov_b32 s10, 4194304
    s_add_u32 s44, s43, 0
    buffer_load_dwordx4 v[100:103], v99, s[8:11], s44 offen offset:256
    s_add_u32 s44, s43, 524288
    buffer_load_dwordx4 v[100:103], v99, s[8:11], s44 offen offset:256
    s_add_u32 s44, s43, 1048576
    buffer_load_dwordx4 v[100:103], v99, s[8:11], s44 offen offset:256
    s_add_u32 s44, s43, 1572864
    buffer_load_dwordx4 v[100:103], v99, s[8:11], s44 offen offset:256
    s_add_u32 s44, s43, 2097152
    buffer_load_dwordx4 v[100:103], v99, s[8:11], s44 offen offset:256
    s_add_u32 s44, s43, 2621440
    buffer_load_dwordx4 v[100:103], v99, s[8:11], s44 offen offset:256
    s_add_u32 s44, s43, 3145728
    buffer_load_dwordx4 v[100:103], v99, s[8:11], s44 offen offset:256
    s_add_u32 s44, s43, 3670016
    buffer_load_dwordx4 v[100:103], v99, s[8:11], s44 offen offset:256
    s_mov_b32 s8, s56
    s_mov_b32 s9, s57
    s_mov_b32 s10, 4194304
    s_add_u32 s44, s43, 0
    buffer_load_dwordx4 v[100:103], v99, s[8:11], s44 offen offset:256
    s_add_u32 s44, s43, 524288
    buffer_load_dwordx4 v[100:103], v99, s[8:11], s44 offen offset:256
    s_add_u32 s44, s43, 1048576
    buffer_load_dwordx4 v[100:103], v99, s[8:11], s44 offen offset:256
    s_add_u32 s44, s43, 1572864
    buffer_load_dwordx4 v[100:103], v99, s[8:11], s44 offen offset:256
    s_add_u32 s44, s43, 2097152
    buffer_load_dwordx4 v[100:103], v99, s[8:11], s44 offen offset:256
    s_add_u32 s44, s43, 2621440
    buffer_load_dwordx4 v[100:103], v99, s[8:11], s44 offen offset:256
    s_add_u32 s44, s43, 3145728
    buffer_load_dwordx4 v[100:103], v99, s[8:11], s44 offen offset:256
    s_add_u32 s44, s43, 3670016
    buffer_load_dwordx4 v[100:103], v99, s[8:11], s44 offen offset:256
L_mod_np:
    s_add_u32 s39, s39, 32
    s_cmp_lt_u32 s39, 96
    s_cbranch_scc1 L_mod_top
    s_branch L_p2
L_ln:
    s_sub_u32 s20, s14, 96
    s_mov_b32 s8, s52
    s_mov_b32 s9, s53
    s_mov_b32 s10, 2097152
    v_lshlrev_b32 v4, 10, v1
    v_lshl_add_u32 v4, v2, 4, v4
    s_lshl_b32 s40, s20, 14
    s_lshl_b32 s41, s15, 8
    s_add_u32 s40, s40, s41
    buffer_load_dwordx4 v[16:19], v4, s[8:11], s40 offen offset:0
    buffer_load_dwordx4 v[20:23], v4, s[8:11], s40 offen offset:64
    buffer_load_dwordx4 v[24:27], v4, s[8:11], s40 offen offset:128
    buffer_load_dwordx4 v[28:31], v4, s[8:11], s40 offen offset:192
    v_mov_b32 v9, 140
    global_load_dword v9, v9, s[12:13] sc1
    v_lshlrev_b32 v5, 4, v1
    s_lshl_b32 s42, s15, 2
    v_add_u32 v4, s42, v5
    s_waitcnt vmcnt(4)
    v_and_b32 v33, s16, v16
    v_lshlrev_b32 v32, 16, v16
    v_and_b32 v35, s16, v17
    v_lshlrev_b32 v34, 16, v17
    v_and_b32 v37, s16, v18
    v_lshlrev_b32 v36, 16, v18
    v_and_b32 v39, s16, v19
    v_lshlrev_b32 v38, 16, v19
    s_waitcnt vmcnt(3)
    v_and_b32 v41, s16, v20
    v_lshlrev_b32 v40, 16, v20
    v_and_b32 v43, s16, v21
    v_lshlrev_b32 v42, 16, v21
    v_and_b32 v45, s16, v22
    v_lshlrev_b32 v44, 16, v22
    v_and_b32 v47, s16, v23
    v_lshlrev_b32 v46, 16, v23
    s_waitcnt vmcnt(2)
    v_and_b32 v49, s16, v24
    v_lshlrev_b32 v48, 16, v24
    v_and_b32 v51, s16, v25
    v_lshlrev_b32 v50, 16, v25
    v_and_b32 v53, s16, v26
    v_lshlrev_b32 v52, 16, v26
    v_and_b32 v55, s16, v27
    v_lshlrev_b32 v54, 16, v27
    s_waitcnt vmcnt(1)
    v_and_b32 v57, s16, v28
    v_lshlrev_b32 v56, 16, v28
    v_and_b32 v59, s16, v29
    v_lshlrev_b32 v58, 16, v29
    v_and_b32 v61, s16, v30
    v_lshlrev_b32 v60, 16, v30
    v_and_b32 v63, s16, v31
    v_lshlrev_b32 v62, 16, v31
    v_add_f32 v7, v32, v33
    v_add_f32 v7, v7, v34
    v_add_f32 v7, v7, v35
    v_add_f32 v7, v7, v36
    v_add_f32 v7, v7, v37
    v_add_f32 v7, v7, v38
    v_add_f32 v7, v7, v39
    v_add_f32 v7, v7, v40
    v_add_f32 v7, v7, v41
    v_add_f32 v7, v7, v42
    v_add_f32 v7, v7, v43
    v_add_f32 v7, v7, v44
    v_add_f32 v7, v7, v45
    v_add_f32 v7, v7, v46
    v_add_f32 v7, v7, v47
    v_add_f32 v7, v7, v48
    v_add_f32 v7, v7, v49
    v_add_f32 v7, v7, v50
    v_add_f32 v7, v7, v51
    v_add_f32 v7, v7, v52
    v_add_f32 v7, v7, v53
    v_add_f32 v7, v7, v54
    v_add_f32 v7, v7, v55
    v_add_f32 v7, v7, v56
    v_add_f32 v7, v7, v57
    v_add_f32 v7, v7, v58
    v_add_f32 v7, v7, v59
    v_add_f32 v7, v7, v60
    v_add_f32 v7, v7, v61
    v_add_f32 v7, v7, v62
    v_add_f32 v7, v7, v63
L_vfl:
    s_waitcnt vmcnt(0)
    v_readfirstlane_b32 s43, v9
    s_add_u32 s17, s17, 1
    s_cmp_gt_u32 s17, 0x200000
    s_cbranch_scc1 L_vxl
    s_cmp_lg_u32 s43, 0
    s_cbranch_scc1 L_vgl
    v_mov_b32 v9, 140
    global_load_dword v9, v9, s[12:13] sc1
    s_waitcnt vmcnt(0)
    s_branch L_vfl
L_vgl:
    s_sub_u32 s43, s43, 1
    s_and_b32 s43, s43, 7
    s_cmp_eq_u32 s43, s101
    s_cbranch_scc1 L_vxl
    s_mov_b32 s101, s43
    s_branch L_restart
L_vxl:
    s_cmp_lg_u32 s14, 223
    s_cbranch_scc1 L_ln2
    v_mov_b32 v108, 0
    v_mov_b32 v109, 0
    v_mov_b32 v110, 0
    v_mov_b32 v111, 0
    s_lshl_b32 s45, s15, 12
    s_add_u32 s45, s45, 80871424
    buffer_store_dwordx4 v[108:111], v3, s[4:7], s45 offen offset:0 sc1
    buffer_store_dwordx4 v[108:111], v3, s[4:7], s45 offen offset:1024 sc1
    buffer_store_dwordx4 v[108:111], v3, s[4:7], s45 offen offset:2048 sc1
    buffer_store_dwordx4 v[108:111], v3, s[4:7], s45 offen offset:3072 sc1
    s_mov_b32 s45, 80805888
    buffer_store_dwordx4 v[108:111], v3, s[4:7], s45 offen sc1
    v_mov_b32 v112, -1
    v_mov_b32 v113, -1
    v_mov_b32 v114, -1
    v_mov_b32 v115, -1
    s_lshl_b32 s45, s15, 13
    s_add_u32 s45, s45, 80740352
    s_add_u32 s46, s45, 4096
    buffer_store_dwordx4 v[112:115], v3, s[4:7], s45 offen offset:0 sc1
    buffer_store_dwordx4 v[112:115], v3, s[4:7], s45 offen offset:1024 sc1
    buffer_store_dwordx4 v[112:115], v3, s[4:7], s45 offen offset:2048 sc1
    buffer_store_dwordx4 v[112:115], v3, s[4:7], s45 offen offset:3072 sc1
    buffer_store_dwordx4 v[112:115], v3, s[4:7], s46 offen offset:0 sc1
    buffer_store_dwordx4 v[112:115], v3, s[4:7], s46 offen offset:1024 sc1
    buffer_store_dwordx4 v[112:115], v3, s[4:7], s46 offen offset:2048 sc1
    buffer_store_dwordx4 v[112:115], v3, s[4:7], s46 offen offset:3072 sc1
    s_waitcnt vmcnt(0)
    s_barrier
    v_mov_b32 v108, 136
    v_mov_b32 v109, 1
    s_mov_b64 exec, 1
    global_store_dword v108, v109, s[12:13] sc1
    s_mov_b64 exec, -1
L_ln2:
    v_mov_b32 v104, -1
    v_mov_b32 v105, -1
    v_mov_b32 v106, -1
    v_mov_b32 v107, -1
    s_lshl_b32 s43, s20, 2
    s_add_u32 s43, s43, s15
    s_lshl_b32 s43, s43, 11
    s_add_u32 s43, s43, 79691776
    buffer_store_dwordx4 v[104:107], v3, s[4:7], s43 offen offset:0 sc1
    buffer_store_dwordx4 v[104:107], v3, s[4:7], s43 offen offset:1024 sc1
    v_mov_b32 v6, v7
    s_nop 1
    v_permlane32_swap_b32 v7, v6
    v_add_f32 v7, v7, v6
    v_mov_b32 v6, v7
    s_nop 1
    v_permlane16_swap_b32 v7, v6
    v_add_f32 v7, v7, v6
    ds_write_b32 v4, v7 offset:0
    s_waitcnt lgkmcnt(0)
    s_barrier
    ds_read_b128 v[10:13], v5 offset:0
    s_waitcnt lgkmcnt(0)
    v_add_f32 v7, v10, v11
    v_add_f32 v6, v12, v13
    v_add_f32 v7, v7, v6
    v_mul_f32 v7, 0x3b000000, v7
    v_mov_b32 v14, v7
    v_sub_f32 v6, v32, v14
    v_mul_f32 v7, v6, v6
    v_sub_f32 v6, v33, v14
    v_fmac_f32 v7, v6, v6
    v_sub_f32 v6, v34, v14
    v_fmac_f32 v7, v6, v6
    v_sub_f32 v6, v35, v14
    v_fmac_f32 v7, v6, v6
    v_sub_f32 v6, v36, v14
    v_fmac_f32 v7, v6, v6
    v_sub_f32 v6, v37, v14
    v_fmac_f32 v7, v6, v6
    v_sub_f32 v6, v38, v14
    v_fmac_f32 v7, v6, v6
    v_sub_f32 v6, v39, v14
    v_fmac_f32 v7, v6, v6
    v_sub_f32 v6, v40, v14
    v_fmac_f32 v7, v6, v6
    v_sub_f32 v6, v41, v14
    v_fmac_f32 v7, v6, v6
    v_sub_f32 v6, v42, v14
    v_fmac_f32 v7, v6, v6
    v_sub_f32 v6, v43, v14
    v_fmac_f32 v7, v6, v6
    v_sub_f32 v6, v44, v14
    v_fmac_f32 v7, v6, v6
    v_sub_f32 v6, v45, v14
    v_fmac_f32 v7, v6, v6
    v_sub_f32 v6, v46, v14
    v_fmac_f32 v7, v6, v6
    v_sub_f32 v6, v47, v14
    v_fmac_f32 v7, v6, v6
    v_sub_f32 v6, v48, v14
    v_fmac_f32 v7, v6, v6
    v_sub_f32 v6, v49, v14
    v_fmac_f32 v7, v6, v6
    v_sub_f32 v6, v50, v14
    v_fmac_f32 v7, v6, v6
    v_sub_f32 v6, v51, v14
    v_fmac_f32 v7, v6, v6
    v_sub_f32 v6, v52, v14
    v_fmac_f32 v7, v6, v6
    v_sub_f32 v6, v53, v14
    v_fmac_f32 v7, v6, v6
    v_sub_f32 v6, v54, v14
    v_fmac_f32 v7, v6, v6
    v_sub_f32 v6, v55, v14
    v_fmac_f32 v7, v6, v6
    v_sub_f32 v6, v56, v14
    v_fmac_f32 v7, v6, v6
    v_sub_f32 v6, v57, v14
    v_fmac_f32 v7, v6, v6
    v_sub_f32 v6, v58, v14
    v_fmac_f32 v7, v6, v6
    v_sub_f32 v6, v59, v14
    v_fmac_f32 v7, v6, v6
    v_sub_f32 v6, v60, v14
    v_fmac_f32 v7, v6, v6
    v_sub_f32 v6, v61, v14
    v_fmac_f32 v7, v6, v6
    v_sub_f32 v6, v62, v14
    v_fmac_f32 v7, v6, v6
    v_sub_f32 v6, v63, v14
    v_fmac_f32 v7, v6, v6
    v_mov_b32 v6, v7
    s_nop 1
    v_permlane32_swap_b32 v7, v6
    v_add_f32 v7, v7, v6
    v_mov_b32 v6, v7
    s_nop 1
    v_permlane16_swap_b32 v7, v6
    v_add_f32 v7, v7, v6
    ds_write_b32 v4, v7 offset:256
    s_waitcnt lgkmcnt(0)
    s_barrier
    ds_read_b128 v[10:13], v5 offset:256
    s_waitcnt lgkmcnt(0)
    v_add_f32 v7, v10, v11
    v_add_f32 v6, v12, v13
    v_add_f32 v7, v7, v6
    v_mul_f32 v7, 0x3b000000, v7
    v_cvt_pk_bf16_f32 v6, v14, v7
    v_lshlrev_b32 v14, 16, v6
    v_and_b32 v7, s16, v6
    v_add_f32 v7, 0x3727c5ac, v7
    v_cvt_pk_bf16_f32 v6, v7, v8
    v_lshlrev_b32 v7, 16, v6
    v_sqrt_f32 v7, v7
    s_nop 0
    v_cvt_pk_bf16_f32 v6, v7, v8
    v_lshlrev_b32 v7, 16, v6
    v_rcp_f32 v7, v7
    v_sub_f32 v32, v32, v14
    v_sub_f32 v33, v33, v14
    v_cvt_pk_bf16_f32 v6, v32, v33
    v_lshlrev_b32 v32, 16, v6
    v_and_b32 v33, s16, v6
    v_mul_f32 v32, v32, v7
    v_mul_f32 v33, v33, v7
    v_cvt_pk_bf16_f32 v6, v32, v33
    v_lshlrev_b32 v32, 16, v6
    v_and_b32 v33, s16, v6
    v_sub_f32 v34, v34, v14
    v_sub_f32 v35, v35, v14
    v_cvt_pk_bf16_f32 v6, v34, v35
    v_lshlrev_b32 v34, 16, v6
    v_and_b32 v35, s16, v6
    v_mul_f32 v34, v34, v7
    v_mul_f32 v35, v35, v7
    v_cvt_pk_bf16_f32 v6, v34, v35
    v_lshlrev_b32 v34, 16, v6
    v_and_b32 v35, s16, v6
    v_sub_f32 v36, v36, v14
    v_sub_f32 v37, v37, v14
    v_cvt_pk_bf16_f32 v6, v36, v37
    v_lshlrev_b32 v36, 16, v6
    v_and_b32 v37, s16, v6
    v_mul_f32 v36, v36, v7
    v_mul_f32 v37, v37, v7
    v_cvt_pk_bf16_f32 v6, v36, v37
    v_lshlrev_b32 v36, 16, v6
    v_and_b32 v37, s16, v6
    v_sub_f32 v38, v38, v14
    v_sub_f32 v39, v39, v14
    v_cvt_pk_bf16_f32 v6, v38, v39
    v_lshlrev_b32 v38, 16, v6
    v_and_b32 v39, s16, v6
    v_mul_f32 v38, v38, v7
    v_mul_f32 v39, v39, v7
    v_cvt_pk_bf16_f32 v6, v38, v39
    v_lshlrev_b32 v38, 16, v6
    v_and_b32 v39, s16, v6
    v_sub_f32 v40, v40, v14
    v_sub_f32 v41, v41, v14
    v_cvt_pk_bf16_f32 v6, v40, v41
    v_lshlrev_b32 v40, 16, v6
    v_and_b32 v41, s16, v6
    v_mul_f32 v40, v40, v7
    v_mul_f32 v41, v41, v7
    v_cvt_pk_bf16_f32 v6, v40, v41
    v_lshlrev_b32 v40, 16, v6
    v_and_b32 v41, s16, v6
    v_sub_f32 v42, v42, v14
    v_sub_f32 v43, v43, v14
    v_cvt_pk_bf16_f32 v6, v42, v43
    v_lshlrev_b32 v42, 16, v6
    v_and_b32 v43, s16, v6
    v_mul_f32 v42, v42, v7
    v_mul_f32 v43, v43, v7
    v_cvt_pk_bf16_f32 v6, v42, v43
    v_lshlrev_b32 v42, 16, v6
    v_and_b32 v43, s16, v6
    v_sub_f32 v44, v44, v14
    v_sub_f32 v45, v45, v14
    v_cvt_pk_bf16_f32 v6, v44, v45
    v_lshlrev_b32 v44, 16, v6
    v_and_b32 v45, s16, v6
    v_mul_f32 v44, v44, v7
    v_mul_f32 v45, v45, v7
    v_cvt_pk_bf16_f32 v6, v44, v45
    v_lshlrev_b32 v44, 16, v6
    v_and_b32 v45, s16, v6
    v_sub_f32 v46, v46, v14
    v_sub_f32 v47, v47, v14
    v_cvt_pk_bf16_f32 v6, v46, v47
    v_lshlrev_b32 v46, 16, v6
    v_and_b32 v47, s16, v6
    v_mul_f32 v46, v46, v7
    v_mul_f32 v47, v47, v7
    v_cvt_pk_bf16_f32 v6, v46, v47
    v_lshlrev_b32 v46, 16, v6
    v_and_b32 v47, s16, v6
    v_sub_f32 v48, v48, v14
    v_sub_f32 v49, v49, v14
    v_cvt_pk_bf16_f32 v6, v48, v49
    v_lshlrev_b32 v48, 16, v6
    v_and_b32 v49, s16, v6
    v_mul_f32 v48, v48, v7
    v_mul_f32 v49, v49, v7
    v_cvt_pk_bf16_f32 v6, v48, v49
    v_lshlrev_b32 v48, 16, v6
    v_and_b32 v49, s16, v6
    v_sub_f32 v50, v50, v14
    v_sub_f32 v51, v51, v14
    v_cvt_pk_bf16_f32 v6, v50, v51
    v_lshlrev_b32 v50, 16, v6
    v_and_b32 v51, s16, v6
    v_mul_f32 v50, v50, v7
    v_mul_f32 v51, v51, v7
    v_cvt_pk_bf16_f32 v6, v50, v51
    v_lshlrev_b32 v50, 16, v6
    v_and_b32 v51, s16, v6
    v_sub_f32 v52, v52, v14
    v_sub_f32 v53, v53, v14
    v_cvt_pk_bf16_f32 v6, v52, v53
    v_lshlrev_b32 v52, 16, v6
    v_and_b32 v53, s16, v6
    v_mul_f32 v52, v52, v7
    v_mul_f32 v53, v53, v7
    v_cvt_pk_bf16_f32 v6, v52, v53
    v_lshlrev_b32 v52, 16, v6
    v_and_b32 v53, s16, v6
    v_sub_f32 v54, v54, v14
    v_sub_f32 v55, v55, v14
    v_cvt_pk_bf16_f32 v6, v54, v55
    v_lshlrev_b32 v54, 16, v6
    v_and_b32 v55, s16, v6
    v_mul_f32 v54, v54, v7
    v_mul_f32 v55, v55, v7
    v_cvt_pk_bf16_f32 v6, v54, v55
    v_lshlrev_b32 v54, 16, v6
    v_and_b32 v55, s16, v6
    v_sub_f32 v56, v56, v14
    v_sub_f32 v57, v57, v14
    v_cvt_pk_bf16_f32 v6, v56, v57
    v_lshlrev_b32 v56, 16, v6
    v_and_b32 v57, s16, v6
    v_mul_f32 v56, v56, v7
    v_mul_f32 v57, v57, v7
    v_cvt_pk_bf16_f32 v6, v56, v57
    v_lshlrev_b32 v56, 16, v6
    v_and_b32 v57, s16, v6
    v_sub_f32 v58, v58, v14
    v_sub_f32 v59, v59, v14
    v_cvt_pk_bf16_f32 v6, v58, v59
    v_lshlrev_b32 v58, 16, v6
    v_and_b32 v59, s16, v6
    v_mul_f32 v58, v58, v7
    v_mul_f32 v59, v59, v7
    v_cvt_pk_bf16_f32 v6, v58, v59
    v_lshlrev_b32 v58, 16, v6
    v_and_b32 v59, s16, v6
    v_sub_f32 v60, v60, v14
    v_sub_f32 v61, v61, v14
    v_cvt_pk_bf16_f32 v6, v60, v61
    v_lshlrev_b32 v60, 16, v6
    v_and_b32 v61, s16, v6
    v_mul_f32 v60, v60, v7
    v_mul_f32 v61, v61, v7
    v_cvt_pk_bf16_f32 v6, v60, v61
    v_lshlrev_b32 v60, 16, v6
    v_and_b32 v61, s16, v6
    v_sub_f32 v62, v62, v14
    v_sub_f32 v63, v63, v14
    v_cvt_pk_bf16_f32 v6, v62, v63
    v_lshlrev_b32 v62, 16, v6
    v_and_b32 v63, s16, v6
    v_mul_f32 v62, v62, v7
    v_mul_f32 v63, v63, v7
    v_cvt_pk_bf16_f32 v6, v62, v63
    v_lshlrev_b32 v62, 16, v6
    v_and_b32 v63, s16, v6
    v_mov_b32 v11, 128
L_po3:
    global_load_dword v10, v11, s[12:13] sc1
    s_add_u32 s17, s17, 1
    s_cmp_gt_u32 s17, 0x400000
    s_cbranch_scc1 L_pe3
    s_waitcnt vmcnt(0)
    v_cmp_gt_u32 vcc, 32, v10
    s_cbranch_vccnz L_po3
L_pe3:
    s_waitcnt vmcnt(0)
    v_lshlrev_b32 v4, 4, v2
    s_add_u32 s41, s41, 81788928
    buffer_load_dwordx4 v[64:67], v4, s[4:7], s41 offen offset:1024 sc1
    buffer_load_dwordx4 v[68:71], v4, s[4:7], s41 offen offset:1088 sc1
    buffer_load_dwordx4 v[72:75], v4, s[4:7], s41 offen offset:1152 sc1
    buffer_load_dwordx4 v[76:79], v4, s[4:7], s41 offen offset:1216 sc1
    buffer_load_dwordx4 v[80:83], v4, s[4:7], s41 offen offset:0 sc1
    buffer_load_dwordx4 v[84:87], v4, s[4:7], s41 offen offset:64 sc1
    buffer_load_dwordx4 v[88:91], v4, s[4:7], s41 offen offset:128 sc1
    buffer_load_dwordx4 v[92:95], v4, s[4:7], s41 offen offset:192 sc1
    s_lshl_b32 s40, s20, 14
    s_lshl_b32 s42, s15, 12
    s_add_u32 s40, s40, s42
    s_add_u32 s40, s40, 77594624
    s_waitcnt vmcnt(7)
    v_and_b32 v9, s16, v64
    v_lshlrev_b32 v8, 16, v64
    v_add_f32 v8, 1.0, v8
    v_add_f32 v9, 1.0, v9
    v_cvt_pk_bf16_f32 v6, v8, v9
    v_lshlrev_b32 v8, 16, v6
    v_and_b32 v9, s16, v6
    v_mul_f32 v32, v32, v8
    v_mul_f32 v33, v33, v9
    v_cvt_pk_bf16_f32 v6, v32, v33
    v_lshlrev_b32 v32, 16, v6
    v_and_b32 v33, s16, v6
    s_waitcnt vmcnt(3)
    v_and_b32 v9, s16, v80
    v_lshlrev_b32 v8, 16, v80
    v_add_f32 v32, v32, v8
    v_add_f32 v33, v33, v9
    v_cvt_pk_bf16_f32 v16, v32, v33
    v_and_b32 v9, s16, v65
    v_lshlrev_b32 v8, 16, v65
    v_add_f32 v8, 1.0, v8
    v_add_f32 v9, 1.0, v9
    v_cvt_pk_bf16_f32 v6, v8, v9
    v_lshlrev_b32 v8, 16, v6
    v_and_b32 v9, s16, v6
    v_mul_f32 v34, v34, v8
    v_mul_f32 v35, v35, v9
    v_cvt_pk_bf16_f32 v6, v34, v35
    v_lshlrev_b32 v34, 16, v6
    v_and_b32 v35, s16, v6
    v_and_b32 v9, s16, v81
    v_lshlrev_b32 v8, 16, v81
    v_add_f32 v34, v34, v8
    v_add_f32 v35, v35, v9
    v_cvt_pk_bf16_f32 v17, v34, v35
    v_and_b32 v9, s16, v66
    v_lshlrev_b32 v8, 16, v66
    v_add_f32 v8, 1.0, v8
    v_add_f32 v9, 1.0, v9
    v_cvt_pk_bf16_f32 v6, v8, v9
    v_lshlrev_b32 v8, 16, v6
    v_and_b32 v9, s16, v6
    v_mul_f32 v36, v36, v8
    v_mul_f32 v37, v37, v9
    v_cvt_pk_bf16_f32 v6, v36, v37
    v_lshlrev_b32 v36, 16, v6
    v_and_b32 v37, s16, v6
    v_and_b32 v9, s16, v82
    v_lshlrev_b32 v8, 16, v82
    v_add_f32 v36, v36, v8
    v_add_f32 v37, v37, v9
    v_cvt_pk_bf16_f32 v18, v36, v37
    v_and_b32 v9, s16, v67
    v_lshlrev_b32 v8, 16, v67
    v_add_f32 v8, 1.0, v8
    v_add_f32 v9, 1.0, v9
    v_cvt_pk_bf16_f32 v6, v8, v9
    v_lshlrev_b32 v8, 16, v6
    v_and_b32 v9, s16, v6
    v_mul_f32 v38, v38, v8
    v_mul_f32 v39, v39, v9
    v_cvt_pk_bf16_f32 v6, v38, v39
    v_lshlrev_b32 v38, 16, v6
    v_and_b32 v39, s16, v6
    v_and_b32 v9, s16, v83
    v_lshlrev_b32 v8, 16, v83
    v_add_f32 v38, v38, v8
    v_add_f32 v39, v39, v9
    v_cvt_pk_bf16_f32 v19, v38, v39
    buffer_store_dwordx4 v[16:19], v3, s[4:7], s40 offen offset:0 sc1
    v_and_b32 v9, s16, v68
    v_lshlrev_b32 v8, 16, v68
    v_add_f32 v8, 1.0, v8
    v_add_f32 v9, 1.0, v9
    v_cvt_pk_bf16_f32 v6, v8, v9
    v_lshlrev_b32 v8, 16, v6
    v_and_b32 v9, s16, v6
    v_mul_f32 v40, v40, v8
    v_mul_f32 v41, v41, v9
    v_cvt_pk_bf16_f32 v6, v40, v41
    v_lshlrev_b32 v40, 16, v6
    v_and_b32 v41, s16, v6
    s_waitcnt vmcnt(3)
    v_and_b32 v9, s16, v84
    v_lshlrev_b32 v8, 16, v84
    v_add_f32 v40, v40, v8
    v_add_f32 v41, v41, v9
    v_cvt_pk_bf16_f32 v20, v40, v41
    v_and_b32 v9, s16, v69
    v_lshlrev_b32 v8, 16, v69
    v_add_f32 v8, 1.0, v8
    v_add_f32 v9, 1.0, v9
    v_cvt_pk_bf16_f32 v6, v8, v9
    v_lshlrev_b32 v8, 16, v6
    v_and_b32 v9, s16, v6
    v_mul_f32 v42, v42, v8
    v_mul_f32 v43, v43, v9
    v_cvt_pk_bf16_f32 v6, v42, v43
    v_lshlrev_b32 v42, 16, v6
    v_and_b32 v43, s16, v6
    v_and_b32 v9, s16, v85
    v_lshlrev_b32 v8, 16, v85
    v_add_f32 v42, v42, v8
    v_add_f32 v43, v43, v9
    v_cvt_pk_bf16_f32 v21, v42, v43
    v_and_b32 v9, s16, v70
    v_lshlrev_b32 v8, 16, v70
    v_add_f32 v8, 1.0, v8
    v_add_f32 v9, 1.0, v9
    v_cvt_pk_bf16_f32 v6, v8, v9
    v_lshlrev_b32 v8, 16, v6
    v_and_b32 v9, s16, v6
    v_mul_f32 v44, v44, v8
    v_mul_f32 v45, v45, v9
    v_cvt_pk_bf16_f32 v6, v44, v45
    v_lshlrev_b32 v44, 16, v6
    v_and_b32 v45, s16, v6
    v_and_b32 v9, s16, v86
    v_lshlrev_b32 v8, 16, v86
    v_add_f32 v44, v44, v8
    v_add_f32 v45, v45, v9
    v_cvt_pk_bf16_f32 v22, v44, v45
    v_and_b32 v9, s16, v71
    v_lshlrev_b32 v8, 16, v71
    v_add_f32 v8, 1.0, v8
    v_add_f32 v9, 1.0, v9
    v_cvt_pk_bf16_f32 v6, v8, v9
    v_lshlrev_b32 v8, 16, v6
    v_and_b32 v9, s16, v6
    v_mul_f32 v46, v46, v8
    v_mul_f32 v47, v47, v9
    v_cvt_pk_bf16_f32 v6, v46, v47
    v_lshlrev_b32 v46, 16, v6
    v_and_b32 v47, s16, v6
    v_and_b32 v9, s16, v87
    v_lshlrev_b32 v8, 16, v87
    v_add_f32 v46, v46, v8
    v_add_f32 v47, v47, v9
    v_cvt_pk_bf16_f32 v23, v46, v47
    buffer_store_dwordx4 v[20:23], v3, s[4:7], s40 offen offset:1024 sc1
    v_and_b32 v9, s16, v72
    v_lshlrev_b32 v8, 16, v72
    v_add_f32 v8, 1.0, v8
    v_add_f32 v9, 1.0, v9
    v_cvt_pk_bf16_f32 v6, v8, v9
    v_lshlrev_b32 v8, 16, v6
    v_and_b32 v9, s16, v6
    v_mul_f32 v48, v48, v8
    v_mul_f32 v49, v49, v9
    v_cvt_pk_bf16_f32 v6, v48, v49
    v_lshlrev_b32 v48, 16, v6
    v_and_b32 v49, s16, v6
    s_waitcnt vmcnt(3)
    v_and_b32 v9, s16, v88
    v_lshlrev_b32 v8, 16, v88
    v_add_f32 v48, v48, v8
    v_add_f32 v49, v49, v9
    v_cvt_pk_bf16_f32 v24, v48, v49
    v_and_b32 v9, s16, v73
    v_lshlrev_b32 v8, 16, v73
    v_add_f32 v8, 1.0, v8
    v_add_f32 v9, 1.0, v9
    v_cvt_pk_bf16_f32 v6, v8, v9
    v_lshlrev_b32 v8, 16, v6
    v_and_b32 v9, s16, v6
    v_mul_f32 v50, v50, v8
    v_mul_f32 v51, v51, v9
    v_cvt_pk_bf16_f32 v6, v50, v51
    v_lshlrev_b32 v50, 16, v6
    v_and_b32 v51, s16, v6
    v_and_b32 v9, s16, v89
    v_lshlrev_b32 v8, 16, v89
    v_add_f32 v50, v50, v8
    v_add_f32 v51, v51, v9
    v_cvt_pk_bf16_f32 v25, v50, v51
    v_and_b32 v9, s16, v74
    v_lshlrev_b32 v8, 16, v74
    v_add_f32 v8, 1.0, v8
    v_add_f32 v9, 1.0, v9
    v_cvt_pk_bf16_f32 v6, v8, v9
    v_lshlrev_b32 v8, 16, v6
    v_and_b32 v9, s16, v6
    v_mul_f32 v52, v52, v8
    v_mul_f32 v53, v53, v9
    v_cvt_pk_bf16_f32 v6, v52, v53
    v_lshlrev_b32 v52, 16, v6
    v_and_b32 v53, s16, v6
    v_and_b32 v9, s16, v90
    v_lshlrev_b32 v8, 16, v90
    v_add_f32 v52, v52, v8
    v_add_f32 v53, v53, v9
    v_cvt_pk_bf16_f32 v26, v52, v53
    v_and_b32 v9, s16, v75
    v_lshlrev_b32 v8, 16, v75
    v_add_f32 v8, 1.0, v8
    v_add_f32 v9, 1.0, v9
    v_cvt_pk_bf16_f32 v6, v8, v9
    v_lshlrev_b32 v8, 16, v6
    v_and_b32 v9, s16, v6
    v_mul_f32 v54, v54, v8
    v_mul_f32 v55, v55, v9
    v_cvt_pk_bf16_f32 v6, v54, v55
    v_lshlrev_b32 v54, 16, v6
    v_and_b32 v55, s16, v6
    v_and_b32 v9, s16, v91
    v_lshlrev_b32 v8, 16, v91
    v_add_f32 v54, v54, v8
    v_add_f32 v55, v55, v9
    v_cvt_pk_bf16_f32 v27, v54, v55
    buffer_store_dwordx4 v[24:27], v3, s[4:7], s40 offen offset:2048 sc1
    v_and_b32 v9, s16, v76
    v_lshlrev_b32 v8, 16, v76
    v_add_f32 v8, 1.0, v8
    v_add_f32 v9, 1.0, v9
    v_cvt_pk_bf16_f32 v6, v8, v9
    v_lshlrev_b32 v8, 16, v6
    v_and_b32 v9, s16, v6
    v_mul_f32 v56, v56, v8
    v_mul_f32 v57, v57, v9
    v_cvt_pk_bf16_f32 v6, v56, v57
    v_lshlrev_b32 v56, 16, v6
    v_and_b32 v57, s16, v6
    s_waitcnt vmcnt(3)
    v_and_b32 v9, s16, v92
    v_lshlrev_b32 v8, 16, v92
    v_add_f32 v56, v56, v8
    v_add_f32 v57, v57, v9
    v_cvt_pk_bf16_f32 v28, v56, v57
    v_and_b32 v9, s16, v77
    v_lshlrev_b32 v8, 16, v77
    v_add_f32 v8, 1.0, v8
    v_add_f32 v9, 1.0, v9
    v_cvt_pk_bf16_f32 v6, v8, v9
    v_lshlrev_b32 v8, 16, v6
    v_and_b32 v9, s16, v6
    v_mul_f32 v58, v58, v8
    v_mul_f32 v59, v59, v9
    v_cvt_pk_bf16_f32 v6, v58, v59
    v_lshlrev_b32 v58, 16, v6
    v_and_b32 v59, s16, v6
    v_and_b32 v9, s16, v93
    v_lshlrev_b32 v8, 16, v93
    v_add_f32 v58, v58, v8
    v_add_f32 v59, v59, v9
    v_cvt_pk_bf16_f32 v29, v58, v59
    v_and_b32 v9, s16, v78
    v_lshlrev_b32 v8, 16, v78
    v_add_f32 v8, 1.0, v8
    v_add_f32 v9, 1.0, v9
    v_cvt_pk_bf16_f32 v6, v8, v9
    v_lshlrev_b32 v8, 16, v6
    v_and_b32 v9, s16, v6
    v_mul_f32 v60, v60, v8
    v_mul_f32 v61, v61, v9
    v_cvt_pk_bf16_f32 v6, v60, v61
    v_lshlrev_b32 v60, 16, v6
    v_and_b32 v61, s16, v6
    v_and_b32 v9, s16, v94
    v_lshlrev_b32 v8, 16, v94
    v_add_f32 v60, v60, v8
    v_add_f32 v61, v61, v9
    v_cvt_pk_bf16_f32 v30, v60, v61
    v_and_b32 v9, s16, v79
    v_lshlrev_b32 v8, 16, v79
    v_add_f32 v8, 1.0, v8
    v_add_f32 v9, 1.0, v9
    v_cvt_pk_bf16_f32 v6, v8, v9
    v_lshlrev_b32 v8, 16, v6
    v_and_b32 v9, s16, v6
    v_mul_f32 v62, v62, v8
    v_mul_f32 v63, v63, v9
    v_cvt_pk_bf16_f32 v6, v62, v63
    v_lshlrev_b32 v62, 16, v6
    v_and_b32 v63, s16, v6
    v_and_b32 v9, s16, v95
    v_lshlrev_b32 v8, 16, v95
    v_add_f32 v62, v62, v8
    v_add_f32 v63, v63, v9
    v_cvt_pk_bf16_f32 v31, v62, v63
    buffer_store_dwordx4 v[28:31], v3, s[4:7], s40 offen offset:3072 sc1
    v_mov_b32 v11, 136
L_po4:
    global_load_dword v10, v11, s[12:13] sc1
    s_add_u32 s17, s17, 1
    s_cmp_gt_u32 s17, 0x400000
    s_cbranch_scc1 L_pe4
    s_waitcnt vmcnt(0)
    v_cmp_gt_u32 vcc, 1, v10
    s_cbranch_vccnz L_po4
L_pe4:
    s_waitcnt vmcnt(0)
    s_barrier
    s_lshl_b32 s40, s20, 2
    s_add_u32 s40, s40, 80871424
    v_mov_b32 v6, 1
    s_cmp_lg_u32 s15, 0
    s_cbranch_scc1 L_ln_end
    s_mov_b64 exec, 1
    buffer_store_dword v6, off, s[4:7], s40 sc1
    s_mov_b64 exec, -1
L_ln_end:
L_p2:
    s_barrier
    s_lshr_b32 s21, s14, 5
    s_lshl_b32 s21, s21, 2
    s_lshr_b32 s21, 0x3210465, s21
    s_and_b32 s21, s21, 15
    s_and_b32 s22, s14, 31
    v_mov_b32 v17, 136
L_po5:
    global_load_dword v16, v17, s[12:13] sc1
    s_add_u32 s17, s17, 1
    s_cmp_gt_u32 s17, 0x400000
    s_cbranch_scc1 L_pe5
    s_waitcnt vmcnt(0)
    v_cmp_gt_u32 vcc, 1, v16
    s_cbranch_vccnz L_po5
L_pe5:
    s_waitcnt vmcnt(0)
    s_lshl_b32 s26, s21, 20
    s_add_u32 s26, s26, 60817408
    s_lshr_b32 s30, s22, 3
    s_and_b32 s31, s22, 7
    s_and_b32 s32, s15, 1
    s_lshr_b32 s33, s15, 1
    s_lshl_b32 s29, s21, 8
    s_add_u32 s29, s29, 80880640
    s_lshl_b32 s40, s22, 2
    s_add_u32 s28, s29, s40
    s_mov_b32 s27, 0
    s_mov_b32 s34, 0x3db504f3
    s_mov_b32 s35, 0x3fb8aa3b
    s_lshl_b32 s24, s15, 15
    s_add_u32 s24, s24, 32768
    s_lshl_b32 s38, s22, 7
    s_add_u32 s37, s38, 80872448
    s_add_u32 s38, s38, 80876544
    v_mov_b32 v152, -1
    v_mov_b32 v153, -1
    v_mov_b32 v154, -1
    v_mov_b32 v155, -1
    s_lshl_b32 s40, s22, 13
    s_add_u32 s40, s40, s26
    s_lshl_b32 s41, s15, 11
    s_add_u32 s40, s40, s41
    s_add_u32 s41, s40, 262144
    buffer_store_dwordx4 v[152:155], v3, s[4:7], s41 offen offset:0 sc1
    buffer_store_dwordx4 v[152:155], v3, s[4:7], s41 offen offset:1024 sc1
    s_add_u32 s41, s40, 524288
    buffer_store_dwordx4 v[152:155], v3, s[4:7], s41 offen offset:0 sc1
    buffer_store_dwordx4 v[152:155], v3, s[4:7], s41 offen offset:1024 sc1
    s_waitcnt vmcnt(0)
    s_barrier
    s_getreg_b32 s36, hwreg(HW_REG_XCC_ID)
    s_and_b32 s36, s36, 7
    s_add_u32 s36, s36, 1
    v_mov_b32 v16, s36
    s_mov_b64 exec, 1
    buffer_store_dword v16, off, s[4:7], s28 offset:2048 sc1
    s_mov_b64 exec, -1
    v_and_b32 v16, 1, v0
    v_mul_u32_u24 v16, 0xaaaa, v16
    v_add_u32 v4, 0x4444, v16
    v_bfe_u32 v16, v1, 1, 2
    v_lshlrev_b32 v5, 2, v16
    v_and_b32 v16, 1, v1
    v_lshl_add_u32 v5, v16, 4, v5
    v_lshl_add_u32 v5, v2, 6, v5
    v_lshrrev_b32 v16, 3, v1
    v_lshl_add_u32 v5, v16, 8, v5
    s_lshl_b32 s40, s15, 9
    v_add_u32 v5, s40, v5
    v_and_b32 v6, 31, v0
    v_lshlrev_b32 v6, 2, v6
    v_lshrrev_b32 v16, 1, v1
    v_xor_b32 v16, v16, v2
    v_lshlrev_b32 v16, 4, v16
    v_lshl_add_u32 v7, v1, 7, v16
    s_lshl_b32 s40, s32, 14
    v_add_u32 v7, s40, v7
    v_xor_b32 v151, 64, v7
    v_and_b32 v19, 3, v0
    v_and_b32 v16, 7, v0
    v_xor_b32 v16, v16, v2
    v_lshlrev_b32 v16, 4, v16
    v_lshrrev_b32 v17, 3, v0
    v_lshl_add_u32 v8, v17, 10, v16
    s_lshl_b32 s40, s32, 6
    v_xor_b32 v8, s40, v8
    v_lshlrev_b32 v9, 15, v2
    v_lshl_add_u32 v9, v1, 2, v9
    s_lshl_b32 s40, s22, 8
    s_lshl_b32 s41, s15, 6
    s_add_u32 s40, s40, s41
    v_add_u32 v9, s40, v9
    v_lshlrev_b32 v16, 2, v2
    v_sub_u32 v10, v1, v16
    v_mov_b32 v13, 0
    v_lshrrev_b32 v17, 3, v0
    v_bfe_u32 v16, v0, 4, 1
    s_lshl_b32 s40, s32, 1
    v_or_b32 v16, s40, v16
    v_lshlrev_b32 v16, 1, v16
    v_and_b32 v18, 7, v0
    v_xor_b32 v16, v16, v18
    v_lshlrev_b32 v16, 4, v16
    s_lshl_b32 s40, s15, 3
    v_add_u32 v25, s40, v17
    v_mul_u32_u24 v25, 3584, v25
    v_add_u32 v25, v25, v16
    s_min_u32 s40, s22, 27
    s_lshl_b32 s40, s40, 7
    v_add_u32 v25, s40, v25
    v_and_b32 v18, 3, v17
    v_lshrrev_b32 v17, 2, v17
    v_lshl_add_u32 v17, v17, 4, v18
    v_lshl_add_u32 v24, v17, 10, v16
    s_lshl_b32 s40, s31, 7
    s_lshl_b32 s41, s15, 12
    s_add_u32 s40, s40, s41
    s_mul_i32 s41, s30, 458752
    s_add_u32 s41, s41, s40
    v_add_u32 v26, s41, v24
    s_lshl_b32 s41, s30, 20
    s_add_u32 s41, s41, s40
    v_add_u32 v24, s41, v24
    v_lshrrev_b32 v18, 2, v1
    v_and_b32 v20, 1, v2
    v_lshrrev_b32 v16, 1, v18
    v_lshl_add_u32 v16, v20, 1, v16
    v_lshlrev_b32 v17, 10, v2
    v_lshl_add_u32 v17, v18, 7, v17
    v_lshl_add_u32 v17, v19, 3, v17
    v_lshl_add_u32 v17, v16, 5, v17
    v_add_u32 v17, 32768, v17
    s_lshl_b32 s40, s15, 5
    v_xor_b32 v27, s40, v17
    v_add_u32 v28, 65536, v27
    s_lshl_b32 s40, s33, 6
    v_xor_b32 v29, s40, v17
    v_xor_b32 v30, 32, v29
    s_lshl_b32 s24, s15, 10
    s_add_u32 s24, s24, 32768
    s_mov_b32 s8, s62
    s_mov_b32 s9, s63
    s_mov_b32 s10, 4194304
    s_add_u32 m0, s24, 0
    s_mov_b32 s47, 0
    buffer_load_dwordx4 v24, s[8:11], s47 offen lds
    s_add_u32 m0, s24, 4096
    s_mov_b32 s47, 32768
    buffer_load_dwordx4 v24, s[8:11], s47 offen lds
    s_add_u32 m0, s24, 8192
    s_mov_b32 s47, 65536
    buffer_load_dwordx4 v24, s[8:11], s47 offen lds
    s_add_u32 m0, s24, 12288
    s_mov_b32 s47, 98304
    buffer_load_dwordx4 v24, s[8:11], s47 offen lds
    s_mov_b32 s8, s62
    s_mov_b32 s9, s63
    s_mov_b32 s10, 4194304
    s_add_u32 m0, s24, 16384
    s_mov_b32 s47, 131072
    buffer_load_dwordx4 v24, s[8:11], s47 offen lds
    s_add_u32 m0, s24, 20480
    s_mov_b32 s47, 163840
    buffer_load_dwordx4 v24, s[8:11], s47 offen lds
    s_add_u32 m0, s24, 24576
    s_mov_b32 s47, 196608
    buffer_load_dwordx4 v24, s[8:11], s47 offen lds
    s_add_u32 m0, s24, 28672
    s_mov_b32 s47, 229376
    buffer_load_dwordx4 v24, s[8:11], s47 offen lds
    s_mov_b32 s8, s62
    s_mov_b32 s9, s63
    s_mov_b32 s10, 4194304
    s_add_u32 m0, s24, 32768
    s_mov_b32 s47, 262144
    buffer_load_dwordx4 v24, s[8:11], s47 offen lds
    s_add_u32 m0, s24, 36864
    s_mov_b32 s47, 294912
    buffer_load_dwordx4 v24, s[8:11], s47 offen lds
    s_add_u32 m0, s24, 40960
    s_mov_b32 s47, 327680
    buffer_load_dwordx4 v24, s[8:11], s47 offen lds
    s_add_u32 m0, s24, 45056
    s_mov_b32 s47, 360448
    buffer_load_dwordx4 v24, s[8:11], s47 offen lds
    s_mov_b32 s8, s62
    s_mov_b32 s9, s63
    s_mov_b32 s10, 4194304
    s_add_u32 m0, s24, 49152
    s_mov_b32 s47, 393216
    buffer_load_dwordx4 v24, s[8:11], s47 offen lds
    s_add_u32 m0, s24, 53248
    s_mov_b32 s47, 425984
    buffer_load_dwordx4 v24, s[8:11], s47 offen lds
    s_add_u32 m0, s24, 57344
    s_mov_b32 s47, 458752
    buffer_load_dwordx4 v24, s[8:11], s47 offen lds
    s_add_u32 m0, s24, 61440
    s_mov_b32 s47, 491520
    buffer_load_dwordx4 v24, s[8:11], s47 offen lds
    s_waitcnt vmcnt(12)
    s_barrier
    s_mov_b32 s8, s62
    s_mov_b32 s9, s63
    s_mov_b32 s10, 4194304
    s_add_u32 m0, s24, 65536
    s_mov_b32 s47, 524288
    buffer_load_dwordx4 v24, s[8:11], s47 offen lds
    s_add_u32 m0, s24, 69632
    s_mov_b32 s47, 557056
    buffer_load_dwordx4 v24, s[8:11], s47 offen lds
    s_add_u32 m0, s24, 73728
    s_mov_b32 s47, 589824
    buffer_load_dwordx4 v24, s[8:11], s47 offen lds
    s_add_u32 m0, s24, 77824
    s_mov_b32 s47, 622592
    buffer_load_dwordx4 v24, s[8:11], s47 offen lds
    ds_read_b64_tr_b16 a[0:1], v27 offset:0
    ds_read_b64_tr_b16 a[2:3], v27 offset:512
    ds_read_b64_tr_b16 a[4:5], v27 offset:4096
    ds_read_b64_tr_b16 a[6:7], v27 offset:4608
    ds_read_b64_tr_b16 a[8:9], v27 offset:8192
    ds_read_b64_tr_b16 a[10:11], v27 offset:8704
    ds_read_b64_tr_b16 a[12:13], v27 offset:12288
    ds_read_b64_tr_b16 a[14:15], v27 offset:12800
    s_waitcnt lgkmcnt(0)
    s_waitcnt vmcnt(12)
    s_barrier
    s_mov_b32 s8, s62
    s_mov_b32 s9, s63
    s_mov_b32 s10, 4194304
    s_add_u32 m0, s24, 81920
    s_mov_b32 s47, 655360
    buffer_load_dwordx4 v24, s[8:11], s47 offen lds
    s_add_u32 m0, s24, 86016
    s_mov_b32 s47, 688128
    buffer_load_dwordx4 v24, s[8:11], s47 offen lds
    s_add_u32 m0, s24, 90112
    s_mov_b32 s47, 720896
    buffer_load_dwordx4 v24, s[8:11], s47 offen lds
    s_add_u32 m0, s24, 94208
    s_mov_b32 s47, 753664
    buffer_load_dwordx4 v24, s[8:11], s47 offen lds
    ds_read_b64_tr_b16 a[16:17], v27 offset:16384
    ds_read_b64_tr_b16 a[18:19], v27 offset:16896
    ds_read_b64_tr_b16 a[20:21], v27 offset:20480
    ds_read_b64_tr_b16 a[22:23], v27 offset:20992
    ds_read_b64_tr_b16 a[24:25], v27 offset:24576
    ds_read_b64_tr_b16 a[26:27], v27 offset:25088
    ds_read_b64_tr_b16 a[28:29], v27 offset:28672
    ds_read_b64_tr_b16 a[30:31], v27 offset:29184
    s_waitcnt lgkmcnt(0)
    s_waitcnt vmcnt(12)
    s_barrier
    s_mov_b32 s8, s62
    s_mov_b32 s9, s63
    s_mov_b32 s10, 4194304
    s_add_u32 m0, s24, 98304
    s_mov_b32 s47, 786432
    buffer_load_dwordx4 v24, s[8:11], s47 offen lds
    s_add_u32 m0, s24, 102400
    s_mov_b32 s47, 819200
    buffer_load_dwordx4 v24, s[8:11], s47 offen lds
    s_add_u32 m0, s24, 106496
    s_mov_b32 s47, 851968
    buffer_load_dwordx4 v24, s[8:11], s47 offen lds
    s_add_u32 m0, s24, 110592
    s_mov_b32 s47, 884736
    buffer_load_dwordx4 v24, s[8:11], s47 offen lds
    ds_read_b64_tr_b16 a[32:33], v27 offset:32768
    ds_read_b64_tr_b16 a[34:35], v27 offset:33280
    ds_read_b64_tr_b16 a[36:37], v27 offset:36864
    ds_read_b64_tr_b16 a[38:39], v27 offset:37376
    ds_read_b64_tr_b16 a[40:41], v27 offset:40960
    ds_read_b64_tr_b16 a[42:43], v27 offset:41472
    ds_read_b64_tr_b16 a[44:45], v27 offset:45056
    ds_read_b64_tr_b16 a[46:47], v27 offset:45568
    s_waitcnt lgkmcnt(0)
    s_waitcnt vmcnt(12)
    s_barrier
    s_mov_b32 s8, s62
    s_mov_b32 s9, s63
    s_mov_b32 s10, 4194304
    s_add_u32 m0, s24, 114688
    s_mov_b32 s47, 917504
    buffer_load_dwordx4 v24, s[8:11], s47 offen lds
    s_add_u32 m0, s24, 118784
    s_mov_b32 s47, 950272
    buffer_load_dwordx4 v24, s[8:11], s47 offen lds
    s_add_u32 m0, s24, 122880
    s_mov_b32 s47, 983040
    buffer_load_dwordx4 v24, s[8:11], s47 offen lds
    s_add_u32 m0, s24, 126976
    s_mov_b32 s47, 1015808
    buffer_load_dwordx4 v24, s[8:11], s47 offen lds
    ds_read_b64_tr_b16 a[48:49], v27 offset:49152
    ds_read_b64_tr_b16 a[50:51], v27 offset:49664
    ds_read_b64_tr_b16 a[52:53], v27 offset:53248
    ds_read_b64_tr_b16 a[54:55], v27 offset:53760
    ds_read_b64_tr_b16 a[56:57], v27 offset:57344
    ds_read_b64_tr_b16 a[58:59], v27 offset:57856
    ds_read_b64_tr_b16 a[60:61], v27 offset:61440
    ds_read_b64_tr_b16 a[62:63], v27 offset:61952
    s_waitcnt lgkmcnt(0)
    s_waitcnt vmcnt(12)
    s_barrier
    s_mov_b32 s8, s68
    s_mov_b32 s9, s69
    s_mov_b32 s10, 1835008
    s_add_u32 m0, s24, 0
    s_mov_b32 s47, 0
    buffer_load_dwordx4 v25, s[8:11], s47 offen lds
    s_add_u32 m0, s24, 4096
    s_mov_b32 s47, 114688
    buffer_load_dwordx4 v25, s[8:11], s47 offen lds
    s_add_u32 m0, s24, 8192
    s_mov_b32 s47, 229376
    buffer_load_dwordx4 v25, s[8:11], s47 offen lds
    s_add_u32 m0, s24, 12288
    s_mov_b32 s47, 344064
    buffer_load_dwordx4 v25, s[8:11], s47 offen lds
    ds_read_b64_tr_b16 a[64:65], v28 offset:0
    ds_read_b64_tr_b16 a[66:67], v28 offset:512
    ds_read_b64_tr_b16 a[68:69], v28 offset:4096
    ds_read_b64_tr_b16 a[70:71], v28 offset:4608
    ds_read_b64_tr_b16 a[72:73], v28 offset:8192
    ds_read_b64_tr_b16 a[74:75], v28 offset:8704
    ds_read_b64_tr_b16 a[76:77], v28 offset:12288
    ds_read_b64_tr_b16 a[78:79], v28 offset:12800
    s_waitcnt lgkmcnt(0)
    s_waitcnt vmcnt(12)
    s_barrier
    s_mov_b32 s8, s68
    s_mov_b32 s9, s69
    s_mov_b32 s10, 1835008
    s_add_u32 m0, s24, 16384
    s_mov_b32 s47, 458752
    buffer_load_dwordx4 v25, s[8:11], s47 offen lds
    s_add_u32 m0, s24, 20480
    s_mov_b32 s47, 573440
    buffer_load_dwordx4 v25, s[8:11], s47 offen lds
    s_add_u32 m0, s24, 24576
    s_mov_b32 s47, 688128
    buffer_load_dwordx4 v25, s[8:11], s47 offen lds
    s_add_u32 m0, s24, 28672
    s_mov_b32 s47, 802816
    buffer_load_dwordx4 v25, s[8:11], s47 offen lds
    ds_read_b64_tr_b16 a[80:81], v28 offset:16384
    ds_read_b64_tr_b16 a[82:83], v28 offset:16896
    ds_read_b64_tr_b16 a[84:85], v28 offset:20480
    ds_read_b64_tr_b16 a[86:87], v28 offset:20992
    ds_read_b64_tr_b16 a[88:89], v28 offset:24576
    ds_read_b64_tr_b16 a[90:91], v28 offset:25088
    ds_read_b64_tr_b16 a[92:93], v28 offset:28672
    ds_read_b64_tr_b16 a[94:95], v28 offset:29184
    s_waitcnt lgkmcnt(0)
    s_waitcnt vmcnt(12)
    s_barrier
    s_mov_b32 s8, s68
    s_mov_b32 s9, s69
    s_mov_b32 s10, 1835008
    s_add_u32 m0, s24, 32768
    s_mov_b32 s47, 917504
    buffer_load_dwordx4 v25, s[8:11], s47 offen lds
    s_add_u32 m0, s24, 36864
    s_mov_b32 s47, 1032192
    buffer_load_dwordx4 v25, s[8:11], s47 offen lds
    s_add_u32 m0, s24, 40960
    s_mov_b32 s47, 1146880
    buffer_load_dwordx4 v25, s[8:11], s47 offen lds
    s_add_u32 m0, s24, 45056
    s_mov_b32 s47, 1261568
    buffer_load_dwordx4 v25, s[8:11], s47 offen lds
    ds_read_b64_tr_b16 a[96:97], v28 offset:32768
    ds_read_b64_tr_b16 a[98:99], v28 offset:33280
    ds_read_b64_tr_b16 a[100:101], v28 offset:36864
    ds_read_b64_tr_b16 a[102:103], v28 offset:37376
    ds_read_b64_tr_b16 a[104:105], v28 offset:40960
    ds_read_b64_tr_b16 a[106:107], v28 offset:41472
    ds_read_b64_tr_b16 a[108:109], v28 offset:45056
    ds_read_b64_tr_b16 a[110:111], v28 offset:45568
    s_waitcnt lgkmcnt(0)
    s_waitcnt vmcnt(12)
    s_barrier
    s_mov_b32 s8, s68
    s_mov_b32 s9, s69
    s_mov_b32 s10, 1835008
    s_add_u32 m0, s24, 49152
    s_mov_b32 s47, 1376256
    buffer_load_dwordx4 v25, s[8:11], s47 offen lds
    s_add_u32 m0, s24, 53248
    s_mov_b32 s47, 1490944
    buffer_load_dwordx4 v25, s[8:11], s47 offen lds
    s_add_u32 m0, s24, 57344
    s_mov_b32 s47, 1605632
    buffer_load_dwordx4 v25, s[8:11], s47 offen lds
    s_add_u32 m0, s24, 61440
    s_mov_b32 s47, 1720320
    buffer_load_dwordx4 v25, s[8:11], s47 offen lds
    ds_read_b64_tr_b16 a[112:113], v28 offset:49152
    ds_read_b64_tr_b16 a[114:115], v28 offset:49664
    ds_read_b64_tr_b16 a[116:117], v28 offset:53248
    ds_read_b64_tr_b16 a[118:119], v28 offset:53760
    ds_read_b64_tr_b16 a[120:121], v28 offset:57344
    ds_read_b64_tr_b16 a[122:123], v28 offset:57856
    ds_read_b64_tr_b16 a[124:125], v28 offset:61440
    ds_read_b64_tr_b16 a[126:127], v28 offset:61952
    s_waitcnt lgkmcnt(0)
    s_waitcnt vmcnt(12)
    s_barrier
    s_mov_b32 s8, s70
    s_mov_b32 s9, s71
    s_mov_b32 s10, 1835008
    s_add_u32 m0, s24, 65536
    s_mov_b32 s47, 0
    buffer_load_dwordx4 v26, s[8:11], s47 offen lds
    s_add_u32 m0, s24, 69632
    s_mov_b32 s47, 32768
    buffer_load_dwordx4 v26, s[8:11], s47 offen lds
    s_add_u32 m0, s24, 73728
    s_mov_b32 s47, 65536
    buffer_load_dwordx4 v26, s[8:11], s47 offen lds
    s_add_u32 m0, s24, 77824
    s_mov_b32 s47, 98304
    buffer_load_dwordx4 v26, s[8:11], s47 offen lds
    ds_read_b64_tr_b16 a[128:129], v29 offset:0
    ds_read_b64_tr_b16 a[192:193], v30 offset:0
    ds_read_b64_tr_b16 a[130:131], v29 offset:512
    ds_read_b64_tr_b16 a[194:195], v30 offset:512
    ds_read_b64_tr_b16 a[132:133], v29 offset:4096
    ds_read_b64_tr_b16 a[196:197], v30 offset:4096
    ds_read_b64_tr_b16 a[134:135], v29 offset:4608
    ds_read_b64_tr_b16 a[198:199], v30 offset:4608
    ds_read_b64_tr_b16 a[136:137], v29 offset:8192
    ds_read_b64_tr_b16 a[200:201], v30 offset:8192
    ds_read_b64_tr_b16 a[138:139], v29 offset:8704
    ds_read_b64_tr_b16 a[202:203], v30 offset:8704
    ds_read_b64_tr_b16 a[140:141], v29 offset:12288
    ds_read_b64_tr_b16 a[204:205], v30 offset:12288
    ds_read_b64_tr_b16 a[142:143], v29 offset:12800
    ds_read_b64_tr_b16 a[206:207], v30 offset:12800
    s_waitcnt lgkmcnt(0)
    s_waitcnt vmcnt(12)
    s_barrier
    s_mov_b32 s8, s70
    s_mov_b32 s9, s71
    s_mov_b32 s10, 1835008
    s_add_u32 m0, s24, 81920
    s_mov_b32 s47, 131072
    buffer_load_dwordx4 v26, s[8:11], s47 offen lds
    s_add_u32 m0, s24, 86016
    s_mov_b32 s47, 163840
    buffer_load_dwordx4 v26, s[8:11], s47 offen lds
    s_add_u32 m0, s24, 90112
    s_mov_b32 s47, 196608
    buffer_load_dwordx4 v26, s[8:11], s47 offen lds
    s_add_u32 m0, s24, 94208
    s_mov_b32 s47, 229376
    buffer_load_dwordx4 v26, s[8:11], s47 offen lds
    ds_read_b64_tr_b16 a[144:145], v29 offset:16384
    ds_read_b64_tr_b16 a[208:209], v30 offset:16384
    ds_read_b64_tr_b16 a[146:147], v29 offset:16896
    ds_read_b64_tr_b16 a[210:211], v30 offset:16896
    ds_read_b64_tr_b16 a[148:149], v29 offset:20480
    ds_read_b64_tr_b16 a[212:213], v30 offset:20480
    ds_read_b64_tr_b16 a[150:151], v29 offset:20992
    ds_read_b64_tr_b16 a[214:215], v30 offset:20992
    ds_read_b64_tr_b16 a[152:153], v29 offset:24576
    ds_read_b64_tr_b16 a[216:217], v30 offset:24576
    ds_read_b64_tr_b16 a[154:155], v29 offset:25088
    ds_read_b64_tr_b16 a[218:219], v30 offset:25088
    ds_read_b64_tr_b16 a[156:157], v29 offset:28672
    ds_read_b64_tr_b16 a[220:221], v30 offset:28672
    ds_read_b64_tr_b16 a[158:159], v29 offset:29184
    ds_read_b64_tr_b16 a[222:223], v30 offset:29184
    s_waitcnt lgkmcnt(0)
    s_waitcnt vmcnt(12)
    s_barrier
    s_mov_b32 s8, s70
    s_mov_b32 s9, s71
    s_mov_b32 s10, 1835008
    s_add_u32 m0, s24, 98304
    s_mov_b32 s47, 262144
    buffer_load_dwordx4 v26, s[8:11], s47 offen lds
    s_add_u32 m0, s24, 102400
    s_mov_b32 s47, 294912
    buffer_load_dwordx4 v26, s[8:11], s47 offen lds
    s_add_u32 m0, s24, 106496
    s_mov_b32 s47, 327680
    buffer_load_dwordx4 v26, s[8:11], s47 offen lds
    s_add_u32 m0, s24, 110592
    s_mov_b32 s47, 360448
    buffer_load_dwordx4 v26, s[8:11], s47 offen lds
    ds_read_b64_tr_b16 a[160:161], v29 offset:32768
    ds_read_b64_tr_b16 a[224:225], v30 offset:32768
    ds_read_b64_tr_b16 a[162:163], v29 offset:33280
    ds_read_b64_tr_b16 a[226:227], v30 offset:33280
    ds_read_b64_tr_b16 a[164:165], v29 offset:36864
    ds_read_b64_tr_b16 a[228:229], v30 offset:36864
    ds_read_b64_tr_b16 a[166:167], v29 offset:37376
    ds_read_b64_tr_b16 a[230:231], v30 offset:37376
    ds_read_b64_tr_b16 a[168:169], v29 offset:40960
    ds_read_b64_tr_b16 a[232:233], v30 offset:40960
    ds_read_b64_tr_b16 a[170:171], v29 offset:41472
    ds_read_b64_tr_b16 a[234:235], v30 offset:41472
    ds_read_b64_tr_b16 a[172:173], v29 offset:45056
    ds_read_b64_tr_b16 a[236:237], v30 offset:45056
    ds_read_b64_tr_b16 a[174:175], v29 offset:45568
    ds_read_b64_tr_b16 a[238:239], v30 offset:45568
    s_waitcnt lgkmcnt(0)
    s_waitcnt vmcnt(12)
    s_barrier
    s_mov_b32 s8, s70
    s_mov_b32 s9, s71
    s_mov_b32 s10, 1835008
    s_add_u32 m0, s24, 114688
    s_mov_b32 s47, 393216
    buffer_load_dwordx4 v26, s[8:11], s47 offen lds
    s_add_u32 m0, s24, 118784
    s_mov_b32 s47, 425984
    buffer_load_dwordx4 v26, s[8:11], s47 offen lds
    ds_read_b64_tr_b16 a[176:177], v29 offset:49152
    ds_read_b64_tr_b16 a[240:241], v30 offset:49152
    ds_read_b64_tr_b16 a[178:179], v29 offset:49664
    ds_read_b64_tr_b16 a[242:243], v30 offset:49664
    ds_read_b64_tr_b16 a[180:181], v29 offset:53248
    ds_read_b64_tr_b16 a[244:245], v30 offset:53248
    ds_read_b64_tr_b16 a[182:183], v29 offset:53760
    ds_read_b64_tr_b16 a[246:247], v30 offset:53760
    ds_read_b64_tr_b16 a[184:185], v29 offset:57344
    ds_read_b64_tr_b16 a[248:249], v30 offset:57344
    ds_read_b64_tr_b16 a[186:187], v29 offset:57856
    ds_read_b64_tr_b16 a[250:251], v30 offset:57856
    ds_read_b64_tr_b16 a[188:189], v29 offset:61440
    ds_read_b64_tr_b16 a[252:253], v30 offset:61440
    ds_read_b64_tr_b16 a[190:191], v29 offset:61952
    ds_read_b64_tr_b16 a[254:255], v30 offset:61952
    s_waitcnt lgkmcnt(0)
    s_waitcnt vmcnt(10)
    s_barrier
    ds_read_b64_tr_b16 v[200:201], v28 offset:0
    ds_read_b64_tr_b16 v[202:203], v28 offset:512
    ds_read_b64_tr_b16 v[204:205], v28 offset:4096
    ds_read_b64_tr_b16 v[206:207], v28 offset:4608
    ds_read_b64_tr_b16 v[208:209], v28 offset:8192
    ds_read_b64_tr_b16 v[210:211], v28 offset:8704
    ds_read_b64_tr_b16 v[212:213], v28 offset:12288
    ds_read_b64_tr_b16 v[214:215], v28 offset:12800
    s_waitcnt lgkmcnt(0)
    s_waitcnt vmcnt(6)
    s_barrier
    ds_read_b64_tr_b16 v[216:217], v28 offset:16384
    ds_read_b64_tr_b16 v[218:219], v28 offset:16896
    ds_read_b64_tr_b16 v[220:221], v28 offset:20480
    ds_read_b64_tr_b16 v[222:223], v28 offset:20992
    ds_read_b64_tr_b16 v[224:225], v28 offset:24576
    ds_read_b64_tr_b16 v[226:227], v28 offset:25088
    ds_read_b64_tr_b16 v[228:229], v28 offset:28672
    ds_read_b64_tr_b16 v[230:231], v28 offset:29184
    s_waitcnt lgkmcnt(0)
    s_waitcnt vmcnt(2)
    s_barrier
    ds_read_b64_tr_b16 v[232:233], v28 offset:32768
    ds_read_b64_tr_b16 v[234:235], v28 offset:33280
    ds_read_b64_tr_b16 v[236:237], v28 offset:36864
    ds_read_b64_tr_b16 v[238:239], v28 offset:37376
    ds_read_b64_tr_b16 v[240:241], v28 offset:40960
    ds_read_b64_tr_b16 v[242:243], v28 offset:41472
    ds_read_b64_tr_b16 v[244:245], v28 offset:45056
    ds_read_b64_tr_b16 v[246:247], v28 offset:45568
    s_waitcnt lgkmcnt(0)
    s_waitcnt vmcnt(0)
    s_barrier
    ds_read_b64_tr_b16 v[248:249], v28 offset:49152
    ds_read_b64_tr_b16 v[250:251], v28 offset:49664
    ds_read_b64_tr_b16 v[252:253], v28 offset:53248
    ds_read_b64_tr_b16 v[254:255], v28 offset:53760
    s_waitcnt lgkmcnt(0)
    v_mov_b32 v17, 132
L_po6:
    global_load_dword v16, v17, s[12:13] sc1
    s_add_u32 s17, s17, 1
    s_cmp_gt_u32 s17, 0x400000
    s_cbranch_scc1 L_pe6
    s_waitcnt vmcnt(0)
    v_cmp_gt_u32 vcc, 64, v16
    s_cbranch_vccnz L_po6
L_pe6:
    s_waitcnt vmcnt(0)
    s_mov_b32 s40, 81790976
    v_lshlrev_b32 v149, 3, v0
    buffer_load_dwordx2 v[16:17], v149, s[4:7], s40 offen offset:0 sc1
    buffer_load_dwordx2 v[18:19], v149, s[4:7], s40 offen offset:512 sc1
    buffer_load_dwordx2 v[20:21], v149, s[4:7], s40 offen offset:1024 sc1
    buffer_load_dwordx2 v[22:23], v149, s[4:7], s40 offen offset:1536 sc1
    buffer_load_dwordx2 v[24:25], v149, s[4:7], s40 offen offset:2048 sc1
    buffer_load_dwordx2 v[26:27], v149, s[4:7], s40 offen offset:2560 sc1
    buffer_load_dwordx2 v[28:29], v149, s[4:7], s40 offen offset:3072 sc1
    buffer_load_dwordx2 v[30:31], v149, s[4:7], s40 offen offset:3584 sc1
    s_waitcnt vmcnt(7)
    v_and_b32 v169, s16, v16
    v_lshlrev_b32 v168, 16, v16
    v_and_b32 v171, s16, v17
    v_lshlrev_b32 v170, 16, v17
    s_waitcnt vmcnt(6)
    v_and_b32 v173, s16, v18
    v_lshlrev_b32 v172, 16, v18
    v_and_b32 v175, s16, v19
    v_lshlrev_b32 v174, 16, v19
    s_waitcnt vmcnt(5)
    v_and_b32 v177, s16, v20
    v_lshlrev_b32 v176, 16, v20
    v_and_b32 v179, s16, v21
    v_lshlrev_b32 v178, 16, v21
    s_waitcnt vmcnt(4)
    v_and_b32 v181, s16, v22
    v_lshlrev_b32 v180, 16, v22
    v_and_b32 v183, s16, v23
    v_lshlrev_b32 v182, 16, v23
    s_waitcnt vmcnt(3)
    v_and_b32 v185, s16, v24
    v_lshlrev_b32 v184, 16, v24
    v_and_b32 v187, s16, v25
    v_lshlrev_b32 v186, 16, v25
    s_waitcnt vmcnt(2)
    v_and_b32 v189, s16, v26
    v_lshlrev_b32 v188, 16, v26
    v_and_b32 v191, s16, v27
    v_lshlrev_b32 v190, 16, v27
    s_waitcnt vmcnt(1)
    v_and_b32 v193, s16, v28
    v_lshlrev_b32 v192, 16, v28
    v_and_b32 v195, s16, v29
    v_lshlrev_b32 v194, 16, v29
    s_waitcnt vmcnt(0)
    v_and_b32 v197, s16, v30
    v_lshlrev_b32 v196, 16, v30
    v_and_b32 v199, s16, v31
    v_lshlrev_b32 v198, 16, v31
    v_add_f32 v184, 1.0, v184
    v_add_f32 v185, 1.0, v185
    v_add_f32 v186, 1.0, v186
    v_add_f32 v187, 1.0, v187
    v_add_f32 v188, 1.0, v188
    v_add_f32 v189, 1.0, v189
    v_add_f32 v190, 1.0, v190
    v_add_f32 v191, 1.0, v191
    v_cvt_pk_bf16_f32 v16, v184, v185
    v_lshlrev_b32 v184, 16, v16
    v_and_b32 v185, s16, v16
    v_cvt_pk_bf16_f32 v16, v186, v187
    v_lshlrev_b32 v186, 16, v16
    v_and_b32 v187, s16, v16
    v_cvt_pk_bf16_f32 v16, v188, v189
    v_lshlrev_b32 v188, 16, v16
    v_and_b32 v189, s16, v16
    v_cvt_pk_bf16_f32 v16, v190, v191
    v_lshlrev_b32 v190, 16, v16
    v_and_b32 v191, s16, v16
L_po7:
    buffer_load_dword v16, v6, s[4:7], s29 offen offset:2048 sc1
    s_add_u32 s17, s17, 1
    s_cmp_gt_u32 s17, 0x400000
    s_cbranch_scc1 L_pe7
    s_waitcnt vmcnt(0)
    v_cmp_gt_u32 vcc, 1, v16
    s_cbranch_vccnz L_po7
L_pe7:
    s_waitcnt vmcnt(0)
    v_cmp_ne_u32 vcc, s36, v16
    s_cmp_ge_u32 s21, 5
    s_cselect_b32 s40, 46, 0
    s_add_u32 s23, s21, s40
    s_lshl_b32 s40, s22, 15
    s_lshl_b32 s41, s15, 13
    s_add_u32 s40, s40, s41
    s_add_u32 s40, s40, s26
    s_add_u32 s41, s40, 4096
    buffer_load_dwordx4 v[20:23], v3, s[4:7], s40 offen offset:0 sc1
    buffer_load_dwordx4 v[20:23], v3, s[4:7], s40 offen offset:1024 sc1
    buffer_load_dwordx4 v[20:23], v3, s[4:7], s40 offen offset:2048 sc1
    buffer_load_dwordx4 v[20:23], v3, s[4:7], s40 offen offset:3072 sc1
    buffer_load_dwordx4 v[20:23], v3, s[4:7], s41 offen offset:0 sc1
    buffer_load_dwordx4 v[20:23], v3, s[4:7], s41 offen offset:1024 sc1
    buffer_load_dwordx4 v[20:23], v3, s[4:7], s41 offen offset:2048 sc1
    buffer_load_dwordx4 v[20:23], v3, s[4:7], s41 offen offset:3072 sc1
    s_mov_b64 s[44:45], vcc
    s_barrier
    s_cmp_eq_u32 s15, 0
    s_cbranch_scc1 L_p2_nf
    s_and_b32 s40, s23, 1
    s_lshl_b32 s40, s40, 2
    s_add_u32 s40, s40, s37
    s_lshr_b32 s41, s23, 1
    s_add_u32 s41, s41, 2
L_po8:
    buffer_load_dword v14, v13, s[4:7], s40 offen offset:0 sc1
    s_add_u32 s17, s17, 1
    s_cmp_gt_u32 s17, 0x400000
    s_cbranch_scc1 L_pe8
    s_waitcnt vmcnt(0)
    v_cmp_gt_u32 vcc, s41, v14
    s_cbranch_vccz L_pe8
    s_sleep 2
    s_branch L_po8
L_pe8:
    s_waitcnt vmcnt(0)
    s_lshl_b32 s40, s22, 6
    s_add_u32 s40, s40, s23
    s_lshl_b32 s41, s40, 13
    s_add_u32 s41, s41, 33554432
    s_lshl_b32 s40, s40, 14
    s_lshl_b32 s42, s32, 13
    s_add_u32 s40, s40, s42
    s_add_u32 s40, s40, 0
    s_cmp_eq_u32 s15, 1
    s_cselect_b32 s40, s41, s40
    s_add_u32 s41, s40, 4096
    s_lshl_b32 s42, s15, 13
    s_add_u32 m0, s42, 73728
    s_nop 0
    buffer_load_dwordx4 v3, s[4:7], s40 offen offset:0 sc1 lds
    buffer_load_dwordx4 v3, s[4:7], s40 offen offset:1024 sc1 lds
    buffer_load_dwordx4 v3, s[4:7], s40 offen offset:2048 sc1 lds
    buffer_load_dwordx4 v3, s[4:7], s40 offen offset:3072 sc1 lds
    s_add_u32 m0, m0, 4096
    s_nop 0
    buffer_load_dwordx4 v3, s[4:7], s41 offen offset:0 sc1 lds
    buffer_load_dwordx4 v3, s[4:7], s41 offen offset:1024 sc1 lds
    buffer_load_dwordx4 v3, s[4:7], s41 offen offset:2048 sc1 lds
    buffer_load_dwordx4 v3, s[4:7], s41 offen offset:3072 sc1 lds
L_p2_nf:
    s_mov_b64 vcc, s[44:45]
    s_waitcnt vmcnt(0)
    s_mov_b32 s8, s52
    s_mov_b32 s9, s53
    s_mov_b32 s10, 2097152
    s_barrier
    s_cbranch_vccnz L_p2_S
L_p2_F:
    s_cmp_eq_u32 s21, 0
    s_cselect_b32 s18, 1024, 0
    s_cmp_ge_u32 s23, 63
    s_cselect_b32 s18, s18, 0
    s_cselect_b32 s19, 0x40000000, 0
    s_cselect_b32 s20, 16, 0
    s_add_u32 s19, s19, 1024
    s_lshr_b32 s40, s18, 6
    s_xor_b32 s40, s40, s22
    s_and_b32 s20, s20, s40
    s_lshl_b32 s40, s23, 5
    s_add_u32 s40, s40, s22
    s_lshl_b32 s46, s40, 10
    s_lshl_b32 s40, s22, 6
    s_add_u32 s40, s40, s23
    s_lshl_b32 s45, s40, 12
    s_add_u32 s45, s45, 51380224
    s_lshl_b32 s40, s33, 11
    s_add_u32 s45, s45, s40
    buffer_load_dwordx4 v[80:83], v3, s[4:7], s45 offen offset:0 sc1
    buffer_load_dwordx4 v[84:87], v3, s[4:7], s45 offen offset:1024 sc1
    buffer_load_dwordx2 v[136:137], v149, s[8:11], s46 offen offset:0
    buffer_load_dwordx2 v[138:139], v149, s[8:11], s46 offen offset:512
    s_lshl_b32 s40, s32, 12
    s_add_u32 s40, s40, 81920
    v_add_u32 v120, s40, v3
    ds_read_b128 v[16:19], v120 offset:0
    ds_read_b128 v[20:23], v120 offset:1024
    ds_read_b128 v[24:27], v120 offset:2048
    ds_read_b128 v[28:31], v120 offset:3072
    v_add_u32 v120, 90112, v3
    ds_read_b128 v[32:35], v120 offset:0
    ds_read_b128 v[36:39], v120 offset:1024
    ds_read_b128 v[40:43], v120 offset:2048
    ds_read_b128 v[44:47], v120 offset:3072
    ds_read_b128 v[48:51], v120 offset:4096
    ds_read_b128 v[52:55], v120 offset:5120
    ds_read_b128 v[56:59], v120 offset:6144
    ds_read_b128 v[60:63], v120 offset:7168
    s_lshl_b32 s40, s33, 12
    v_add_u32 v120, s40, v120
    ds_read_b128 v[64:67], v120 offset:8192
    ds_read_b128 v[68:71], v120 offset:9216
    ds_read_b128 v[72:75], v120 offset:10240
    ds_read_b128 v[76:79], v120 offset:11264
    s_waitcnt lgkmcnt(11)
    v_mfma_f32_16x16x32_bf16 v[92:95], v[32:35], v[16:19], 0
    s_waitcnt lgkmcnt(10)
    v_mfma_f32_16x16x32_bf16 v[92:95], v[36:39], v[20:23], v[92:95]
    s_waitcnt lgkmcnt(9)
    v_mfma_f32_16x16x32_bf16 v[92:95], v[40:43], v[24:27], v[92:95]
    s_waitcnt lgkmcnt(8)
    v_mfma_f32_16x16x32_bf16 v[92:95], v[44:47], v[28:31], v[92:95]
    s_waitcnt lgkmcnt(7)
    v_mfma_f32_16x16x32_bf16 v[96:99], v[48:51], v[16:19], 0
    s_waitcnt lgkmcnt(6)
    v_mfma_f32_16x16x32_bf16 v[96:99], v[52:55], v[20:23], v[96:99]
    s_waitcnt lgkmcnt(5)
    v_mfma_f32_16x16x32_bf16 v[96:99], v[56:59], v[24:27], v[96:99]
    s_waitcnt lgkmcnt(4)
    v_mfma_f32_16x16x32_bf16 v[96:99], v[60:63], v[28:31], v[96:99]
    v_mov_b64 v[100:101], 0
    v_mov_b64 v[102:103], 0
    v_cvt_pk_bf16_f32 v120, v92, v93
    v_lshlrev_b32 v92, 16, v120
    v_and_b32 v93, s16, v120
    v_mul_f32 v92, s34, v92
    v_mul_f32 v93, s34, v93
    v_cvt_pk_bf16_f32 v120, v92, v93
    v_lshlrev_b32 v92, 16, v120
    v_and_b32 v93, s16, v120
    v_cvt_pk_bf16_f32 v120, v94, v95
    v_lshlrev_b32 v94, 16, v120
    v_and_b32 v95, s16, v120
    v_mul_f32 v94, s34, v94
    v_mul_f32 v95, s34, v95
    v_cvt_pk_bf16_f32 v120, v94, v95
    v_lshlrev_b32 v94, 16, v120
    v_and_b32 v95, s16, v120
    v_cvt_pk_bf16_f32 v120, v96, v97
    v_lshlrev_b32 v96, 16, v120
    v_and_b32 v97, s16, v120
    v_mul_f32 v96, s34, v96
    v_mul_f32 v97, s34, v97
    v_cvt_pk_bf16_f32 v120, v96, v97
    v_lshlrev_b32 v96, 16, v120
    v_and_b32 v97, s16, v120
    v_cvt_pk_bf16_f32 v120, v98, v99
    v_lshlrev_b32 v98, 16, v120
    v_and_b32 v99, s16, v120
    v_mul_f32 v98, s34, v98
    v_mul_f32 v99, s34, v99
    v_cvt_pk_bf16_f32 v120, v98, v99
    v_lshlrev_b32 v98, 16, v120
    v_and_b32 v99, s16, v120
    s_lshl_b32 s41, s32, 4
    v_add_u32 v120, s41, v10
    v_mov_b32 v122, 0xce6e4000
    v_cmp_le_i32 vcc, 0, v120
    s_nop 1
    v_cndmask_b32 v92, v122, v92, vcc
    v_cmp_le_i32 vcc, 1, v120
    s_nop 1
    v_cndmask_b32 v93, v122, v93, vcc
    v_cmp_le_i32 vcc, 2, v120
    s_nop 1
    v_cndmask_b32 v94, v122, v94, vcc
    v_cmp_le_i32 vcc, 3, v120
    s_nop 1
    v_cndmask_b32 v95, v122, v95, vcc
    v_cmp_le_i32 vcc, 16, v120
    s_nop 1
    v_cndmask_b32 v96, v122, v96, vcc
    v_cmp_le_i32 vcc, 17, v120
    s_nop 1
    v_cndmask_b32 v97, v122, v97, vcc
    v_cmp_le_i32 vcc, 18, v120
    s_nop 1
    v_cndmask_b32 v98, v122, v98, vcc
    v_cmp_le_i32 vcc, 19, v120
    s_nop 1
    v_cndmask_b32 v99, v122, v99, vcc
    v_max3_f32 v121, v92, v93, v94
    v_max3_f32 v121, v121, v95, v96
    v_max3_f32 v121, v121, v97, v98
    v_max_f32 v121, v121, v99
    v_mov_b32 v120, v121
    s_nop 1
    v_permlane32_swap_b32 v121, v120
    v_max_f32 v121, v121, v120
    v_mov_b32 v120, v121
    s_nop 1
    v_permlane16_swap_b32 v121, v120
    v_max_f32 v121, v121, v120
    v_sub_f32 v92, v92, v121
    v_sub_f32 v93, v93, v121
    v_sub_f32 v94, v94, v121
    v_sub_f32 v95, v95, v121
    v_sub_f32 v96, v96, v121
    v_sub_f32 v97, v97, v121
    v_sub_f32 v98, v98, v121
    v_sub_f32 v99, v99, v121
    v_mul_f32 v92, s35, v92
    v_mul_f32 v93, s35, v93
    v_mul_f32 v94, s35, v94
    v_mul_f32 v95, s35, v95
    v_mul_f32 v96, s35, v96
    v_mul_f32 v97, s35, v97
    v_mul_f32 v98, s35, v98
    v_mul_f32 v99, s35, v99
    v_exp_f32 v92, v92
    v_exp_f32 v93, v93
    v_exp_f32 v94, v94
    v_exp_f32 v95, v95
    v_exp_f32 v96, v96
    v_exp_f32 v97, v97
    v_exp_f32 v98, v98
    v_exp_f32 v99, v99
    v_add_f32 v122, v92, v93
    v_add_f32 v122, v122, v94
    v_add_f32 v122, v122, v95
    v_add_f32 v122, v122, v96
    v_add_f32 v122, v122, v97
    v_add_f32 v122, v122, v98
    v_add_f32 v122, v122, v99
L_p2_F_kc:
    s_waitcnt vmcnt(0)
    s_add_u32 s17, s17, 1
    s_cmp_gt_u32 s17, 0x400000
    v_max3_u32 v120, v80, v81, v82
    v_max3_u32 v120, v120, v83, v84
    v_max3_u32 v120, v120, v85, v86
    v_max_u32 v120, v120, v87
    v_cmp_eq_u32 vcc, -1, v120
    s_cbranch_scc1 L_p2_F_kx
    s_cbranch_vccnz L_p2_F_kd
L_p2_F_kx:
    s_cmp_eq_u32 s32, 1
    s_cselect_b64 vcc, -1, 0
    v_cndmask_b32 v89, v81, v85, vcc
    v_cndmask_b32 v91, v83, v87, vcc
    ds_write2_b32 v5, v89, v91 offset0:0 offset1:8
    s_waitcnt lgkmcnt(0)
    s_barrier
    ds_read_b128 v[128:131], v3 offset:0
    ds_read_b128 v[132:135], v3 offset:1024
    s_waitcnt lgkmcnt(1)
    v_smfmac_f32_16x16x64_bf16 v[100:103], v[128:131], v[16:23], v4
    s_waitcnt lgkmcnt(0)
    v_smfmac_f32_16x16x64_bf16 v[100:103], v[132:135], v[24:31], v4
    s_nop 7
    v_add_f32 v100, v100, v101
    v_add_f32 v101, v102, v103
    v_cvt_pk_bf16_f32 v120, v100, v101
    v_lshlrev_b32 v100, 16, v120
    v_and_b32 v101, s16, v120
    v_mul_f32 v100, s34, v100
    v_mul_f32 v101, s34, v101
    v_cvt_pk_bf16_f32 v120, v100, v101
    v_lshlrev_b32 v100, 16, v120
    v_and_b32 v101, s16, v120
    v_max3_f32 v103, v121, v100, v101
    v_mov_b32 v120, v103
    s_nop 1
    v_permlane32_swap_b32 v103, v120
    v_max_f32 v103, v103, v120
    v_mov_b32 v120, v103
    s_nop 1
    v_permlane16_swap_b32 v103, v120
    v_max_f32 v103, v103, v120
    v_sub_f32 v100, v100, v103
    v_sub_f32 v101, v101, v103
    v_sub_f32 v102, v121, v103
    v_mul_f32 v100, s35, v100
    v_mul_f32 v101, s35, v101
    v_mul_f32 v102, s35, v102
    v_exp_f32 v100, v100
    v_exp_f32 v101, v101
    v_exp_f32 v102, v102
    v_add_f32 v103, v100, v101
    v_fmac_f32 v103, v102, v122
    v_mov_b32 v120, v103
    s_nop 1
    v_permlane32_swap_b32 v103, v120
    v_add_f32 v103, v103, v120
    v_mov_b32 v120, v103
    s_nop 1
    v_permlane16_swap_b32 v103, v120
    v_add_f32 v103, v103, v120
    v_rcp_f32 v103, v103
    s_nop 0
    v_mul_f32 v102, v102, v103
    v_pk_mul_f32 v[100:101], v[100:101], v[102:103] op_sel:[0,1]
    v_pk_mul_f32 v[92:93], v[92:93], v[102:103] op_sel_hi:[1,0]
    v_pk_mul_f32 v[94:95], v[94:95], v[102:103] op_sel_hi:[1,0]
    v_pk_mul_f32 v[96:97], v[96:97], v[102:103] op_sel_hi:[1,0]
    v_pk_mul_f32 v[98:99], v[98:99], v[102:103] op_sel_hi:[1,0]
    v_cvt_pk_bf16_f32 v124, v92, v93
    v_cvt_pk_bf16_f32 v125, v94, v95
    v_cvt_pk_bf16_f32 v126, v96, v97
    v_cvt_pk_bf16_f32 v127, v98, v99
    v_cvt_pk_bf16_f32 v12, v100, v101
    s_nop 0
    v_mfma_f32_16x16x32_bf16 v[104:107], v[64:67], v[124:127], 0
    v_mfma_f32_16x16x32_bf16 v[108:111], v[68:71], v[124:127], 0
    v_mfma_f32_16x16x32_bf16 v[112:115], v[72:75], v[124:127], 0
    v_mfma_f32_16x16x32_bf16 v[116:119], v[76:79], v[124:127], 0
    v_mfma_f32_16x16x16_bf16 v[104:107], v[80:81], v[12:13], v[104:107]
    v_mfma_f32_16x16x16_bf16 v[108:111], v[82:83], v[12:13], v[108:111]
    v_mfma_f32_16x16x16_bf16 v[112:115], v[84:85], v[12:13], v[112:115]
    v_mfma_f32_16x16x16_bf16 v[116:119], v[86:87], v[12:13], v[116:119]
    s_lshl_b32 s41, s22, 13
    s_lshl_b32 s42, s33, 12
    s_add_u32 s41, s41, s42
    s_lshl_b32 s42, s32, 10
    s_add_u32 s41, s41, s42
    s_add_u32 s41, s41, s26
    v_cvt_pk_bf16_f32 v16, v104, v105
    v_cvt_pk_bf16_f32 v17, v106, v107
    v_cvt_pk_bf16_f32 v18, v108, v109
    v_cvt_pk_bf16_f32 v19, v110, v111
    buffer_store_dwordx4 v[16:19], v3, s[4:7], s41 offen offset:0
    v_cvt_pk_bf16_f32 v20, v112, v113
    v_cvt_pk_bf16_f32 v21, v114, v115
    v_cvt_pk_bf16_f32 v22, v116, v117
    v_cvt_pk_bf16_f32 v23, v118, v119
    buffer_store_dwordx4 v[20:23], v3, s[4:7], s41 offen offset:2048
    s_waitcnt vmcnt(0)
    s_barrier
    s_add_u32 s27, s27, 1
    s_cmp_lg_u32 s15, 0
    s_cbranch_scc1 L_p2_F_g1
    v_mov_b32 v14, s27
    s_mov_b64 exec, 1
    buffer_store_dword v14, off, s[4:7], s28
    s_mov_b64 exec, -1
    s_nop 15
    buffer_load_dword v150, v6, s[4:7], s29 offen sc1
    s_nop 11
    buffer_load_dword v150, v6, s[4:7], s29 offen sc1
    s_nop 11
    buffer_load_dword v150, v6, s[4:7], s29 offen sc1
    s_nop 11
L_po9:
    buffer_load_dword v150, v6, s[4:7], s29 offen sc1
    s_add_u32 s17, s17, 1
    s_cmp_gt_u32 s17, 0x400000
    s_cbranch_scc1 L_pe9
    s_waitcnt vmcnt(3)
    v_cmp_gt_u32 vcc, s27, v150
    s_cbranch_vccnz L_po9
L_pe9:
L_p2_F_g1:
    s_barrier
    s_lshl_b32 s41, s30, 16
    s_add_u32 s41, s41, s26
    s_lshl_b32 s42, s15, 11
    s_add_u32 s41, s41, s42
    s_add_u32 s43, s41, s19
    s_add_u32 s41, s41, s18
    s_lshl_b32 s42, s15, 10
    s_add_u32 m0, s42, 4096
    v_add_u32 v120, 4096, v3
    buffer_load_dwordx4 v3, s[4:7], s41 offen sc1 lds
    s_add_u32 m0, m0, 4096
    s_add_u32 s41, s41, 8192
    buffer_load_dwordx4 v3, s[4:7], s41 offen sc1 lds
    s_add_u32 m0, m0, 4096
    s_add_u32 s41, s41, 8192
    s_barrier
    buffer_load_dwordx4 v3, s[4:7], s41 offen sc1 lds
    s_add_u32 m0, m0, 4096
    s_add_u32 s41, s41, 8192
    buffer_load_dwordx4 v3, s[4:7], s41 offen sc1 lds
    s_add_u32 m0, m0, 4096
    s_add_u32 s41, s41, 8192
    s_barrier
    buffer_load_dwordx4 v3, s[4:7], s41 offen sc1 lds
    s_add_u32 m0, m0, 4096
    s_add_u32 s41, s41, 8192
    buffer_load_dwordx4 v3, s[4:7], s41 offen sc1 lds
    s_add_u32 m0, m0, 4096
    s_add_u32 s41, s41, 8192
    s_barrier
    s_lshl_b32 s44, s18, 7
    s_add_u32 s44, s44, s26
    s_add_u32 s44, s44, 262144
    s_waitcnt vmcnt(4)
    s_barrier
    ds_read_b128 v[16:19], v120 offset:0
    ds_read_b128 v[20:23], v120 offset:1024
    ds_read_b128 v[24:27], v120 offset:2048
    ds_read_b128 v[28:31], v120 offset:3072
    s_waitcnt lgkmcnt(3)
    v_mfma_f32_16x16x32_bf16 v[104:107], v[16:19], a[0:3], 0
    ds_read_b128 v[32:35], v120 offset:4096
    s_waitcnt lgkmcnt(3)
    v_mfma_f32_16x16x32_bf16 v[104:107], v[20:23], a[4:7], v[104:107]
    ds_read_b128 v[36:39], v120 offset:5120
    buffer_load_dwordx4 v3, s[4:7], s41 offen sc1 lds
    s_add_u32 m0, m0, 4096
    s_add_u32 s41, s41, 8192
    s_waitcnt lgkmcnt(3)
    v_mfma_f32_16x16x32_bf16 v[104:107], v[24:27], a[8:11], v[104:107]
    ds_read_b128 v[40:43], v120 offset:6144
    s_waitcnt lgkmcnt(3)
    v_mfma_f32_16x16x32_bf16 v[104:107], v[28:31], a[12:15], v[104:107]
    ds_read_b128 v[44:47], v120 offset:7168
    s_waitcnt lgkmcnt(3)
    v_mfma_f32_16x16x32_bf16 v[104:107], v[32:35], a[16:19], v[104:107]
    s_waitcnt vmcnt(3)
    s_barrier
    ds_read_b128 v[16:19], v120 offset:8192
    s_waitcnt lgkmcnt(3)
    v_mfma_f32_16x16x32_bf16 v[104:107], v[36:39], a[20:23], v[104:107]
    ds_read_b128 v[20:23], v120 offset:9216
    buffer_load_dwordx4 v3, s[4:7], s41 offen sc1 lds
    s_add_u32 m0, m0, 4096
    s_mov_b32 s41, s43
    s_waitcnt lgkmcnt(3)
    v_mfma_f32_16x16x32_bf16 v[104:107], v[40:43], a[24:27], v[104:107]
    ds_read_b128 v[24:27], v120 offset:10240
    s_waitcnt lgkmcnt(3)
    v_mfma_f32_16x16x32_bf16 v[104:107], v[44:47], a[28:31], v[104:107]
    ds_read_b128 v[28:31], v120 offset:11264
    s_waitcnt lgkmcnt(3)
    v_mfma_f32_16x16x32_bf16 v[104:107], v[16:19], a[32:35], v[104:107]
    ds_read_b128 v[32:35], v120 offset:12288
    s_waitcnt lgkmcnt(3)
    v_mfma_f32_16x16x32_bf16 v[104:107], v[20:23], a[36:39], v[104:107]
    ds_read_b128 v[36:39], v120 offset:13312
    buffer_load_dwordx4 v3, s[4:7], s41 offen sc1 lds
    s_add_u32 m0, m0, 4096
    s_add_u32 s41, s41, 8192
    s_waitcnt lgkmcnt(3)
    v_mfma_f32_16x16x32_bf16 v[104:107], v[24:27], a[40:43], v[104:107]
    ds_read_b128 v[40:43], v120 offset:14336
    s_waitcnt lgkmcnt(3)
    v_mfma_f32_16x16x32_bf16 v[104:107], v[28:31], a[44:47], v[104:107]
    ds_read_b128 v[44:47], v120 offset:15360
    s_waitcnt lgkmcnt(3)
    v_mfma_f32_16x16x32_bf16 v[104:107], v[32:35], a[48:51], v[104:107]
    s_waitcnt vmcnt(3)
    s_barrier
    ds_read_b128 v[16:19], v120 offset:16384
    s_waitcnt lgkmcnt(3)
    v_mfma_f32_16x16x32_bf16 v[104:107], v[36:39], a[52:55], v[104:107]
    ds_read_b128 v[20:23], v120 offset:17408
    buffer_load_dwordx4 v3, s[4:7], s41 offen sc1 lds
    s_add_u32 m0, m0, 4096
    s_add_u32 s41, s41, 8192
    s_waitcnt lgkmcnt(3)
    v_mfma_f32_16x16x32_bf16 v[104:107], v[40:43], a[56:59], v[104:107]
    ds_read_b128 v[24:27], v120 offset:18432
    s_waitcnt lgkmcnt(3)
    v_mfma_f32_16x16x32_bf16 v[104:107], v[44:47], a[60:63], v[104:107]
    ds_read_b128 v[28:31], v120 offset:19456
    s_waitcnt lgkmcnt(3)
    v_mfma_f32_16x16x32_bf16 v[104:107], v[16:19], a[64:67], v[104:107]
    ds_read_b128 v[32:35], v120 offset:20480
    s_waitcnt lgkmcnt(3)
    v_mfma_f32_16x16x32_bf16 v[104:107], v[20:23], a[68:71], v[104:107]
    ds_read_b128 v[36:39], v120 offset:21504
    buffer_load_dwordx4 v3, s[4:7], s41 offen sc1 lds
    s_add_u32 m0, m0, 4096
    s_add_u32 s41, s41, 8192
    s_waitcnt lgkmcnt(3)
    v_mfma_f32_16x16x32_bf16 v[104:107], v[24:27], a[72:75], v[104:107]
    ds_read_b128 v[40:43], v120 offset:22528
    s_waitcnt lgkmcnt(3)
    v_mfma_f32_16x16x32_bf16 v[104:107], v[28:31], a[76:79], v[104:107]
    ds_read_b128 v[44:47], v120 offset:23552
    s_waitcnt lgkmcnt(3)
    v_mfma_f32_16x16x32_bf16 v[104:107], v[32:35], a[80:83], v[104:107]
    s_waitcnt vmcnt(3)
    s_barrier
    ds_read_b128 v[16:19], v120 offset:24576
    s_waitcnt lgkmcnt(3)
    v_mfma_f32_16x16x32_bf16 v[104:107], v[36:39], a[84:87], v[104:107]
    ds_read_b128 v[20:23], v120 offset:25600
    buffer_load_dwordx4 v3, s[4:7], s41 offen sc1 lds
    s_add_u32 m0, m0, 4096
    s_add_u32 s41, s41, 8192
    s_waitcnt lgkmcnt(3)
    v_mfma_f32_16x16x32_bf16 v[104:107], v[40:43], a[88:91], v[104:107]
    ds_read_b128 v[24:27], v120 offset:26624
    s_waitcnt lgkmcnt(3)
    v_mfma_f32_16x16x32_bf16 v[104:107], v[44:47], a[92:95], v[104:107]
    ds_read_b128 v[28:31], v120 offset:27648
    s_waitcnt lgkmcnt(3)
    v_mfma_f32_16x16x32_bf16 v[104:107], v[16:19], a[96:99], v[104:107]
    ds_read_b128 v[32:35], v120 offset:28672
    s_waitcnt lgkmcnt(3)
    v_mfma_f32_16x16x32_bf16 v[104:107], v[20:23], a[100:103], v[104:107]
    ds_read_b128 v[36:39], v120 offset:29696
    buffer_load_dwordx4 v3, s[4:7], s41 offen sc1 lds
    s_add_u32 m0, m0, 4096
    s_add_u32 s41, s41, 8192
    s_waitcnt lgkmcnt(3)
    v_mfma_f32_16x16x32_bf16 v[104:107], v[24:27], a[104:107], v[104:107]
    ds_read_b128 v[40:43], v120 offset:30720
    s_waitcnt lgkmcnt(3)
    v_mfma_f32_16x16x32_bf16 v[104:107], v[28:31], a[108:111], v[104:107]
    ds_read_b128 v[44:47], v120 offset:31744
    s_waitcnt lgkmcnt(3)
    v_mfma_f32_16x16x32_bf16 v[104:107], v[32:35], a[112:115], v[104:107]
    s_waitcnt vmcnt(3)
    s_barrier
    ds_read_b128 v[16:19], v120 offset:32768
    s_waitcnt lgkmcnt(3)
    v_mfma_f32_16x16x32_bf16 v[104:107], v[36:39], a[116:119], v[104:107]
    ds_read_b128 v[20:23], v120 offset:33792
    buffer_load_dwordx4 v3, s[4:7], s41 offen sc1 lds
    s_add_u32 m0, m0, 4096
    s_add_u32 s41, s41, 8192
    s_waitcnt lgkmcnt(3)
    v_mfma_f32_16x16x32_bf16 v[104:107], v[40:43], a[120:123], v[104:107]
    ds_read_b128 v[24:27], v120 offset:34816
    s_waitcnt lgkmcnt(3)
    v_mfma_f32_16x16x32_bf16 v[104:107], v[44:47], a[124:127], v[104:107]
    s_cmp_lg_u32 s19, 1024
    s_cbranch_scc1 L_p2_F_gah
    ds_read_b128 v[28:31], v120 offset:35840
    s_waitcnt lgkmcnt(3)
    v_mfma_f32_16x16x32_bf16 v[108:111], v[16:19], a[0:3], 0
    ds_read_b128 v[32:35], v120 offset:36864
    s_waitcnt lgkmcnt(3)
    v_mfma_f32_16x16x32_bf16 v[108:111], v[20:23], a[4:7], v[108:111]
    ds_read_b128 v[36:39], v120 offset:37888
    buffer_load_dwordx4 v3, s[4:7], s41 offen sc1 lds
    s_add_u32 m0, m0, 4096
    s_add_u32 s41, s41, 8192
    s_waitcnt lgkmcnt(3)
    v_mfma_f32_16x16x32_bf16 v[108:111], v[24:27], a[8:11], v[108:111]
    ds_read_b128 v[40:43], v120 offset:38912
    s_waitcnt lgkmcnt(3)
    v_mfma_f32_16x16x32_bf16 v[108:111], v[28:31], a[12:15], v[108:111]
    ds_read_b128 v[44:47], v120 offset:39936
    buffer_store_dword v104, v9, s[4:7], s44 offen
    s_add_u32 s44, s44, 8192
    s_waitcnt lgkmcnt(3)
    v_mfma_f32_16x16x32_bf16 v[108:111], v[32:35], a[16:19], v[108:111]
    s_waitcnt vmcnt(4)
    s_barrier
    ds_read_b128 v[16:19], v120 offset:40960
    s_waitcnt lgkmcnt(3)
    v_mfma_f32_16x16x32_bf16 v[108:111], v[36:39], a[20:23], v[108:111]
    ds_read_b128 v[20:23], v120 offset:41984
    buffer_load_dwordx4 v3, s[4:7], s41 offen sc1 lds
    s_add_u32 m0, m0, 4096
    s_add_u32 s41, s41, 8192
    buffer_store_dword v105, v9, s[4:7], s44 offen
    s_add_u32 s44, s44, 8192
    s_waitcnt lgkmcnt(3)
    v_mfma_f32_16x16x32_bf16 v[108:111], v[40:43], a[24:27], v[108:111]
    ds_read_b128 v[24:27], v120 offset:43008
    s_waitcnt lgkmcnt(3)
    v_mfma_f32_16x16x32_bf16 v[108:111], v[44:47], a[28:31], v[108:111]
    ds_read_b128 v[28:31], v120 offset:44032
    buffer_store_dword v106, v9, s[4:7], s44 offen
    s_add_u32 s44, s44, 8192
    s_waitcnt lgkmcnt(3)
    v_mfma_f32_16x16x32_bf16 v[108:111], v[16:19], a[32:35], v[108:111]
    ds_read_b128 v[32:35], v120 offset:45056
    s_waitcnt lgkmcnt(3)
    v_mfma_f32_16x16x32_bf16 v[108:111], v[20:23], a[36:39], v[108:111]
    ds_read_b128 v[36:39], v120 offset:46080
    buffer_store_dword v107, v9, s[4:7], s44 offen
    s_add_u32 s44, s44, 106496
    s_waitcnt lgkmcnt(3)
    v_mfma_f32_16x16x32_bf16 v[108:111], v[24:27], a[40:43], v[108:111]
    ds_read_b128 v[40:43], v120 offset:47104
    s_waitcnt lgkmcnt(3)
    v_mfma_f32_16x16x32_bf16 v[108:111], v[28:31], a[44:47], v[108:111]
    ds_read_b128 v[44:47], v120 offset:48128
    s_waitcnt lgkmcnt(3)
    v_mfma_f32_16x16x32_bf16 v[108:111], v[32:35], a[48:51], v[108:111]
    s_waitcnt vmcnt(6)
    s_barrier
    ds_read_b128 v[16:19], v120 offset:49152
    s_waitcnt lgkmcnt(3)
    v_mfma_f32_16x16x32_bf16 v[108:111], v[36:39], a[52:55], v[108:111]
    ds_read_b128 v[20:23], v120 offset:50176
    s_waitcnt lgkmcnt(3)
    v_mfma_f32_16x16x32_bf16 v[108:111], v[40:43], a[56:59], v[108:111]
    ds_read_b128 v[24:27], v120 offset:51200
    s_waitcnt lgkmcnt(3)
    v_mfma_f32_16x16x32_bf16 v[108:111], v[44:47], a[60:63], v[108:111]
    ds_read_b128 v[28:31], v120 offset:52224
    s_waitcnt lgkmcnt(3)
    v_mfma_f32_16x16x32_bf16 v[108:111], v[16:19], a[64:67], v[108:111]
    ds_read_b128 v[32:35], v120 offset:53248
    s_waitcnt lgkmcnt(3)
    v_mfma_f32_16x16x32_bf16 v[108:111], v[20:23], a[68:71], v[108:111]
    ds_read_b128 v[36:39], v120 offset:54272
    s_waitcnt lgkmcnt(3)
    v_mfma_f32_16x16x32_bf16 v[108:111], v[24:27], a[72:75], v[108:111]
    ds_read_b128 v[40:43], v120 offset:55296
    s_waitcnt lgkmcnt(3)
    v_mfma_f32_16x16x32_bf16 v[108:111], v[28:31], a[76:79], v[108:111]
    ds_read_b128 v[44:47], v120 offset:56320
    s_waitcnt lgkmcnt(3)
    v_mfma_f32_16x16x32_bf16 v[108:111], v[32:35], a[80:83], v[108:111]
    s_waitcnt vmcnt(3)
    s_barrier
    ds_read_b128 v[16:19], v120 offset:57344
    s_waitcnt lgkmcnt(3)
    v_mfma_f32_16x16x32_bf16 v[108:111], v[36:39], a[84:87], v[108:111]
    ds_read_b128 v[20:23], v120 offset:58368
    s_waitcnt lgkmcnt(3)
    v_mfma_f32_16x16x32_bf16 v[108:111], v[40:43], a[88:91], v[108:111]
    ds_read_b128 v[24:27], v120 offset:59392
    s_waitcnt lgkmcnt(3)
    v_mfma_f32_16x16x32_bf16 v[108:111], v[44:47], a[92:95], v[108:111]
    ds_read_b128 v[28:31], v120 offset:60416
    s_waitcnt lgkmcnt(3)
    v_mfma_f32_16x16x32_bf16 v[108:111], v[16:19], a[96:99], v[108:111]
    ds_read_b128 v[32:35], v120 offset:61440
    s_waitcnt lgkmcnt(3)
    v_mfma_f32_16x16x32_bf16 v[108:111], v[20:23], a[100:103], v[108:111]
    ds_read_b128 v[36:39], v120 offset:62464
    s_waitcnt lgkmcnt(3)
    v_mfma_f32_16x16x32_bf16 v[108:111], v[24:27], a[104:107], v[108:111]
    ds_read_b128 v[40:43], v120 offset:63488
    s_waitcnt lgkmcnt(3)
    v_mfma_f32_16x16x32_bf16 v[108:111], v[28:31], a[108:111], v[108:111]
    ds_read_b128 v[44:47], v120 offset:64512
    s_waitcnt lgkmcnt(3)
    v_mfma_f32_16x16x32_bf16 v[108:111], v[32:35], a[112:115], v[108:111]
    s_waitcnt lgkmcnt(2)
    v_mfma_f32_16x16x32_bf16 v[108:111], v[36:39], a[116:119], v[108:111]
    s_waitcnt lgkmcnt(1)
    v_mfma_f32_16x16x32_bf16 v[108:111], v[40:43], a[120:123], v[108:111]
    s_waitcnt lgkmcnt(0)
    v_mfma_f32_16x16x32_bf16 v[108:111], v[44:47], a[124:127], v[108:111]
    s_nop 7
    buffer_store_dword v108, v9, s[4:7], s44 offen
    s_add_u32 s44, s44, 8192
    buffer_store_dword v109, v9, s[4:7], s44 offen
    s_add_u32 s44, s44, 8192
    buffer_store_dword v110, v9, s[4:7], s44 offen
    s_add_u32 s44, s44, 8192
    buffer_store_dword v111, v9, s[4:7], s44 offen
    s_add_u32 s44, s44, 106496
L_p2_F_gax:
    s_cmp_lt_u32 s23, 46
    s_cselect_b32 s25, 5, 7
    s_cmp_ge_u32 s23, 57
    s_cselect_b32 s25, 6, s25
    s_add_u32 s25, s23, s25
    s_cmp_eq_u32 s15, 0
    s_cbranch_scc1 L_p2_F_n0
    s_barrier
    s_cmp_ge_u32 s25, 64
    s_cbranch_scc1 L_p2_F_n1
    s_and_b32 s40, s25, 1
    s_lshl_b32 s40, s40, 2
    s_add_u32 s40, s40, s37
    s_lshr_b32 s41, s25, 1
    s_add_u32 s41, s41, 2
L_po10:
    buffer_load_dword v14, v13, s[4:7], s40 offen offset:0 sc1
    s_add_u32 s17, s17, 1
    s_cmp_gt_u32 s17, 0x400000
    s_cbranch_scc1 L_pe10
    s_waitcnt vmcnt(0)
    v_cmp_gt_u32 vcc, s41, v14
    s_cbranch_vccz L_pe10
    s_sleep 2
    s_branch L_po10
L_pe10:
    s_waitcnt vmcnt(0)
    s_lshl_b32 s40, s22, 6
    s_add_u32 s40, s40, s25
    s_lshl_b32 s41, s40, 13
    s_add_u32 s41, s41, 33554432
    s_lshl_b32 s40, s40, 14
    s_lshl_b32 s42, s32, 13
    s_add_u32 s40, s40, s42
    s_add_u32 s40, s40, 0
    s_cmp_eq_u32 s15, 1
    s_cselect_b32 s40, s41, s40
    s_add_u32 s41, s40, 4096
    s_lshl_b32 s42, s15, 13
    s_add_u32 m0, s42, 73728
    s_nop 0
    buffer_load_dwordx4 v3, s[4:7], s40 offen offset:0 sc1 lds
    buffer_load_dwordx4 v3, s[4:7], s40 offen offset:1024 sc1 lds
    buffer_load_dwordx4 v3, s[4:7], s40 offen offset:2048 sc1 lds
    buffer_load_dwordx4 v3, s[4:7], s40 offen offset:3072 sc1 lds
    s_add_u32 m0, m0, 4096
    s_nop 0
    buffer_load_dwordx4 v3, s[4:7], s41 offen offset:0 sc1 lds
    buffer_load_dwordx4 v3, s[4:7], s41 offen offset:1024 sc1 lds
    buffer_load_dwordx4 v3, s[4:7], s41 offen offset:2048 sc1 lds
    buffer_load_dwordx4 v3, s[4:7], s41 offen offset:3072 sc1 lds
    s_branch L_p2_F_n1
L_p2_F_n0:
    s_cmp_eq_u32 s20, 0
    s_cbranch_scc1 L_p2_F_n5
    s_barrier
    s_branch L_p2_F_n1
L_p2_F_n5:
    v_and_b32 v141, s16, v136
    v_lshlrev_b32 v140, 16, v136
    v_and_b32 v143, s16, v137
    v_lshlrev_b32 v142, 16, v137
    v_and_b32 v145, s16, v138
    v_lshlrev_b32 v144, 16, v138
    v_and_b32 v147, s16, v139
    v_lshlrev_b32 v146, 16, v139
    s_lshl_b32 s41, s22, 13
    s_add_u32 s41, s41, s26
    s_add_u32 s41, s41, 262144
    s_add_u32 s42, s41, 4096
    s_sleep 4
L_p2_F_ra:
    buffer_load_dwordx4 v[16:19], v3, s[4:7], s41 offen offset:0 sc1
    buffer_load_dwordx4 v[20:23], v3, s[4:7], s41 offen offset:1024 sc1
    buffer_load_dwordx4 v[24:27], v3, s[4:7], s41 offen offset:2048 sc1
    buffer_load_dwordx4 v[28:31], v3, s[4:7], s41 offen offset:3072 sc1
    buffer_load_dwordx4 v[32:35], v3, s[4:7], s42 offen offset:0 sc1
    buffer_load_dwordx4 v[36:39], v3, s[4:7], s42 offen offset:1024 sc1
    buffer_load_dwordx4 v[40:43], v3, s[4:7], s42 offen offset:2048 sc1
    buffer_load_dwordx4 v[44:47], v3, s[4:7], s42 offen offset:3072 sc1
    s_add_u32 s17, s17, 4
    s_cmp_gt_u32 s17, 0x400000
    s_waitcnt vmcnt(5)
    v_pk_add_f32 v[16:17], v[16:17], v[24:25]
    v_pk_add_f32 v[18:19], v[18:19], v[26:27]
    s_waitcnt vmcnt(4)
    v_pk_add_f32 v[20:21], v[20:21], v[28:29]
    v_pk_add_f32 v[22:23], v[22:23], v[30:31]
    s_waitcnt vmcnt(3)
    v_pk_add_f32 v[16:17], v[16:17], v[32:33]
    v_pk_add_f32 v[18:19], v[18:19], v[34:35]
    s_waitcnt vmcnt(2)
    v_pk_add_f32 v[20:21], v[20:21], v[36:37]
    v_pk_add_f32 v[22:23], v[22:23], v[38:39]
    s_waitcnt vmcnt(1)
    v_pk_add_f32 v[16:17], v[16:17], v[40:41]
    v_pk_add_f32 v[18:19], v[18:19], v[42:43]
    s_waitcnt vmcnt(0)
    v_pk_add_f32 v[20:21], v[20:21], v[44:45]
    v_pk_add_f32 v[22:23], v[22:23], v[46:47]
    v_pk_add_f32 v[24:25], v[16:17], v[18:19]
    v_pk_add_f32 v[26:27], v[20:21], v[22:23]
    v_pk_add_f32 v[24:25], v[24:25], v[26:27]
    v_cmp_u_f32 vcc, v24, v25
    s_cbranch_scc1 L_p2_F_rax
    s_cbranch_vccnz L_p2_F_ra
L_p2_F_rax:
    v_cvt_pk_bf16_f32 v120, v16, v17
    v_lshlrev_b32 v16, 16, v120
    v_and_b32 v17, s16, v120
    v_cvt_pk_bf16_f32 v120, v18, v19
    v_lshlrev_b32 v18, 16, v120
    v_and_b32 v19, s16, v120
    v_cvt_pk_bf16_f32 v120, v20, v21
    v_lshlrev_b32 v20, 16, v120
    v_and_b32 v21, s16, v120
    v_cvt_pk_bf16_f32 v120, v22, v23
    v_lshlrev_b32 v22, 16, v120
    v_and_b32 v23, s16, v120
    s_barrier
    v_pk_mul_f32 v[16:17], v[16:17], v[168:169]
    v_pk_mul_f32 v[18:19], v[18:19], v[170:171]
    v_pk_mul_f32 v[20:21], v[20:21], v[172:173]
    v_pk_mul_f32 v[22:23], v[22:23], v[174:175]
    v_cvt_pk_bf16_f32 v120, v16, v17
    v_lshlrev_b32 v16, 16, v120
    v_and_b32 v17, s16, v120
    v_cvt_pk_bf16_f32 v120, v18, v19
    v_lshlrev_b32 v18, 16, v120
    v_and_b32 v19, s16, v120
    v_cvt_pk_bf16_f32 v120, v20, v21
    v_lshlrev_b32 v20, 16, v120
    v_and_b32 v21, s16, v120
    v_cvt_pk_bf16_f32 v120, v22, v23
    v_lshlrev_b32 v22, 16, v120
    v_and_b32 v23, s16, v120
    v_pk_add_f32 v[140:141], v[140:141], v[16:17]
    v_pk_add_f32 v[142:143], v[142:143], v[18:19]
    v_pk_add_f32 v[144:145], v[144:145], v[20:21]
    v_pk_add_f32 v[146:147], v[146:147], v[22:23]
    v_cvt_pk_bf16_f32 v120, v140, v141
    v_lshlrev_b32 v140, 16, v120
    v_and_b32 v141, s16, v120
    v_cvt_pk_bf16_f32 v120, v142, v143
    v_lshlrev_b32 v142, 16, v120
    v_and_b32 v143, s16, v120
    v_cvt_pk_bf16_f32 v120, v144, v145
    v_lshlrev_b32 v144, 16, v120
    v_and_b32 v145, s16, v120
    v_cvt_pk_bf16_f32 v120, v146, v147
    v_lshlrev_b32 v146, 16, v120
    v_and_b32 v147, s16, v120
    v_pk_add_f32 v[16:17], v[140:141], v[142:143]
    v_pk_add_f32 v[18:19], v[144:145], v[146:147]
    v_pk_add_f32 v[16:17], v[16:17], v[18:19]
    v_add_f32 v121, v16, v17
    s_nop 1
    v_add_f32_dpp v121, v121, v121 row_ror:1 row_mask:0xf bank_mask:0xf
    s_nop 1
    v_add_f32_dpp v121, v121, v121 row_ror:2 row_mask:0xf bank_mask:0xf
    s_nop 1
    v_add_f32_dpp v121, v121, v121 row_ror:4 row_mask:0xf bank_mask:0xf
    s_nop 1
    v_add_f32_dpp v121, v121, v121 row_ror:8 row_mask:0xf bank_mask:0xf
    v_mov_b32 v120, v121
    s_nop 1
    v_permlane32_swap_b32 v121, v120
    v_add_f32 v121, v121, v120
    v_mov_b32 v120, v121
    s_nop 1
    v_permlane16_swap_b32 v121, v120
    v_add_f32 v121, v121, v120
    v_mul_f32 v121, 0x3b000000, v121
    v_pk_add_f32 v[16:17], v[140:141], v[120:121] op_sel:[0,1] neg_lo:[0,1] neg_hi:[0,1]
    v_pk_add_f32 v[18:19], v[142:143], v[120:121] op_sel:[0,1] neg_lo:[0,1] neg_hi:[0,1]
    v_pk_add_f32 v[20:21], v[144:145], v[120:121] op_sel:[0,1] neg_lo:[0,1] neg_hi:[0,1]
    v_pk_add_f32 v[22:23], v[146:147], v[120:121] op_sel:[0,1] neg_lo:[0,1] neg_hi:[0,1]
    v_pk_mul_f32 v[16:17], v[16:17], v[16:17]
    v_pk_fma_f32 v[16:17], v[18:19], v[18:19], v[16:17]
    v_pk_fma_f32 v[16:17], v[20:21], v[20:21], v[16:17]
    v_pk_fma_f32 v[16:17], v[22:23], v[22:23], v[16:17]
    v_add_f32 v122, v16, v17
    s_nop 1
    v_add_f32_dpp v122, v122, v122 row_ror:1 row_mask:0xf bank_mask:0xf
    s_nop 1
    v_add_f32_dpp v122, v122, v122 row_ror:2 row_mask:0xf bank_mask:0xf
    s_nop 1
    v_add_f32_dpp v122, v122, v122 row_ror:4 row_mask:0xf bank_mask:0xf
    s_nop 1
    v_add_f32_dpp v122, v122, v122 row_ror:8 row_mask:0xf bank_mask:0xf
    v_mov_b32 v120, v122
    s_nop 1
    v_permlane32_swap_b32 v122, v120
    v_add_f32 v122, v122, v120
    v_mov_b32 v120, v122
    s_nop 1
    v_permlane16_swap_b32 v122, v120
    v_add_f32 v122, v122, v120
    v_mul_f32 v122, 0x3b000000, v122
    v_cvt_pk_bf16_f32 v120, v121, v122
    v_lshlrev_b32 v121, 16, v120
    v_and_b32 v122, s16, v120
    v_add_f32 v122, 0x3727c5ac, v122
    v_cvt_pk_bf16_f32 v120, v122, v122
    v_lshlrev_b32 v122, 16, v120
    v_sqrt_f32 v122, v122
    s_nop 0
    v_cvt_pk_bf16_f32 v120, v122, v122
    v_lshlrev_b32 v122, 16, v120
    v_rcp_f32 v122, v122
    v_pk_add_f32 v[16:17], v[140:141], v[120:121] op_sel:[0,1] neg_lo:[0,1] neg_hi:[0,1]
    v_pk_add_f32 v[18:19], v[142:143], v[120:121] op_sel:[0,1] neg_lo:[0,1] neg_hi:[0,1]
    v_pk_add_f32 v[20:21], v[144:145], v[120:121] op_sel:[0,1] neg_lo:[0,1] neg_hi:[0,1]
    v_pk_add_f32 v[22:23], v[146:147], v[120:121] op_sel:[0,1] neg_lo:[0,1] neg_hi:[0,1]
    v_cvt_pk_bf16_f32 v120, v16, v17
    v_lshlrev_b32 v16, 16, v120
    v_and_b32 v17, s16, v120
    v_cvt_pk_bf16_f32 v120, v18, v19
    v_lshlrev_b32 v18, 16, v120
    v_and_b32 v19, s16, v120
    v_cvt_pk_bf16_f32 v120, v20, v21
    v_lshlrev_b32 v20, 16, v120
    v_and_b32 v21, s16, v120
    v_cvt_pk_bf16_f32 v120, v22, v23
    v_lshlrev_b32 v22, 16, v120
    v_and_b32 v23, s16, v120
    v_pk_mul_f32 v[16:17], v[16:17], v[122:123] op_sel_hi:[1,0]
    v_pk_mul_f32 v[18:19], v[18:19], v[122:123] op_sel_hi:[1,0]
    v_pk_mul_f32 v[20:21], v[20:21], v[122:123] op_sel_hi:[1,0]
    v_pk_mul_f32 v[22:23], v[22:23], v[122:123] op_sel_hi:[1,0]
    v_cvt_pk_bf16_f32 v120, v16, v17
    v_lshlrev_b32 v16, 16, v120
    v_and_b32 v17, s16, v120
    v_cvt_pk_bf16_f32 v120, v18, v19
    v_lshlrev_b32 v18, 16, v120
    v_and_b32 v19, s16, v120
    v_cvt_pk_bf16_f32 v120, v20, v21
    v_lshlrev_b32 v20, 16, v120
    v_and_b32 v21, s16, v120
    v_cvt_pk_bf16_f32 v120, v22, v23
    v_lshlrev_b32 v22, 16, v120
    v_and_b32 v23, s16, v120
    v_pk_mul_f32 v[16:17], v[16:17], v[184:185]
    v_pk_mul_f32 v[18:19], v[18:19], v[186:187]
    v_pk_mul_f32 v[20:21], v[20:21], v[188:189]
    v_pk_mul_f32 v[22:23], v[22:23], v[190:191]
    v_cvt_pk_bf16_f32 v120, v16, v17
    v_lshlrev_b32 v16, 16, v120
    v_and_b32 v17, s16, v120
    v_cvt_pk_bf16_f32 v120, v18, v19
    v_lshlrev_b32 v18, 16, v120
    v_and_b32 v19, s16, v120
    v_cvt_pk_bf16_f32 v120, v20, v21
    v_lshlrev_b32 v20, 16, v120
    v_and_b32 v21, s16, v120
    v_cvt_pk_bf16_f32 v120, v22, v23
    v_lshlrev_b32 v22, 16, v120
    v_and_b32 v23, s16, v120
    v_pk_add_f32 v[16:17], v[16:17], v[176:177]
    v_pk_add_f32 v[18:19], v[18:19], v[178:179]
    v_pk_add_f32 v[20:21], v[20:21], v[180:181]
    v_pk_add_f32 v[22:23], v[22:23], v[182:183]
    v_cvt_pk_bf16_f32 v24, v16, v17
    v_cvt_pk_bf16_f32 v25, v18, v19
    v_cvt_pk_bf16_f32 v26, v20, v21
    v_cvt_pk_bf16_f32 v27, v22, v23
    s_lshl_b32 s41, s22, 10
    s_add_u32 s41, s41, s26
    s_add_u32 s41, s41, 786432
    buffer_store_dwordx2 v[24:25], v149, s[4:7], s41 offen offset:0
    buffer_store_dwordx2 v[26:27], v149, s[4:7], s41 offen offset:512
L_p2_F_n1:
    s_waitcnt vmcnt(0)
    s_barrier
    s_add_u32 s27, s27, 1
    s_cmp_lg_u32 s15, 0
    s_cbranch_scc1 L_p2_F_g3
    v_mov_b32 v14, s27
    s_mov_b64 exec, 1
    buffer_store_dword v14, off, s[4:7], s28
    s_mov_b64 exec, -1
    s_nop 15
    buffer_load_dword v150, v6, s[4:7], s29 offen sc1
    s_nop 11
    buffer_load_dword v150, v6, s[4:7], s29 offen sc1
    s_nop 11
    buffer_load_dword v150, v6, s[4:7], s29 offen sc1
    s_nop 11
L_po11:
    buffer_load_dword v150, v6, s[4:7], s29 offen sc1
    s_add_u32 s17, s17, 1
    s_cmp_gt_u32 s17, 0x400000
    s_cbranch_scc1 L_pe11
    s_waitcnt vmcnt(3)
    v_cmp_gt_u32 vcc, s27, v150
    s_cbranch_vccnz L_po11
L_pe11:
L_p2_F_g3:
    s_barrier
    s_cmp_ge_u32 s22, 28
    s_cbranch_scc1 L_p2_F_n2
    s_lshl_b32 s41, s15, 13
    s_add_u32 s41, s41, s26
    s_add_u32 s41, s41, 786432
    s_lshl_b32 s42, s33, 10
    s_cmp_eq_u32 s42, s18
    s_cselect_b32 s42, 0, s19
    s_and_b32 s42, s42, 0x40000000
    s_add_u32 s41, s41, s42
    s_lshl_b32 s42, s33, 14
    s_lshl_b32 s43, s32, 10
    s_add_u32 s42, s42, s43
    s_add_u32 m0, s42, 4096
    s_add_u32 s43, s41, 0
    buffer_load_dwordx4 v8, s[4:7], s43 offen sc1 lds
    s_add_u32 m0, s42, 6144
    s_add_u32 s43, s41, 128
    buffer_load_dwordx4 v8, s[4:7], s43 offen sc1 lds
    s_barrier
    s_add_u32 m0, s42, 8192
    s_add_u32 s43, s41, 256
    buffer_load_dwordx4 v8, s[4:7], s43 offen sc1 lds
    s_add_u32 m0, s42, 10240
    s_add_u32 s43, s41, 384
    buffer_load_dwordx4 v8, s[4:7], s43 offen sc1 lds
    s_barrier
    s_add_u32 m0, s42, 12288
    s_add_u32 s43, s41, 512
    buffer_load_dwordx4 v8, s[4:7], s43 offen sc1 lds
    s_add_u32 m0, s42, 14336
    s_add_u32 s43, s41, 640
    buffer_load_dwordx4 v8, s[4:7], s43 offen sc1 lds
    s_barrier
    s_add_u32 m0, s42, 16384
    s_add_u32 s43, s41, 768
    buffer_load_dwordx4 v8, s[4:7], s43 offen sc1 lds
    s_add_u32 m0, s42, 18432
    s_add_u32 s43, s41, 896
    buffer_load_dwordx4 v8, s[4:7], s43 offen sc1 lds
    s_waitcnt vmcnt(6)
    s_barrier
    ds_read_b128 v[16:19], v7 offset:4096
    ds_read_b128 v[20:23], v151 offset:4096
    ds_read_b128 v[24:27], v7 offset:6144
    s_waitcnt lgkmcnt(2)
    v_mfma_f32_16x16x32_bf16 v[104:107], a[128:131], v[16:19], 0
    ds_read_b128 v[28:31], v151 offset:6144
    v_mfma_f32_16x16x32_bf16 v[108:111], a[192:195], v[16:19], 0
    s_waitcnt lgkmcnt(2)
    v_mfma_f32_16x16x32_bf16 v[104:107], a[132:135], v[20:23], v[104:107]
    s_waitcnt vmcnt(4)
    s_barrier
    ds_read_b128 v[32:35], v7 offset:8192
    v_mfma_f32_16x16x32_bf16 v[108:111], a[196:199], v[20:23], v[108:111]
    s_waitcnt lgkmcnt(2)
    v_mfma_f32_16x16x32_bf16 v[104:107], a[136:139], v[24:27], v[104:107]
    ds_read_b128 v[36:39], v151 offset:8192
    v_mfma_f32_16x16x32_bf16 v[108:111], a[200:203], v[24:27], v[108:111]
    s_waitcnt lgkmcnt(2)
    v_mfma_f32_16x16x32_bf16 v[104:107], a[140:143], v[28:31], v[104:107]
    ds_read_b128 v[40:43], v7 offset:10240
    v_mfma_f32_16x16x32_bf16 v[108:111], a[204:207], v[28:31], v[108:111]
    s_waitcnt lgkmcnt(2)
    v_mfma_f32_16x16x32_bf16 v[104:107], a[144:147], v[32:35], v[104:107]
    ds_read_b128 v[44:47], v151 offset:10240
    v_mfma_f32_16x16x32_bf16 v[108:111], a[208:211], v[32:35], v[108:111]
    s_waitcnt lgkmcnt(2)
    v_mfma_f32_16x16x32_bf16 v[104:107], a[148:151], v[36:39], v[104:107]
    s_waitcnt vmcnt(2)
    s_barrier
    ds_read_b128 v[16:19], v7 offset:12288
    v_mfma_f32_16x16x32_bf16 v[108:111], a[212:215], v[36:39], v[108:111]
    s_waitcnt lgkmcnt(2)
    v_mfma_f32_16x16x32_bf16 v[104:107], a[152:155], v[40:43], v[104:107]
    ds_read_b128 v[20:23], v151 offset:12288
    v_mfma_f32_16x16x32_bf16 v[108:111], a[216:219], v[40:43], v[108:111]
    s_waitcnt lgkmcnt(2)
    v_mfma_f32_16x16x32_bf16 v[104:107], a[156:159], v[44:47], v[104:107]
    ds_read_b128 v[24:27], v7 offset:14336
    v_mfma_f32_16x16x32_bf16 v[108:111], a[220:223], v[44:47], v[108:111]
    s_waitcnt lgkmcnt(2)
    v_mfma_f32_16x16x32_bf16 v[104:107], a[160:163], v[16:19], v[104:107]
    ds_read_b128 v[28:31], v151 offset:14336
    v_mfma_f32_16x16x32_bf16 v[108:111], a[224:227], v[16:19], v[108:111]
    s_waitcnt lgkmcnt(2)
    v_mfma_f32_16x16x32_bf16 v[104:107], a[164:167], v[20:23], v[104:107]
    s_waitcnt vmcnt(0)
    s_barrier
    ds_read_b128 v[32:35], v7 offset:16384
    v_mfma_f32_16x16x32_bf16 v[108:111], a[228:231], v[20:23], v[108:111]
    s_waitcnt lgkmcnt(2)
    v_mfma_f32_16x16x32_bf16 v[104:107], a[168:171], v[24:27], v[104:107]
    ds_read_b128 v[36:39], v151 offset:16384
    v_mfma_f32_16x16x32_bf16 v[108:111], a[232:235], v[24:27], v[108:111]
    s_waitcnt lgkmcnt(2)
    v_mfma_f32_16x16x32_bf16 v[104:107], a[172:175], v[28:31], v[104:107]
    ds_read_b128 v[40:43], v7 offset:18432
    v_mfma_f32_16x16x32_bf16 v[108:111], a[236:239], v[28:31], v[108:111]
    s_waitcnt lgkmcnt(2)
    v_mfma_f32_16x16x32_bf16 v[104:107], a[176:179], v[32:35], v[104:107]
    ds_read_b128 v[44:47], v151 offset:18432
    v_mfma_f32_16x16x32_bf16 v[108:111], a[240:243], v[32:35], v[108:111]
    s_waitcnt lgkmcnt(2)
    v_mfma_f32_16x16x32_bf16 v[104:107], a[180:183], v[36:39], v[104:107]
    v_mfma_f32_16x16x32_bf16 v[108:111], a[244:247], v[36:39], v[108:111]
    s_waitcnt lgkmcnt(1)
    v_mfma_f32_16x16x32_bf16 v[104:107], a[184:187], v[40:43], v[104:107]
    v_mfma_f32_16x16x32_bf16 v[108:111], a[248:251], v[40:43], v[108:111]
    s_waitcnt lgkmcnt(0)
    v_mfma_f32_16x16x32_bf16 v[104:107], a[188:191], v[44:47], v[104:107]
    v_mfma_f32_16x16x32_bf16 v[108:111], a[252:255], v[44:47], v[108:111]
    s_lshl_b32 s41, s22, 12
    s_lshl_b32 s42, s33, 11
    s_add_u32 s41, s41, s42
    s_lshl_b32 s42, s32, 10
    s_add_u32 s41, s41, s42
    s_add_u32 s41, s41, s26
    s_add_u32 s41, s41, 819200
    v_max_f32 v104, 0, v104
    v_max_f32 v105, 0, v105
    v_max_f32 v106, 0, v106
    v_max_f32 v107, 0, v107
    v_max_f32 v108, 0, v108
    v_max_f32 v109, 0, v109
    v_max_f32 v110, 0, v110
    v_max_f32 v111, 0, v111
    v_cvt_pk_bf16_f32 v124, v104, v105
    v_cvt_pk_bf16_f32 v125, v106, v107
    v_cvt_pk_bf16_f32 v126, v108, v109
    v_cvt_pk_bf16_f32 v127, v110, v111
    buffer_store_dwordx4 v[124:127], v3, s[4:7], s41 offen
L_p2_F_n2:
    s_waitcnt vmcnt(0)
    s_barrier
    s_add_u32 s27, s27, 1
    s_cmp_lg_u32 s15, 0
    s_cbranch_scc1 L_p2_F_g4
    v_mov_b32 v14, s27
    s_mov_b64 exec, 1
    buffer_store_dword v14, off, s[4:7], s28
    s_mov_b64 exec, -1
    s_nop 15
    buffer_load_dword v150, v6, s[4:7], s29 offen sc1
    s_nop 11
    buffer_load_dword v150, v6, s[4:7], s29 offen sc1
    s_nop 11
    buffer_load_dword v150, v6, s[4:7], s29 offen sc1
    s_nop 11
L_po12:
    buffer_load_dword v150, v6, s[4:7], s29 offen sc1
    s_add_u32 s17, s17, 1
    s_cmp_gt_u32 s17, 0x400000
    s_cbranch_scc1 L_pe12
    s_waitcnt vmcnt(3)
    v_cmp_gt_u32 vcc, s27, v150
    s_cbranch_vccnz L_po12
L_pe12:
L_p2_F_g4:
    s_barrier
    s_mul_i32 s41, s30, 28672
    s_add_u32 s41, s41, s26
    s_add_u32 s41, s41, 819200
    s_lshl_b32 s42, s15, 11
    s_add_u32 s41, s41, s42
    s_add_u32 s43, s41, s19
    s_add_u32 s41, s41, s18
    s_lshl_b32 s42, s15, 10
    s_add_u32 m0, s42, 4096
    v_add_u32 v120, 4096, v3
    buffer_load_dwordx4 v3, s[4:7], s41 offen sc1 lds
    s_add_u32 m0, m0, 4096
    s_add_u32 s41, s41, 8192
    buffer_load_dwordx4 v3, s[4:7], s41 offen sc1 lds
    s_add_u32 m0, m0, 4096
    s_add_u32 s41, s41, 8192
    s_barrier
    buffer_load_dwordx4 v3, s[4:7], s41 offen sc1 lds
    s_add_u32 m0, m0, 4096
    s_add_u32 s41, s41, 8192
    buffer_load_dwordx4 v3, s[4:7], s41 offen sc1 lds
    s_add_u32 m0, m0, 4096
    s_mov_b32 s41, s43
    s_barrier
    buffer_load_dwordx4 v3, s[4:7], s41 offen sc1 lds
    s_add_u32 m0, m0, 4096
    s_add_u32 s41, s41, 8192
    buffer_load_dwordx4 v3, s[4:7], s41 offen sc1 lds
    s_add_u32 m0, m0, 4096
    s_add_u32 s41, s41, 8192
    s_barrier
    s_lshl_b32 s44, s18, 7
    s_add_u32 s44, s44, s26
    s_add_u32 s44, s44, 524288
    s_waitcnt vmcnt(4)
    s_barrier
    ds_read_b128 v[16:19], v120 offset:0
    ds_read_b128 v[20:23], v120 offset:1024
    ds_read_b128 v[24:27], v120 offset:2048
    ds_read_b128 v[28:31], v120 offset:3072
    s_waitcnt lgkmcnt(3)
    v_mfma_f32_16x16x32_bf16 v[104:107], v[16:19], v[200:203], 0
    ds_read_b128 v[32:35], v120 offset:4096
    s_waitcnt lgkmcnt(3)
    v_mfma_f32_16x16x32_bf16 v[104:107], v[20:23], v[204:207], v[104:107]
    ds_read_b128 v[36:39], v120 offset:5120
    buffer_load_dwordx4 v3, s[4:7], s41 offen sc1 lds
    s_add_u32 m0, m0, 4096
    s_add_u32 s41, s41, 8192
    s_waitcnt lgkmcnt(3)
    v_mfma_f32_16x16x32_bf16 v[104:107], v[24:27], v[208:211], v[104:107]
    ds_read_b128 v[40:43], v120 offset:6144
    s_waitcnt lgkmcnt(3)
    v_mfma_f32_16x16x32_bf16 v[104:107], v[28:31], v[212:215], v[104:107]
    ds_read_b128 v[44:47], v120 offset:7168
    s_waitcnt lgkmcnt(3)
    v_mfma_f32_16x16x32_bf16 v[104:107], v[32:35], v[216:219], v[104:107]
    s_waitcnt vmcnt(3)
    s_barrier
    ds_read_b128 v[16:19], v120 offset:8192
    s_waitcnt lgkmcnt(3)
    v_mfma_f32_16x16x32_bf16 v[104:107], v[36:39], v[220:223], v[104:107]
    ds_read_b128 v[20:23], v120 offset:9216
    buffer_load_dwordx4 v3, s[4:7], s41 offen sc1 lds
    s_add_u32 m0, m0, 4096
    s_add_u32 s41, s41, 8192
    s_waitcnt lgkmcnt(3)
    v_mfma_f32_16x16x32_bf16 v[104:107], v[40:43], v[224:227], v[104:107]
    ds_read_b128 v[24:27], v120 offset:10240
    s_waitcnt lgkmcnt(3)
    v_mfma_f32_16x16x32_bf16 v[104:107], v[44:47], v[228:231], v[104:107]
    ds_read_b128 v[28:31], v120 offset:11264
    s_waitcnt lgkmcnt(3)
    v_mfma_f32_16x16x32_bf16 v[104:107], v[16:19], v[232:235], v[104:107]
    ds_read_b128 v[32:35], v120 offset:12288
    s_waitcnt lgkmcnt(3)
    v_mfma_f32_16x16x32_bf16 v[104:107], v[20:23], v[236:239], v[104:107]
    ds_read_b128 v[36:39], v120 offset:13312
    s_waitcnt lgkmcnt(3)
    v_mfma_f32_16x16x32_bf16 v[104:107], v[24:27], v[240:243], v[104:107]
    s_waitcnt vmcnt(2)
    s_barrier
    ds_read_b128 v[40:43], v120 offset:16384
    s_waitcnt lgkmcnt(3)
    v_mfma_f32_16x16x32_bf16 v[104:107], v[28:31], v[244:247], v[104:107]
    ds_read_b128 v[44:47], v120 offset:17408
    s_waitcnt lgkmcnt(3)
    v_mfma_f32_16x16x32_bf16 v[104:107], v[32:35], v[248:251], v[104:107]
    ds_read_b128 v[16:19], v120 offset:18432
    s_waitcnt lgkmcnt(3)
    v_mfma_f32_16x16x32_bf16 v[104:107], v[36:39], v[252:255], v[104:107]
    s_cmp_lg_u32 s19, 1024
    s_cbranch_scc1 L_p2_F_gbh
    ds_read_b128 v[20:23], v120 offset:19456
    s_waitcnt lgkmcnt(3)
    v_mfma_f32_16x16x32_bf16 v[108:111], v[40:43], v[200:203], 0
    ds_read_b128 v[24:27], v120 offset:20480
    s_waitcnt lgkmcnt(3)
    v_mfma_f32_16x16x32_bf16 v[108:111], v[44:47], v[204:207], v[108:111]
    ds_read_b128 v[28:31], v120 offset:21504
    s_waitcnt lgkmcnt(3)
    v_mfma_f32_16x16x32_bf16 v[108:111], v[16:19], v[208:211], v[108:111]
    ds_read_b128 v[32:35], v120 offset:22528
    s_waitcnt lgkmcnt(3)
    v_mfma_f32_16x16x32_bf16 v[108:111], v[20:23], v[212:215], v[108:111]
    ds_read_b128 v[36:39], v120 offset:23552
    buffer_store_dword v104, v9, s[4:7], s44 offen
    s_add_u32 s44, s44, 8192
    s_waitcnt lgkmcnt(3)
    v_mfma_f32_16x16x32_bf16 v[108:111], v[24:27], v[216:219], v[108:111]
    s_waitcnt vmcnt(1)
    s_barrier
    ds_read_b128 v[40:43], v120 offset:24576
    s_waitcnt lgkmcnt(3)
    v_mfma_f32_16x16x32_bf16 v[108:111], v[28:31], v[220:223], v[108:111]
    ds_read_b128 v[44:47], v120 offset:25600
    buffer_store_dword v105, v9, s[4:7], s44 offen
    s_add_u32 s44, s44, 8192
    s_waitcnt lgkmcnt(3)
    v_mfma_f32_16x16x32_bf16 v[108:111], v[32:35], v[224:227], v[108:111]
    ds_read_b128 v[16:19], v120 offset:26624
    s_waitcnt lgkmcnt(3)
    v_mfma_f32_16x16x32_bf16 v[108:111], v[36:39], v[228:231], v[108:111]
    ds_read_b128 v[20:23], v120 offset:27648
    buffer_store_dword v106, v9, s[4:7], s44 offen
    s_add_u32 s44, s44, 8192
    s_waitcnt lgkmcnt(3)
    v_mfma_f32_16x16x32_bf16 v[108:111], v[40:43], v[232:235], v[108:111]
    ds_read_b128 v[24:27], v120 offset:28672
    s_waitcnt lgkmcnt(3)
    v_mfma_f32_16x16x32_bf16 v[108:111], v[44:47], v[236:239], v[108:111]
    ds_read_b128 v[28:31], v120 offset:29696
    buffer_store_dword v107, v9, s[4:7], s44 offen
    s_add_u32 s44, s44, 106496
    s_waitcnt lgkmcnt(3)
    v_mfma_f32_16x16x32_bf16 v[108:111], v[16:19], v[240:243], v[108:111]
    s_waitcnt lgkmcnt(2)
    v_mfma_f32_16x16x32_bf16 v[108:111], v[20:23], v[244:247], v[108:111]
    s_waitcnt lgkmcnt(1)
    v_mfma_f32_16x16x32_bf16 v[108:111], v[24:27], v[248:251], v[108:111]
    s_waitcnt lgkmcnt(0)
    v_mfma_f32_16x16x32_bf16 v[108:111], v[28:31], v[252:255], v[108:111]
    s_nop 7
    buffer_store_dword v108, v9, s[4:7], s44 offen
    s_add_u32 s44, s44, 8192
    buffer_store_dword v109, v9, s[4:7], s44 offen
    s_add_u32 s44, s44, 8192
    buffer_store_dword v110, v9, s[4:7], s44 offen
    s_add_u32 s44, s44, 8192
    buffer_store_dword v111, v9, s[4:7], s44 offen
    s_add_u32 s44, s44, 106496
L_p2_F_gbx:
    s_or_b32 s40, s15, s20
    s_cbranch_scc1 L_p2_F_n3
    s_lshl_b32 s41, s22, 13
    s_add_u32 s41, s41, s26
    s_add_u32 s41, s41, 524288
    s_add_u32 s42, s41, 4096
    s_sleep 4
L_p2_F_rb:
    buffer_load_dwordx4 v[16:19], v3, s[4:7], s41 offen offset:0 sc1
    buffer_load_dwordx4 v[20:23], v3, s[4:7], s41 offen offset:1024 sc1
    buffer_load_dwordx4 v[24:27], v3, s[4:7], s41 offen offset:2048 sc1
    buffer_load_dwordx4 v[28:31], v3, s[4:7], s41 offen offset:3072 sc1
    buffer_load_dwordx4 v[32:35], v3, s[4:7], s42 offen offset:0 sc1
    buffer_load_dwordx4 v[36:39], v3, s[4:7], s42 offen offset:1024 sc1
    buffer_load_dwordx4 v[40:43], v3, s[4:7], s42 offen offset:2048 sc1
    buffer_load_dwordx4 v[44:47], v3, s[4:7], s42 offen offset:3072 sc1
    s_add_u32 s17, s17, 4
    s_cmp_gt_u32 s17, 0x400000
    s_waitcnt vmcnt(5)
    v_pk_add_f32 v[16:17], v[16:17], v[24:25]
    v_pk_add_f32 v[18:19], v[18:19], v[26:27]
    s_waitcnt vmcnt(4)
    v_pk_add_f32 v[20:21], v[20:21], v[28:29]
    v_pk_add_f32 v[22:23], v[22:23], v[30:31]
    s_waitcnt vmcnt(3)
    v_pk_add_f32 v[16:17], v[16:17], v[32:33]
    v_pk_add_f32 v[18:19], v[18:19], v[34:35]
    s_waitcnt vmcnt(2)
    v_pk_add_f32 v[20:21], v[20:21], v[36:37]
    v_pk_add_f32 v[22:23], v[22:23], v[38:39]
    s_waitcnt vmcnt(1)
    v_pk_add_f32 v[16:17], v[16:17], v[40:41]
    v_pk_add_f32 v[18:19], v[18:19], v[42:43]
    s_waitcnt vmcnt(0)
    v_pk_add_f32 v[20:21], v[20:21], v[44:45]
    v_pk_add_f32 v[22:23], v[22:23], v[46:47]
    v_pk_add_f32 v[24:25], v[16:17], v[18:19]
    v_pk_add_f32 v[26:27], v[20:21], v[22:23]
    v_pk_add_f32 v[24:25], v[24:25], v[26:27]
    v_cmp_u_f32 vcc, v24, v25
    s_cbranch_scc1 L_p2_F_rbx
    s_cbranch_vccnz L_p2_F_rb
L_p2_F_rbx:
    v_cvt_pk_bf16_f32 v120, v16, v17
    v_lshlrev_b32 v16, 16, v120
    v_and_b32 v17, s16, v120
    v_cvt_pk_bf16_f32 v120, v18, v19
    v_lshlrev_b32 v18, 16, v120
    v_and_b32 v19, s16, v120
    v_cvt_pk_bf16_f32 v120, v20, v21
    v_lshlrev_b32 v20, 16, v120
    v_and_b32 v21, s16, v120
    v_cvt_pk_bf16_f32 v120, v22, v23
    v_lshlrev_b32 v22, 16, v120
    v_and_b32 v23, s16, v120
    v_pk_mul_f32 v[16:17], v[16:17], v[192:193]
    v_pk_mul_f32 v[18:19], v[18:19], v[194:195]
    v_pk_mul_f32 v[20:21], v[20:21], v[196:197]
    v_pk_mul_f32 v[22:23], v[22:23], v[198:199]
    v_cvt_pk_bf16_f32 v120, v16, v17
    v_lshlrev_b32 v16, 16, v120
    v_and_b32 v17, s16, v120
    v_cvt_pk_bf16_f32 v120, v18, v19
    v_lshlrev_b32 v18, 16, v120
    v_and_b32 v19, s16, v120
    v_cvt_pk_bf16_f32 v120, v20, v21
    v_lshlrev_b32 v20, 16, v120
    v_and_b32 v21, s16, v120
    v_cvt_pk_bf16_f32 v120, v22, v23
    v_lshlrev_b32 v22, 16, v120
    v_and_b32 v23, s16, v120
    v_pk_add_f32 v[16:17], v[16:17], v[140:141]
    v_pk_add_f32 v[18:19], v[18:19], v[142:143]
    v_pk_add_f32 v[20:21], v[20:21], v[144:145]
    v_pk_add_f32 v[22:23], v[22:23], v[146:147]
    v_cvt_pk_bf16_f32 v24, v16, v17
    v_cvt_pk_bf16_f32 v25, v18, v19
    v_cvt_pk_bf16_f32 v26, v20, v21
    v_cvt_pk_bf16_f32 v27, v22, v23
    v_add_u32 v120, s46, v149
    global_store_dwordx2 v120, v[24:25], s[76:77] offset:0
    global_store_dwordx2 v120, v[26:27], s[76:77] offset:512
    s_cmp_ge_u32 s25, 64
    s_cbranch_scc1 L_p2_F_n4
    buffer_store_dwordx4 v[152:155], v3, s[4:7], s41 offen offset:0
    buffer_store_dwordx4 v[152:155], v3, s[4:7], s41 offen offset:1024
    buffer_store_dwordx4 v[152:155], v3, s[4:7], s41 offen offset:2048
    buffer_store_dwordx4 v[152:155], v3, s[4:7], s41 offen offset:3072
    buffer_store_dwordx4 v[152:155], v3, s[4:7], s42 offen offset:0
    buffer_store_dwordx4 v[152:155], v3, s[4:7], s42 offen offset:1024
    buffer_store_dwordx4 v[152:155], v3, s[4:7], s42 offen offset:2048
    buffer_store_dwordx4 v[152:155], v3, s[4:7], s42 offen offset:3072
L_p2_F_n4:
L_p2_F_n3:
    s_lshl_b32 s41, s22, 2
    s_add_u32 s41, s41, s15
    s_lshl_b32 s41, s41, 11
    s_add_u32 s41, s41, s26
    s_add_u32 s41, s41, 262144
    s_cmp_ge_u32 s25, 64
    s_cbranch_scc1 L_p2_F_end
    s_barrier
    buffer_store_dwordx4 v[152:155], v3, s[4:7], s41 offen offset:0
    buffer_store_dwordx4 v[152:155], v3, s[4:7], s41 offen offset:1024
    s_mov_b32 s23, s25
    s_branch L_p2_F
L_p2_F_end:
    s_endpgm
L_p2_F_kd:
    s_cmp_ge_u32 s23, 62
    s_cbranch_scc1 L_p2_F_ke
    s_sleep 6
L_p2_F_ke:
    buffer_load_dwordx4 v[80:83], v3, s[4:7], s45 offen offset:0 sc1
    buffer_load_dwordx4 v[84:87], v3, s[4:7], s45 offen offset:1024 sc1
    s_branch L_p2_F_kc
L_p2_F_gah:
    s_nop 5
    buffer_store_dword v104, v9, s[4:7], s44 offen
    s_add_u32 s44, s44, 8192
    buffer_store_dword v105, v9, s[4:7], s44 offen
    s_add_u32 s44, s44, 8192
    buffer_store_dword v106, v9, s[4:7], s44 offen
    s_add_u32 s44, s44, 8192
    buffer_store_dword v107, v9, s[4:7], s44 offen
    s_add_u32 s44, s44, 106496
    s_waitcnt lgkmcnt(0)
    s_branch L_p2_F_gax
L_p2_F_gbh:
    s_nop 5
    buffer_store_dword v104, v9, s[4:7], s44 offen
    s_add_u32 s44, s44, 8192
    buffer_store_dword v105, v9, s[4:7], s44 offen
    s_add_u32 s44, s44, 8192
    buffer_store_dword v106, v9, s[4:7], s44 offen
    s_add_u32 s44, s44, 8192
    buffer_store_dword v107, v9, s[4:7], s44 offen
    s_add_u32 s44, s44, 106496
    s_waitcnt lgkmcnt(0)
    s_branch L_p2_F_gbx
L_p2_S:
    s_cmp_eq_u32 s21, 0
    s_cselect_b32 s18, 1024, 0
    s_cmp_ge_u32 s23, 63
    s_cselect_b32 s18, s18, 0
    s_cselect_b32 s19, 0x40000000, 0
    s_cselect_b32 s20, 16, 0
    s_add_u32 s19, s19, 1024
    s_lshr_b32 s40, s18, 6
    s_xor_b32 s40, s40, s22
    s_and_b32 s20, s20, s40
    s_lshl_b32 s40, s23, 5
    s_add_u32 s40, s40, s22
    s_lshl_b32 s46, s40, 10
    s_lshl_b32 s40, s22, 6
    s_add_u32 s40, s40, s23
    s_lshl_b32 s45, s40, 12
    s_add_u32 s45, s45, 51380224
    s_lshl_b32 s40, s33, 11
    s_add_u32 s45, s45, s40
    buffer_load_dwordx4 v[80:83], v3, s[4:7], s45 offen offset:0 sc1
    buffer_load_dwordx4 v[84:87], v3, s[4:7], s45 offen offset:1024 sc1
    buffer_load_dwordx2 v[136:137], v149, s[8:11], s46 offen offset:0
    buffer_load_dwordx2 v[138:139], v149, s[8:11], s46 offen offset:512
    s_lshl_b32 s40, s32, 12
    s_add_u32 s40, s40, 81920
    v_add_u32 v120, s40, v3
    ds_read_b128 v[16:19], v120 offset:0
    ds_read_b128 v[20:23], v120 offset:1024
    ds_read_b128 v[24:27], v120 offset:2048
    ds_read_b128 v[28:31], v120 offset:3072
    v_add_u32 v120, 90112, v3
    ds_read_b128 v[32:35], v120 offset:0
    ds_read_b128 v[36:39], v120 offset:1024
    ds_read_b128 v[40:43], v120 offset:2048
    ds_read_b128 v[44:47], v120 offset:3072
    ds_read_b128 v[48:51], v120 offset:4096
    ds_read_b128 v[52:55], v120 offset:5120
    ds_read_b128 v[56:59], v120 offset:6144
    ds_read_b128 v[60:63], v120 offset:7168
    s_lshl_b32 s40, s33, 12
    v_add_u32 v120, s40, v120
    ds_read_b128 v[64:67], v120 offset:8192
    ds_read_b128 v[68:71], v120 offset:9216
    ds_read_b128 v[72:75], v120 offset:10240
    ds_read_b128 v[76:79], v120 offset:11264
    s_waitcnt lgkmcnt(11)
    v_mfma_f32_16x16x32_bf16 v[92:95], v[32:35], v[16:19], 0
    s_waitcnt lgkmcnt(10)
    v_mfma_f32_16x16x32_bf16 v[92:95], v[36:39], v[20:23], v[92:95]
    s_waitcnt lgkmcnt(9)
    v_mfma_f32_16x16x32_bf16 v[92:95], v[40:43], v[24:27], v[92:95]
    s_waitcnt lgkmcnt(8)
    v_mfma_f32_16x16x32_bf16 v[92:95], v[44:47], v[28:31], v[92:95]
    s_waitcnt lgkmcnt(7)
    v_mfma_f32_16x16x32_bf16 v[96:99], v[48:51], v[16:19], 0
    s_waitcnt lgkmcnt(6)
    v_mfma_f32_16x16x32_bf16 v[96:99], v[52:55], v[20:23], v[96:99]
    s_waitcnt lgkmcnt(5)
    v_mfma_f32_16x16x32_bf16 v[96:99], v[56:59], v[24:27], v[96:99]
    s_waitcnt lgkmcnt(4)
    v_mfma_f32_16x16x32_bf16 v[96:99], v[60:63], v[28:31], v[96:99]
    v_mov_b64 v[100:101], 0
    v_mov_b64 v[102:103], 0
    v_cvt_pk_bf16_f32 v120, v92, v93
    v_lshlrev_b32 v92, 16, v120
    v_and_b32 v93, s16, v120
    v_mul_f32 v92, s34, v92
    v_mul_f32 v93, s34, v93
    v_cvt_pk_bf16_f32 v120, v92, v93
    v_lshlrev_b32 v92, 16, v120
    v_and_b32 v93, s16, v120
    v_cvt_pk_bf16_f32 v120, v94, v95
    v_lshlrev_b32 v94, 16, v120
    v_and_b32 v95, s16, v120
    v_mul_f32 v94, s34, v94
    v_mul_f32 v95, s34, v95
    v_cvt_pk_bf16_f32 v120, v94, v95
    v_lshlrev_b32 v94, 16, v120
    v_and_b32 v95, s16, v120
    v_cvt_pk_bf16_f32 v120, v96, v97
    v_lshlrev_b32 v96, 16, v120
    v_and_b32 v97, s16, v120
    v_mul_f32 v96, s34, v96
    v_mul_f32 v97, s34, v97
    v_cvt_pk_bf16_f32 v120, v96, v97
    v_lshlrev_b32 v96, 16, v120
    v_and_b32 v97, s16, v120
    v_cvt_pk_bf16_f32 v120, v98, v99
    v_lshlrev_b32 v98, 16, v120
    v_and_b32 v99, s16, v120
    v_mul_f32 v98, s34, v98
    v_mul_f32 v99, s34, v99
    v_cvt_pk_bf16_f32 v120, v98, v99
    v_lshlrev_b32 v98, 16, v120
    v_and_b32 v99, s16, v120
    s_lshl_b32 s41, s32, 4
    v_add_u32 v120, s41, v10
    v_mov_b32 v122, 0xce6e4000
    v_cmp_le_i32 vcc, 0, v120
    s_nop 1
    v_cndmask_b32 v92, v122, v92, vcc
    v_cmp_le_i32 vcc, 1, v120
    s_nop 1
    v_cndmask_b32 v93, v122, v93, vcc
    v_cmp_le_i32 vcc, 2, v120
    s_nop 1
    v_cndmask_b32 v94, v122, v94, vcc
    v_cmp_le_i32 vcc, 3, v120
    s_nop 1
    v_cndmask_b32 v95, v122, v95, vcc
    v_cmp_le_i32 vcc, 16, v120
    s_nop 1
    v_cndmask_b32 v96, v122, v96, vcc
    v_cmp_le_i32 vcc, 17, v120
    s_nop 1
    v_cndmask_b32 v97, v122, v97, vcc
    v_cmp_le_i32 vcc, 18, v120
    s_nop 1
    v_cndmask_b32 v98, v122, v98, vcc
    v_cmp_le_i32 vcc, 19, v120
    s_nop 1
    v_cndmask_b32 v99, v122, v99, vcc
    v_max3_f32 v121, v92, v93, v94
    v_max3_f32 v121, v121, v95, v96
    v_max3_f32 v121, v121, v97, v98
    v_max_f32 v121, v121, v99
    v_mov_b32 v120, v121
    s_nop 1
    v_permlane32_swap_b32 v121, v120
    v_max_f32 v121, v121, v120
    v_mov_b32 v120, v121
    s_nop 1
    v_permlane16_swap_b32 v121, v120
    v_max_f32 v121, v121, v120
    v_sub_f32 v92, v92, v121
    v_sub_f32 v93, v93, v121
    v_sub_f32 v94, v94, v121
    v_sub_f32 v95, v95, v121
    v_sub_f32 v96, v96, v121
    v_sub_f32 v97, v97, v121
    v_sub_f32 v98, v98, v121
    v_sub_f32 v99, v99, v121
    v_mul_f32 v92, s35, v92
    v_mul_f32 v93, s35, v93
    v_mul_f32 v94, s35, v94
    v_mul_f32 v95, s35, v95
    v_mul_f32 v96, s35, v96
    v_mul_f32 v97, s35, v97
    v_mul_f32 v98, s35, v98
    v_mul_f32 v99, s35, v99
    v_exp_f32 v92, v92
    v_exp_f32 v93, v93
    v_exp_f32 v94, v94
    v_exp_f32 v95, v95
    v_exp_f32 v96, v96
    v_exp_f32 v97, v97
    v_exp_f32 v98, v98
    v_exp_f32 v99, v99
    v_add_f32 v122, v92, v93
    v_add_f32 v122, v122, v94
    v_add_f32 v122, v122, v95
    v_add_f32 v122, v122, v96
    v_add_f32 v122, v122, v97
    v_add_f32 v122, v122, v98
    v_add_f32 v122, v122, v99
L_p2_S_kc:
    s_waitcnt vmcnt(0)
    s_add_u32 s17, s17, 1
    s_cmp_gt_u32 s17, 0x400000
    v_max3_u32 v120, v80, v81, v82
    v_max3_u32 v120, v120, v83, v84
    v_max3_u32 v120, v120, v85, v86
    v_max_u32 v120, v120, v87
    v_cmp_eq_u32 vcc, -1, v120
    s_cbranch_scc1 L_p2_S_kx
    s_cbranch_vccnz L_p2_S_kd
L_p2_S_kx:
    s_cmp_eq_u32 s32, 1
    s_cselect_b64 vcc, -1, 0
    v_cndmask_b32 v89, v81, v85, vcc
    v_cndmask_b32 v91, v83, v87, vcc
    ds_write2_b32 v5, v89, v91 offset0:0 offset1:8
    s_waitcnt lgkmcnt(0)
    s_barrier
    ds_read_b128 v[128:131], v3 offset:0
    ds_read_b128 v[132:135], v3 offset:1024
    s_waitcnt lgkmcnt(1)
    v_smfmac_f32_16x16x64_bf16 v[100:103], v[128:131], v[16:23], v4
    s_waitcnt lgkmcnt(0)
    v_smfmac_f32_16x16x64_bf16 v[100:103], v[132:135], v[24:31], v4
    s_nop 7
    v_add_f32 v100, v100, v101
    v_add_f32 v101, v102, v103
    v_cvt_pk_bf16_f32 v120, v100, v101
    v_lshlrev_b32 v100, 16, v120
    v_and_b32 v101, s16, v120
    v_mul_f32 v100, s34, v100
    v_mul_f32 v101, s34, v101
    v_cvt_pk_bf16_f32 v120, v100, v101
    v_lshlrev_b32 v100, 16, v120
    v_and_b32 v101, s16, v120
    v_max3_f32 v103, v121, v100, v101
    v_mov_b32 v120, v103
    s_nop 1
    v_permlane32_swap_b32 v103, v120
    v_max_f32 v103, v103, v120
    v_mov_b32 v120, v103
    s_nop 1
    v_permlane16_swap_b32 v103, v120
    v_max_f32 v103, v103, v120
    v_sub_f32 v100, v100, v103
    v_sub_f32 v101, v101, v103
    v_sub_f32 v102, v121, v103
    v_mul_f32 v100, s35, v100
    v_mul_f32 v101, s35, v101
    v_mul_f32 v102, s35, v102
    v_exp_f32 v100, v100
    v_exp_f32 v101, v101
    v_exp_f32 v102, v102
    v_add_f32 v103, v100, v101
    v_fmac_f32 v103, v102, v122
    v_mov_b32 v120, v103
    s_nop 1
    v_permlane32_swap_b32 v103, v120
    v_add_f32 v103, v103, v120
    v_mov_b32 v120, v103
    s_nop 1
    v_permlane16_swap_b32 v103, v120
    v_add_f32 v103, v103, v120
    v_rcp_f32 v103, v103
    s_nop 0
    v_mul_f32 v102, v102, v103
    v_pk_mul_f32 v[100:101], v[100:101], v[102:103] op_sel:[0,1]
    v_pk_mul_f32 v[92:93], v[92:93], v[102:103] op_sel_hi:[1,0]
    v_pk_mul_f32 v[94:95], v[94:95], v[102:103] op_sel_hi:[1,0]
    v_pk_mul_f32 v[96:97], v[96:97], v[102:103] op_sel_hi:[1,0]
    v_pk_mul_f32 v[98:99], v[98:99], v[102:103] op_sel_hi:[1,0]
    v_cvt_pk_bf16_f32 v124, v92, v93
    v_cvt_pk_bf16_f32 v125, v94, v95
    v_cvt_pk_bf16_f32 v126, v96, v97
    v_cvt_pk_bf16_f32 v127, v98, v99
    v_cvt_pk_bf16_f32 v12, v100, v101
    s_nop 0
    v_mfma_f32_16x16x32_bf16 v[104:107], v[64:67], v[124:127], 0
    v_mfma_f32_16x16x32_bf16 v[108:111], v[68:71], v[124:127], 0
    v_mfma_f32_16x16x32_bf16 v[112:115], v[72:75], v[124:127], 0
    v_mfma_f32_16x16x32_bf16 v[116:119], v[76:79], v[124:127], 0
    v_mfma_f32_16x16x16_bf16 v[104:107], v[80:81], v[12:13], v[104:107]
    v_mfma_f32_16x16x16_bf16 v[108:111], v[82:83], v[12:13], v[108:111]
    v_mfma_f32_16x16x16_bf16 v[112:115], v[84:85], v[12:13], v[112:115]
    v_mfma_f32_16x16x16_bf16 v[116:119], v[86:87], v[12:13], v[116:119]
    s_lshl_b32 s41, s22, 13
    s_lshl_b32 s42, s33, 12
    s_add_u32 s41, s41, s42
    s_lshl_b32 s42, s32, 10
    s_add_u32 s41, s41, s42
    s_add_u32 s41, s41, s26
    v_cvt_pk_bf16_f32 v16, v104, v105
    v_cvt_pk_bf16_f32 v17, v106, v107
    v_cvt_pk_bf16_f32 v18, v108, v109
    v_cvt_pk_bf16_f32 v19, v110, v111
    buffer_store_dwordx4 v[16:19], v3, s[4:7], s41 offen offset:0 sc1
    v_cvt_pk_bf16_f32 v20, v112, v113
    v_cvt_pk_bf16_f32 v21, v114, v115
    v_cvt_pk_bf16_f32 v22, v116, v117
    v_cvt_pk_bf16_f32 v23, v118, v119
    buffer_store_dwordx4 v[20:23], v3, s[4:7], s41 offen offset:2048 sc1
    s_waitcnt vmcnt(0)
    s_barrier
    s_add_u32 s27, s27, 1
    s_cmp_lg_u32 s15, 0
    s_cbranch_scc1 L_p2_S_g1
    v_mov_b32 v14, s27
    s_mov_b64 exec, 1
    buffer_store_dword v14, off, s[4:7], s28 sc1
    s_mov_b64 exec, -1
    s_nop 15
    buffer_load_dword v150, v6, s[4:7], s29 offen sc1
    s_nop 11
    buffer_load_dword v150, v6, s[4:7], s29 offen sc1
    s_nop 11
    buffer_load_dword v150, v6, s[4:7], s29 offen sc1
    s_nop 11
L_po13:
    buffer_load_dword v150, v6, s[4:7], s29 offen sc1
    s_add_u32 s17, s17, 1
    s_cmp_gt_u32 s17, 0x400000
    s_cbranch_scc1 L_pe13
    s_waitcnt vmcnt(3)
    v_cmp_gt_u32 vcc, s27, v150
    s_cbranch_vccnz L_po13
L_pe13:
L_p2_S_g1:
    s_barrier
    s_lshl_b32 s41, s30, 16
    s_add_u32 s41, s41, s26
    s_lshl_b32 s42, s15, 11
    s_add_u32 s41, s41, s42
    s_add_u32 s43, s41, s19
    s_add_u32 s41, s41, s18
    s_lshl_b32 s42, s15, 10
    s_add_u32 m0, s42, 4096
    v_add_u32 v120, 4096, v3
    buffer_load_dwordx4 v3, s[4:7], s41 offen sc1 lds
    s_add_u32 m0, m0, 4096
    s_add_u32 s41, s41, 8192
    buffer_load_dwordx4 v3, s[4:7], s41 offen sc1 lds
    s_add_u32 m0, m0, 4096
    s_add_u32 s41, s41, 8192
    s_barrier
    buffer_load_dwordx4 v3, s[4:7], s41 offen sc1 lds
    s_add_u32 m0, m0, 4096
    s_add_u32 s41, s41, 8192
    buffer_load_dwordx4 v3, s[4:7], s41 offen sc1 lds
    s_add_u32 m0, m0, 4096
    s_add_u32 s41, s41, 8192
    s_barrier
    buffer_load_dwordx4 v3, s[4:7], s41 offen sc1 lds
    s_add_u32 m0, m0, 4096
    s_add_u32 s41, s41, 8192
    buffer_load_dwordx4 v3, s[4:7], s41 offen sc1 lds
    s_add_u32 m0, m0, 4096
    s_add_u32 s41, s41, 8192
    s_barrier
    s_lshl_b32 s44, s18, 7
    s_add_u32 s44, s44, s26
    s_add_u32 s44, s44, 262144
    s_waitcnt vmcnt(4)
    s_barrier
    ds_read_b128 v[16:19], v120 offset:0
    ds_read_b128 v[20:23], v120 offset:1024
    ds_read_b128 v[24:27], v120 offset:2048
    ds_read_b128 v[28:31], v120 offset:3072
    s_waitcnt lgkmcnt(3)
    v_mfma_f32_16x16x32_bf16 v[104:107], v[16:19], a[0:3], 0
    ds_read_b128 v[32:35], v120 offset:4096
    s_waitcnt lgkmcnt(3)
    v_mfma_f32_16x16x32_bf16 v[104:107], v[20:23], a[4:7], v[104:107]
    ds_read_b128 v[36:39], v120 offset:5120
    buffer_load_dwordx4 v3, s[4:7], s41 offen sc1 lds
    s_add_u32 m0, m0, 4096
    s_add_u32 s41, s41, 8192
    s_waitcnt lgkmcnt(3)
    v_mfma_f32_16x16x32_bf16 v[104:107], v[24:27], a[8:11], v[104:107]
    ds_read_b128 v[40:43], v120 offset:6144
    s_waitcnt lgkmcnt(3)
    v_mfma_f32_16x16x32_bf16 v[104:107], v[28:31], a[12:15], v[104:107]
    ds_read_b128 v[44:47], v120 offset:7168
    s_waitcnt lgkmcnt(3)
    v_mfma_f32_16x16x32_bf16 v[104:107], v[32:35], a[16:19], v[104:107]
    s_waitcnt vmcnt(3)
    s_barrier
    ds_read_b128 v[16:19], v120 offset:8192
    s_waitcnt lgkmcnt(3)
    v_mfma_f32_16x16x32_bf16 v[104:107], v[36:39], a[20:23], v[104:107]
    ds_read_b128 v[20:23], v120 offset:9216
    buffer_load_dwordx4 v3, s[4:7], s41 offen sc1 lds
    s_add_u32 m0, m0, 4096
    s_mov_b32 s41, s43
    s_waitcnt lgkmcnt(3)
    v_mfma_f32_16x16x32_bf16 v[104:107], v[40:43], a[24:27], v[104:107]
    ds_read_b128 v[24:27], v120 offset:10240
    s_waitcnt lgkmcnt(3)
    v_mfma_f32_16x16x32_bf16 v[104:107], v[44:47], a[28:31], v[104:107]
    ds_read_b128 v[28:31], v120 offset:11264
    s_waitcnt lgkmcnt(3)
    v_mfma_f32_16x16x32_bf16 v[104:107], v[16:19], a[32:35], v[104:107]
    ds_read_b128 v[32:35], v120 offset:12288
    s_waitcnt lgkmcnt(3)
    v_mfma_f32_16x16x32_bf16 v[104:107], v[20:23], a[36:39], v[104:107]
    ds_read_b128 v[36:39], v120 offset:13312
    buffer_load_dwordx4 v3, s[4:7], s41 offen sc1 lds
    s_add_u32 m0, m0, 4096
    s_add_u32 s41, s41, 8192
    s_waitcnt lgkmcnt(3)
    v_mfma_f32_16x16x32_bf16 v[104:107], v[24:27], a[40:43], v[104:107]
    ds_read_b128 v[40:43], v120 offset:14336
    s_waitcnt lgkmcnt(3)
    v_mfma_f32_16x16x32_bf16 v[104:107], v[28:31], a[44:47], v[104:107]
    ds_read_b128 v[44:47], v120 offset:15360
    s_waitcnt lgkmcnt(3)
    v_mfma_f32_16x16x32_bf16 v[104:107], v[32:35], a[48:51], v[104:107]
    s_waitcnt vmcnt(3)
    s_barrier
    ds_read_b128 v[16:19], v120 offset:16384
    s_waitcnt lgkmcnt(3)
    v_mfma_f32_16x16x32_bf16 v[104:107], v[36:39], a[52:55], v[104:107]
    ds_read_b128 v[20:23], v120 offset:17408
    buffer_load_dwordx4 v3, s[4:7], s41 offen sc1 lds
    s_add_u32 m0, m0, 4096
    s_add_u32 s41, s41, 8192
    s_waitcnt lgkmcnt(3)
    v_mfma_f32_16x16x32_bf16 v[104:107], v[40:43], a[56:59], v[104:107]
    ds_read_b128 v[24:27], v120 offset:18432
    s_waitcnt lgkmcnt(3)
    v_mfma_f32_16x16x32_bf16 v[104:107], v[44:47], a[60:63], v[104:107]
    ds_read_b128 v[28:31], v120 offset:19456
    s_waitcnt lgkmcnt(3)
    v_mfma_f32_16x16x32_bf16 v[104:107], v[16:19], a[64:67], v[104:107]
    ds_read_b128 v[32:35], v120 offset:20480
    s_waitcnt lgkmcnt(3)
    v_mfma_f32_16x16x32_bf16 v[104:107], v[20:23], a[68:71], v[104:107]
    ds_read_b128 v[36:39], v120 offset:21504
    buffer_load_dwordx4 v3, s[4:7], s41 offen sc1 lds
    s_add_u32 m0, m0, 4096
    s_add_u32 s41, s41, 8192
    s_waitcnt lgkmcnt(3)
    v_mfma_f32_16x16x32_bf16 v[104:107], v[24:27], a[72:75], v[104:107]
    ds_read_b128 v[40:43], v120 offset:22528
    s_waitcnt lgkmcnt(3)
    v_mfma_f32_16x16x32_bf16 v[104:107], v[28:31], a[76:79], v[104:107]
    ds_read_b128 v[44:47], v120 offset:23552
    s_waitcnt lgkmcnt(3)
    v_mfma_f32_16x16x32_bf16 v[104:107], v[32:35], a[80:83], v[104:107]
    s_waitcnt vmcnt(3)
    s_barrier
    ds_read_b128 v[16:19], v120 offset:24576
    s_waitcnt lgkmcnt(3)
    v_mfma_f32_16x16x32_bf16 v[104:107], v[36:39], a[84:87], v[104:107]
    ds_read_b128 v[20:23], v120 offset:25600
    buffer_load_dwordx4 v3, s[4:7], s41 offen sc1 lds
    s_add_u32 m0, m0, 4096
    s_add_u32 s41, s41, 8192
    s_waitcnt lgkmcnt(3)
    v_mfma_f32_16x16x32_bf16 v[104:107], v[40:43], a[88:91], v[104:107]
    ds_read_b128 v[24:27], v120 offset:26624
    s_waitcnt lgkmcnt(3)
    v_mfma_f32_16x16x32_bf16 v[104:107], v[44:47], a[92:95], v[104:107]
    ds_read_b128 v[28:31], v120 offset:27648
    s_waitcnt lgkmcnt(3)
    v_mfma_f32_16x16x32_bf16 v[104:107], v[16:19], a[96:99], v[104:107]
    ds_read_b128 v[32:35], v120 offset:28672
    s_waitcnt lgkmcnt(3)
    v_mfma_f32_16x16x32_bf16 v[104:107], v[20:23], a[100:103], v[104:107]
    ds_read_b128 v[36:39], v120 offset:29696
    buffer_load_dwordx4 v3, s[4:7], s41 offen sc1 lds
    s_add_u32 m0, m0, 4096
    s_add_u32 s41, s41, 8192
    s_waitcnt lgkmcnt(3)
    v_mfma_f32_16x16x32_bf16 v[104:107], v[24:27], a[104:107], v[104:107]
    ds_read_b128 v[40:43], v120 offset:30720
    s_waitcnt lgkmcnt(3)
    v_mfma_f32_16x16x32_bf16 v[104:107], v[28:31], a[108:111], v[104:107]
    ds_read_b128 v[44:47], v120 offset:31744
    s_waitcnt lgkmcnt(3)
    v_mfma_f32_16x16x32_bf16 v[104:107], v[32:35], a[112:115], v[104:107]
    s_waitcnt vmcnt(3)
    s_barrier
    ds_read_b128 v[16:19], v120 offset:32768
    s_waitcnt lgkmcnt(3)
    v_mfma_f32_16x16x32_bf16 v[104:107], v[36:39], a[116:119], v[104:107]
    ds_read_b128 v[20:23], v120 offset:33792
    buffer_load_dwordx4 v3, s[4:7], s41 offen sc1 lds
    s_add_u32 m0, m0, 4096
    s_add_u32 s41, s41, 8192
    s_waitcnt lgkmcnt(3)
    v_mfma_f32_16x16x32_bf16 v[104:107], v[40:43], a[120:123], v[104:107]
    ds_read_b128 v[24:27], v120 offset:34816
    s_waitcnt lgkmcnt(3)
    v_mfma_f32_16x16x32_bf16 v[104:107], v[44:47], a[124:127], v[104:107]
    s_cmp_lg_u32 s19, 1024
    s_cbranch_scc1 L_p2_S_gah
    ds_read_b128 v[28:31], v120 offset:35840
    s_waitcnt lgkmcnt(3)
    v_mfma_f32_16x16x32_bf16 v[108:111], v[16:19], a[0:3], 0
    ds_read_b128 v[32:35], v120 offset:36864
    s_waitcnt lgkmcnt(3)
    v_mfma_f32_16x16x32_bf16 v[108:111], v[20:23], a[4:7], v[108:111]
    ds_read_b128 v[36:39], v120 offset:37888
    buffer_load_dwordx4 v3, s[4:7], s41 offen sc1 lds
    s_add_u32 m0, m0, 4096
    s_add_u32 s41, s41, 8192
    s_waitcnt lgkmcnt(3)
    v_mfma_f32_16x16x32_bf16 v[108:111], v[24:27], a[8:11], v[108:111]
    ds_read_b128 v[40:43], v120 offset:38912
    s_waitcnt lgkmcnt(3)
    v_mfma_f32_16x16x32_bf16 v[108:111], v[28:31], a[12:15], v[108:111]
    ds_read_b128 v[44:47], v120 offset:39936
    buffer_store_dword v104, v9, s[4:7], s44 offen sc1
    s_add_u32 s44, s44, 8192
    s_waitcnt lgkmcnt(3)
    v_mfma_f32_16x16x32_bf16 v[108:111], v[32:35], a[16:19], v[108:111]
    s_waitcnt vmcnt(4)
    s_barrier
    ds_read_b128 v[16:19], v120 offset:40960
    s_waitcnt lgkmcnt(3)
    v_mfma_f32_16x16x32_bf16 v[108:111], v[36:39], a[20:23], v[108:111]
    ds_read_b128 v[20:23], v120 offset:41984
    buffer_load_dwordx4 v3, s[4:7], s41 offen sc1 lds
    s_add_u32 m0, m0, 4096
    s_add_u32 s41, s41, 8192
    buffer_store_dword v105, v9, s[4:7], s44 offen sc1
    s_add_u32 s44, s44, 8192
    s_waitcnt lgkmcnt(3)
    v_mfma_f32_16x16x32_bf16 v[108:111], v[40:43], a[24:27], v[108:111]
    ds_read_b128 v[24:27], v120 offset:43008
    s_waitcnt lgkmcnt(3)
    v_mfma_f32_16x16x32_bf16 v[108:111], v[44:47], a[28:31], v[108:111]
    ds_read_b128 v[28:31], v120 offset:44032
    buffer_store_dword v106, v9, s[4:7], s44 offen sc1
    s_add_u32 s44, s44, 8192
    s_waitcnt lgkmcnt(3)
    v_mfma_f32_16x16x32_bf16 v[108:111], v[16:19], a[32:35], v[108:111]
    ds_read_b128 v[32:35], v120 offset:45056
    s_waitcnt lgkmcnt(3)
    v_mfma_f32_16x16x32_bf16 v[108:111], v[20:23], a[36:39], v[108:111]
    ds_read_b128 v[36:39], v120 offset:46080
    buffer_store_dword v107, v9, s[4:7], s44 offen sc1
    s_add_u32 s44, s44, 106496
    s_waitcnt lgkmcnt(3)
    v_mfma_f32_16x16x32_bf16 v[108:111], v[24:27], a[40:43], v[108:111]
    ds_read_b128 v[40:43], v120 offset:47104
    s_waitcnt lgkmcnt(3)
    v_mfma_f32_16x16x32_bf16 v[108:111], v[28:31], a[44:47], v[108:111]
    ds_read_b128 v[44:47], v120 offset:48128
    s_waitcnt lgkmcnt(3)
    v_mfma_f32_16x16x32_bf16 v[108:111], v[32:35], a[48:51], v[108:111]
    s_waitcnt vmcnt(6)
    s_barrier
    ds_read_b128 v[16:19], v120 offset:49152
    s_waitcnt lgkmcnt(3)
    v_mfma_f32_16x16x32_bf16 v[108:111], v[36:39], a[52:55], v[108:111]
    ds_read_b128 v[20:23], v120 offset:50176
    s_waitcnt lgkmcnt(3)
    v_mfma_f32_16x16x32_bf16 v[108:111], v[40:43], a[56:59], v[108:111]
    ds_read_b128 v[24:27], v120 offset:51200
    s_waitcnt lgkmcnt(3)
    v_mfma_f32_16x16x32_bf16 v[108:111], v[44:47], a[60:63], v[108:111]
    ds_read_b128 v[28:31], v120 offset:52224
    s_waitcnt lgkmcnt(3)
    v_mfma_f32_16x16x32_bf16 v[108:111], v[16:19], a[64:67], v[108:111]
    ds_read_b128 v[32:35], v120 offset:53248
    s_waitcnt lgkmcnt(3)
    v_mfma_f32_16x16x32_bf16 v[108:111], v[20:23], a[68:71], v[108:111]
    ds_read_b128 v[36:39], v120 offset:54272
    s_waitcnt lgkmcnt(3)
    v_mfma_f32_16x16x32_bf16 v[108:111], v[24:27], a[72:75], v[108:111]
    ds_read_b128 v[40:43], v120 offset:55296
    s_waitcnt lgkmcnt(3)
    v_mfma_f32_16x16x32_bf16 v[108:111], v[28:31], a[76:79], v[108:111]
    ds_read_b128 v[44:47], v120 offset:56320
    s_waitcnt lgkmcnt(3)
    v_mfma_f32_16x16x32_bf16 v[108:111], v[32:35], a[80:83], v[108:111]
    s_waitcnt vmcnt(3)
    s_barrier
    ds_read_b128 v[16:19], v120 offset:57344
    s_waitcnt lgkmcnt(3)
    v_mfma_f32_16x16x32_bf16 v[108:111], v[36:39], a[84:87], v[108:111]
    ds_read_b128 v[20:23], v120 offset:58368
    s_waitcnt lgkmcnt(3)
    v_mfma_f32_16x16x32_bf16 v[108:111], v[40:43], a[88:91], v[108:111]
    ds_read_b128 v[24:27], v120 offset:59392
    s_waitcnt lgkmcnt(3)
    v_mfma_f32_16x16x32_bf16 v[108:111], v[44:47], a[92:95], v[108:111]
    ds_read_b128 v[28:31], v120 offset:60416
    s_waitcnt lgkmcnt(3)
    v_mfma_f32_16x16x32_bf16 v[108:111], v[16:19], a[96:99], v[108:111]
    ds_read_b128 v[32:35], v120 offset:61440
    s_waitcnt lgkmcnt(3)
    v_mfma_f32_16x16x32_bf16 v[108:111], v[20:23], a[100:103], v[108:111]
    ds_read_b128 v[36:39], v120 offset:62464
    s_waitcnt lgkmcnt(3)
    v_mfma_f32_16x16x32_bf16 v[108:111], v[24:27], a[104:107], v[108:111]
    ds_read_b128 v[40:43], v120 offset:63488
    s_waitcnt lgkmcnt(3)
    v_mfma_f32_16x16x32_bf16 v[108:111], v[28:31], a[108:111], v[108:111]
    ds_read_b128 v[44:47], v120 offset:64512
    s_waitcnt lgkmcnt(3)
    v_mfma_f32_16x16x32_bf16 v[108:111], v[32:35], a[112:115], v[108:111]
    s_waitcnt lgkmcnt(2)
    v_mfma_f32_16x16x32_bf16 v[108:111], v[36:39], a[116:119], v[108:111]
    s_waitcnt lgkmcnt(1)
    v_mfma_f32_16x16x32_bf16 v[108:111], v[40:43], a[120:123], v[108:111]
    s_waitcnt lgkmcnt(0)
    v_mfma_f32_16x16x32_bf16 v[108:111], v[44:47], a[124:127], v[108:111]
    s_nop 7
    buffer_store_dword v108, v9, s[4:7], s44 offen sc1
    s_add_u32 s44, s44, 8192
    buffer_store_dword v109, v9, s[4:7], s44 offen sc1
    s_add_u32 s44, s44, 8192
    buffer_store_dword v110, v9, s[4:7], s44 offen sc1
    s_add_u32 s44, s44, 8192
    buffer_store_dword v111, v9, s[4:7], s44 offen sc1
    s_add_u32 s44, s44, 106496
L_p2_S_gax:
    s_cmp_lt_u32 s23, 46
    s_cselect_b32 s25, 5, 7
    s_cmp_ge_u32 s23, 57
    s_cselect_b32 s25, 6, s25
    s_add_u32 s25, s23, s25
    s_cmp_eq_u32 s15, 0
    s_cbranch_scc1 L_p2_S_n0
    s_barrier
    s_cmp_ge_u32 s25, 64
    s_cbranch_scc1 L_p2_S_n1
    s_and_b32 s40, s25, 1
    s_lshl_b32 s40, s40, 2
    s_add_u32 s40, s40, s37
    s_lshr_b32 s41, s25, 1
    s_add_u32 s41, s41, 2
L_po14:
    buffer_load_dword v14, v13, s[4:7], s40 offen offset:0 sc1
    s_add_u32 s17, s17, 1
    s_cmp_gt_u32 s17, 0x400000
    s_cbranch_scc1 L_pe14
    s_waitcnt vmcnt(0)
    v_cmp_gt_u32 vcc, s41, v14
    s_cbranch_vccz L_pe14
    s_sleep 2
    s_branch L_po14
L_pe14:
    s_waitcnt vmcnt(0)
    s_lshl_b32 s40, s22, 6
    s_add_u32 s40, s40, s25
    s_lshl_b32 s41, s40, 13
    s_add_u32 s41, s41, 33554432
    s_lshl_b32 s40, s40, 14
    s_lshl_b32 s42, s32, 13
    s_add_u32 s40, s40, s42
    s_add_u32 s40, s40, 0
    s_cmp_eq_u32 s15, 1
    s_cselect_b32 s40, s41, s40
    s_add_u32 s41, s40, 4096
    s_lshl_b32 s42, s15, 13
    s_add_u32 m0, s42, 73728
    s_nop 0
    buffer_load_dwordx4 v3, s[4:7], s40 offen offset:0 sc1 lds
    buffer_load_dwordx4 v3, s[4:7], s40 offen offset:1024 sc1 lds
    buffer_load_dwordx4 v3, s[4:7], s40 offen offset:2048 sc1 lds
    buffer_load_dwordx4 v3, s[4:7], s40 offen offset:3072 sc1 lds
    s_add_u32 m0, m0, 4096
    s_nop 0
    buffer_load_dwordx4 v3, s[4:7], s41 offen offset:0 sc1 lds
    buffer_load_dwordx4 v3, s[4:7], s41 offen offset:1024 sc1 lds
    buffer_load_dwordx4 v3, s[4:7], s41 offen offset:2048 sc1 lds
    buffer_load_dwordx4 v3, s[4:7], s41 offen offset:3072 sc1 lds
    s_branch L_p2_S_n1
L_p2_S_n0:
    s_cmp_eq_u32 s20, 0
    s_cbranch_scc1 L_p2_S_n5
    s_barrier
    s_branch L_p2_S_n1
L_p2_S_n5:
    v_and_b32 v141, s16, v136
    v_lshlrev_b32 v140, 16, v136
    v_and_b32 v143, s16, v137
    v_lshlrev_b32 v142, 16, v137
    v_and_b32 v145, s16, v138
    v_lshlrev_b32 v144, 16, v138
    v_and_b32 v147, s16, v139
    v_lshlrev_b32 v146, 16, v139
    s_lshl_b32 s41, s22, 13
    s_add_u32 s41, s41, s26
    s_add_u32 s41, s41, 262144
    s_add_u32 s42, s41, 4096
    s_sleep 4
L_p2_S_ra:
    buffer_load_dwordx4 v[16:19], v3, s[4:7], s41 offen offset:0 sc1
    buffer_load_dwordx4 v[20:23], v3, s[4:7], s41 offen offset:1024 sc1
    buffer_load_dwordx4 v[24:27], v3, s[4:7], s41 offen offset:2048 sc1
    buffer_load_dwordx4 v[28:31], v3, s[4:7], s41 offen offset:3072 sc1
    buffer_load_dwordx4 v[32:35], v3, s[4:7], s42 offen offset:0 sc1
    buffer_load_dwordx4 v[36:39], v3, s[4:7], s42 offen offset:1024 sc1
    buffer_load_dwordx4 v[40:43], v3, s[4:7], s42 offen offset:2048 sc1
    buffer_load_dwordx4 v[44:47], v3, s[4:7], s42 offen offset:3072 sc1
    s_add_u32 s17, s17, 4
    s_cmp_gt_u32 s17, 0x400000
    s_waitcnt vmcnt(5)
    v_pk_add_f32 v[16:17], v[16:17], v[24:25]
    v_pk_add_f32 v[18:19], v[18:19], v[26:27]
    s_waitcnt vmcnt(4)
    v_pk_add_f32 v[20:21], v[20:21], v[28:29]
    v_pk_add_f32 v[22:23], v[22:23], v[30:31]
    s_waitcnt vmcnt(3)
    v_pk_add_f32 v[16:17], v[16:17], v[32:33]
    v_pk_add_f32 v[18:19], v[18:19], v[34:35]
    s_waitcnt vmcnt(2)
    v_pk_add_f32 v[20:21], v[20:21], v[36:37]
    v_pk_add_f32 v[22:23], v[22:23], v[38:39]
    s_waitcnt vmcnt(1)
    v_pk_add_f32 v[16:17], v[16:17], v[40:41]
    v_pk_add_f32 v[18:19], v[18:19], v[42:43]
    s_waitcnt vmcnt(0)
    v_pk_add_f32 v[20:21], v[20:21], v[44:45]
    v_pk_add_f32 v[22:23], v[22:23], v[46:47]
    v_pk_add_f32 v[24:25], v[16:17], v[18:19]
    v_pk_add_f32 v[26:27], v[20:21], v[22:23]
    v_pk_add_f32 v[24:25], v[24:25], v[26:27]
    v_cmp_u_f32 vcc, v24, v25
    s_cbranch_scc1 L_p2_S_rax
    s_cbranch_vccnz L_p2_S_ra
L_p2_S_rax:
    v_cvt_pk_bf16_f32 v120, v16, v17
    v_lshlrev_b32 v16, 16, v120
    v_and_b32 v17, s16, v120
    v_cvt_pk_bf16_f32 v120, v18, v19
    v_lshlrev_b32 v18, 16, v120
    v_and_b32 v19, s16, v120
    v_cvt_pk_bf16_f32 v120, v20, v21
    v_lshlrev_b32 v20, 16, v120
    v_and_b32 v21, s16, v120
    v_cvt_pk_bf16_f32 v120, v22, v23
    v_lshlrev_b32 v22, 16, v120
    v_and_b32 v23, s16, v120
    s_barrier
    v_pk_mul_f32 v[16:17], v[16:17], v[168:169]
    v_pk_mul_f32 v[18:19], v[18:19], v[170:171]
    v_pk_mul_f32 v[20:21], v[20:21], v[172:173]
    v_pk_mul_f32 v[22:23], v[22:23], v[174:175]
    v_cvt_pk_bf16_f32 v120, v16, v17
    v_lshlrev_b32 v16, 16, v120
    v_and_b32 v17, s16, v120
    v_cvt_pk_bf16_f32 v120, v18, v19
    v_lshlrev_b32 v18, 16, v120
    v_and_b32 v19, s16, v120
    v_cvt_pk_bf16_f32 v120, v20, v21
    v_lshlrev_b32 v20, 16, v120
    v_and_b32 v21, s16, v120
    v_cvt_pk_bf16_f32 v120, v22, v23
    v_lshlrev_b32 v22, 16, v120
    v_and_b32 v23, s16, v120
    v_pk_add_f32 v[140:141], v[140:141], v[16:17]
    v_pk_add_f32 v[142:143], v[142:143], v[18:19]
    v_pk_add_f32 v[144:145], v[144:145], v[20:21]
    v_pk_add_f32 v[146:147], v[146:147], v[22:23]
    v_cvt_pk_bf16_f32 v120, v140, v141
    v_lshlrev_b32 v140, 16, v120
    v_and_b32 v141, s16, v120
    v_cvt_pk_bf16_f32 v120, v142, v143
    v_lshlrev_b32 v142, 16, v120
    v_and_b32 v143, s16, v120
    v_cvt_pk_bf16_f32 v120, v144, v145
    v_lshlrev_b32 v144, 16, v120
    v_and_b32 v145, s16, v120
    v_cvt_pk_bf16_f32 v120, v146, v147
    v_lshlrev_b32 v146, 16, v120
    v_and_b32 v147, s16, v120
    v_pk_add_f32 v[16:17], v[140:141], v[142:143]
    v_pk_add_f32 v[18:19], v[144:145], v[146:147]
    v_pk_add_f32 v[16:17], v[16:17], v[18:19]
    v_add_f32 v121, v16, v17
    s_nop 1
    v_add_f32_dpp v121, v121, v121 row_ror:1 row_mask:0xf bank_mask:0xf
    s_nop 1
    v_add_f32_dpp v121, v121, v121 row_ror:2 row_mask:0xf bank_mask:0xf
    s_nop 1
    v_add_f32_dpp v121, v121, v121 row_ror:4 row_mask:0xf bank_mask:0xf
    s_nop 1
    v_add_f32_dpp v121, v121, v121 row_ror:8 row_mask:0xf bank_mask:0xf
    v_mov_b32 v120, v121
    s_nop 1
    v_permlane32_swap_b32 v121, v120
    v_add_f32 v121, v121, v120
    v_mov_b32 v120, v121
    s_nop 1
    v_permlane16_swap_b32 v121, v120
    v_add_f32 v121, v121, v120
    v_mul_f32 v121, 0x3b000000, v121
    v_pk_add_f32 v[16:17], v[140:141], v[120:121] op_sel:[0,1] neg_lo:[0,1] neg_hi:[0,1]
    v_pk_add_f32 v[18:19], v[142:143], v[120:121] op_sel:[0,1] neg_lo:[0,1] neg_hi:[0,1]
    v_pk_add_f32 v[20:21], v[144:145], v[120:121] op_sel:[0,1] neg_lo:[0,1] neg_hi:[0,1]
    v_pk_add_f32 v[22:23], v[146:147], v[120:121] op_sel:[0,1] neg_lo:[0,1] neg_hi:[0,1]
    v_pk_mul_f32 v[16:17], v[16:17], v[16:17]
    v_pk_fma_f32 v[16:17], v[18:19], v[18:19], v[16:17]
    v_pk_fma_f32 v[16:17], v[20:21], v[20:21], v[16:17]
    v_pk_fma_f32 v[16:17], v[22:23], v[22:23], v[16:17]
    v_add_f32 v122, v16, v17
    s_nop 1
    v_add_f32_dpp v122, v122, v122 row_ror:1 row_mask:0xf bank_mask:0xf
    s_nop 1
    v_add_f32_dpp v122, v122, v122 row_ror:2 row_mask:0xf bank_mask:0xf
    s_nop 1
    v_add_f32_dpp v122, v122, v122 row_ror:4 row_mask:0xf bank_mask:0xf
    s_nop 1
    v_add_f32_dpp v122, v122, v122 row_ror:8 row_mask:0xf bank_mask:0xf
    v_mov_b32 v120, v122
    s_nop 1
    v_permlane32_swap_b32 v122, v120
    v_add_f32 v122, v122, v120
    v_mov_b32 v120, v122
    s_nop 1
    v_permlane16_swap_b32 v122, v120
    v_add_f32 v122, v122, v120
    v_mul_f32 v122, 0x3b000000, v122
    v_cvt_pk_bf16_f32 v120, v121, v122
    v_lshlrev_b32 v121, 16, v120
    v_and_b32 v122, s16, v120
    v_add_f32 v122, 0x3727c5ac, v122
    v_cvt_pk_bf16_f32 v120, v122, v122
    v_lshlrev_b32 v122, 16, v120
    v_sqrt_f32 v122, v122
    s_nop 0
    v_cvt_pk_bf16_f32 v120, v122, v122
    v_lshlrev_b32 v122, 16, v120
    v_rcp_f32 v122, v122
    v_pk_add_f32 v[16:17], v[140:141], v[120:121] op_sel:[0,1] neg_lo:[0,1] neg_hi:[0,1]
    v_pk_add_f32 v[18:19], v[142:143], v[120:121] op_sel:[0,1] neg_lo:[0,1] neg_hi:[0,1]
    v_pk_add_f32 v[20:21], v[144:145], v[120:121] op_sel:[0,1] neg_lo:[0,1] neg_hi:[0,1]
    v_pk_add_f32 v[22:23], v[146:147], v[120:121] op_sel:[0,1] neg_lo:[0,1] neg_hi:[0,1]
    v_cvt_pk_bf16_f32 v120, v16, v17
    v_lshlrev_b32 v16, 16, v120
    v_and_b32 v17, s16, v120
    v_cvt_pk_bf16_f32 v120, v18, v19
    v_lshlrev_b32 v18, 16, v120
    v_and_b32 v19, s16, v120
    v_cvt_pk_bf16_f32 v120, v20, v21
    v_lshlrev_b32 v20, 16, v120
    v_and_b32 v21, s16, v120
    v_cvt_pk_bf16_f32 v120, v22, v23
    v_lshlrev_b32 v22, 16, v120
    v_and_b32 v23, s16, v120
    v_pk_mul_f32 v[16:17], v[16:17], v[122:123] op_sel_hi:[1,0]
    v_pk_mul_f32 v[18:19], v[18:19], v[122:123] op_sel_hi:[1,0]
    v_pk_mul_f32 v[20:21], v[20:21], v[122:123] op_sel_hi:[1,0]
    v_pk_mul_f32 v[22:23], v[22:23], v[122:123] op_sel_hi:[1,0]
    v_cvt_pk_bf16_f32 v120, v16, v17
    v_lshlrev_b32 v16, 16, v120
    v_and_b32 v17, s16, v120
    v_cvt_pk_bf16_f32 v120, v18, v19
    v_lshlrev_b32 v18, 16, v120
    v_and_b32 v19, s16, v120
    v_cvt_pk_bf16_f32 v120, v20, v21
    v_lshlrev_b32 v20, 16, v120
    v_and_b32 v21, s16, v120
    v_cvt_pk_bf16_f32 v120, v22, v23
    v_lshlrev_b32 v22, 16, v120
    v_and_b32 v23, s16, v120
    v_pk_mul_f32 v[16:17], v[16:17], v[184:185]
    v_pk_mul_f32 v[18:19], v[18:19], v[186:187]
    v_pk_mul_f32 v[20:21], v[20:21], v[188:189]
    v_pk_mul_f32 v[22:23], v[22:23], v[190:191]
    v_cvt_pk_bf16_f32 v120, v16, v17
    v_lshlrev_b32 v16, 16, v120
    v_and_b32 v17, s16, v120
    v_cvt_pk_bf16_f32 v120, v18, v19
    v_lshlrev_b32 v18, 16, v120
    v_and_b32 v19, s16, v120
    v_cvt_pk_bf16_f32 v120, v20, v21
    v_lshlrev_b32 v20, 16, v120
    v_and_b32 v21, s16, v120
    v_cvt_pk_bf16_f32 v120, v22, v23
    v_lshlrev_b32 v22, 16, v120
    v_and_b32 v23, s16, v120
    v_pk_add_f32 v[16:17], v[16:17], v[176:177]
    v_pk_add_f32 v[18:19], v[18:19], v[178:179]
    v_pk_add_f32 v[20:21], v[20:21], v[180:181]
    v_pk_add_f32 v[22:23], v[22:23], v[182:183]
    v_cvt_pk_bf16_f32 v24, v16, v17
    v_cvt_pk_bf16_f32 v25, v18, v19
    v_cvt_pk_bf16_f32 v26, v20, v21
    v_cvt_pk_bf16_f32 v27, v22, v23
    s_lshl_b32 s41, s22, 10
    s_add_u32 s41, s41, s26
    s_add_u32 s41, s41, 786432
    buffer_store_dwordx2 v[24:25], v149, s[4:7], s41 offen offset:0 sc1
    buffer_store_dwordx2 v[26:27], v149, s[4:7], s41 offen offset:512 sc1
L_p2_S_n1:
    s_waitcnt vmcnt(0)
    s_barrier
    s_add_u32 s27, s27, 1
    s_cmp_lg_u32 s15, 0
    s_cbranch_scc1 L_p2_S_g3
    v_mov_b32 v14, s27
    s_mov_b64 exec, 1
    buffer_store_dword v14, off, s[4:7], s28 sc1
    s_mov_b64 exec, -1
    s_nop 15
    buffer_load_dword v150, v6, s[4:7], s29 offen sc1
    s_nop 11
    buffer_load_dword v150, v6, s[4:7], s29 offen sc1
    s_nop 11
    buffer_load_dword v150, v6, s[4:7], s29 offen sc1
    s_nop 11
L_po15:
    buffer_load_dword v150, v6, s[4:7], s29 offen sc1
    s_add_u32 s17, s17, 1
    s_cmp_gt_u32 s17, 0x400000
    s_cbranch_scc1 L_pe15
    s_waitcnt vmcnt(3)
    v_cmp_gt_u32 vcc, s27, v150
    s_cbranch_vccnz L_po15
L_pe15:
L_p2_S_g3:
    s_barrier
    s_cmp_ge_u32 s22, 28
    s_cbranch_scc1 L_p2_S_n2
    s_lshl_b32 s41, s15, 13
    s_add_u32 s41, s41, s26
    s_add_u32 s41, s41, 786432
    s_lshl_b32 s42, s33, 10
    s_cmp_eq_u32 s42, s18
    s_cselect_b32 s42, 0, s19
    s_and_b32 s42, s42, 0x40000000
    s_add_u32 s41, s41, s42
    s_lshl_b32 s42, s33, 14
    s_lshl_b32 s43, s32, 10
    s_add_u32 s42, s42, s43
    s_add_u32 m0, s42, 4096
    s_add_u32 s43, s41, 0
    buffer_load_dwordx4 v8, s[4:7], s43 offen sc1 lds
    s_add_u32 m0, s42, 6144
    s_add_u32 s43, s41, 128
    buffer_load_dwordx4 v8, s[4:7], s43 offen sc1 lds
    s_barrier
    s_add_u32 m0, s42, 8192
    s_add_u32 s43, s41, 256
    buffer_load_dwordx4 v8, s[4:7], s43 offen sc1 lds
    s_add_u32 m0, s42, 10240
    s_add_u32 s43, s41, 384
    buffer_load_dwordx4 v8, s[4:7], s43 offen sc1 lds
    s_barrier
    s_add_u32 m0, s42, 12288
    s_add_u32 s43, s41, 512
    buffer_load_dwordx4 v8, s[4:7], s43 offen sc1 lds
    s_add_u32 m0, s42, 14336
    s_add_u32 s43, s41, 640
    buffer_load_dwordx4 v8, s[4:7], s43 offen sc1 lds
    s_barrier
    s_add_u32 m0, s42, 16384
    s_add_u32 s43, s41, 768
    buffer_load_dwordx4 v8, s[4:7], s43 offen sc1 lds
    s_add_u32 m0, s42, 18432
    s_add_u32 s43, s41, 896
    buffer_load_dwordx4 v8, s[4:7], s43 offen sc1 lds
    s_waitcnt vmcnt(6)
    s_barrier
    ds_read_b128 v[16:19], v7 offset:4096
    ds_read_b128 v[20:23], v151 offset:4096
    ds_read_b128 v[24:27], v7 offset:6144
    s_waitcnt lgkmcnt(2)
    v_mfma_f32_16x16x32_bf16 v[104:107], a[128:131], v[16:19], 0
    ds_read_b128 v[28:31], v151 offset:6144
    v_mfma_f32_16x16x32_bf16 v[108:111], a[192:195], v[16:19], 0
    s_waitcnt lgkmcnt(2)
    v_mfma_f32_16x16x32_bf16 v[104:107], a[132:135], v[20:23], v[104:107]
    s_waitcnt vmcnt(4)
    s_barrier
    ds_read_b128 v[32:35], v7 offset:8192
    v_mfma_f32_16x16x32_bf16 v[108:111], a[196:199], v[20:23], v[108:111]
    s_waitcnt lgkmcnt(2)
    v_mfma_f32_16x16x32_bf16 v[104:107], a[136:139], v[24:27], v[104:107]
    ds_read_b128 v[36:39], v151 offset:8192
    v_mfma_f32_16x16x32_bf16 v[108:111], a[200:203], v[24:27], v[108:111]
    s_waitcnt lgkmcnt(2)
    v_mfma_f32_16x16x32_bf16 v[104:107], a[140:143], v[28:31], v[104:107]
    ds_read_b128 v[40:43], v7 offset:10240
    v_mfma_f32_16x16x32_bf16 v[108:111], a[204:207], v[28:31], v[108:111]
    s_waitcnt lgkmcnt(2)
    v_mfma_f32_16x16x32_bf16 v[104:107], a[144:147], v[32:35], v[104:107]
    ds_read_b128 v[44:47], v151 offset:10240
    v_mfma_f32_16x16x32_bf16 v[108:111], a[208:211], v[32:35], v[108:111]
    s_waitcnt lgkmcnt(2)
    v_mfma_f32_16x16x32_bf16 v[104:107], a[148:151], v[36:39], v[104:107]
    s_waitcnt vmcnt(2)
    s_barrier
    ds_read_b128 v[16:19], v7 offset:12288
    v_mfma_f32_16x16x32_bf16 v[108:111], a[212:215], v[36:39], v[108:111]
    s_waitcnt lgkmcnt(2)
    v_mfma_f32_16x16x32_bf16 v[104:107], a[152:155], v[40:43], v[104:107]
    ds_read_b128 v[20:23], v151 offset:12288
    v_mfma_f32_16x16x32_bf16 v[108:111], a[216:219], v[40:43], v[108:111]
    s_waitcnt lgkmcnt(2)
    v_mfma_f32_16x16x32_bf16 v[104:107], a[156:159], v[44:47], v[104:107]
    ds_read_b128 v[24:27], v7 offset:14336
    v_mfma_f32_16x16x32_bf16 v[108:111], a[220:223], v[44:47], v[108:111]
    s_waitcnt lgkmcnt(2)
    v_mfma_f32_16x16x32_bf16 v[104:107], a[160:163], v[16:19], v[104:107]
    ds_read_b128 v[28:31], v151 offset:14336
    v_mfma_f32_16x16x32_bf16 v[108:111], a[224:227], v[16:19], v[108:111]
    s_waitcnt lgkmcnt(2)
    v_mfma_f32_16x16x32_bf16 v[104:107], a[164:167], v[20:23], v[104:107]
    s_waitcnt vmcnt(0)
    s_barrier
    ds_read_b128 v[32:35], v7 offset:16384
    v_mfma_f32_16x16x32_bf16 v[108:111], a[228:231], v[20:23], v[108:111]
    s_waitcnt lgkmcnt(2)
    v_mfma_f32_16x16x32_bf16 v[104:107], a[168:171], v[24:27], v[104:107]
    ds_read_b128 v[36:39], v151 offset:16384
    v_mfma_f32_16x16x32_bf16 v[108:111], a[232:235], v[24:27], v[108:111]
    s_waitcnt lgkmcnt(2)
    v_mfma_f32_16x16x32_bf16 v[104:107], a[172:175], v[28:31], v[104:107]
    ds_read_b128 v[40:43], v7 offset:18432
    v_mfma_f32_16x16x32_bf16 v[108:111], a[236:239], v[28:31], v[108:111]
    s_waitcnt lgkmcnt(2)
    v_mfma_f32_16x16x32_bf16 v[104:107], a[176:179], v[32:35], v[104:107]
    ds_read_b128 v[44:47], v151 offset:18432
    v_mfma_f32_16x16x32_bf16 v[108:111], a[240:243], v[32:35], v[108:111]
    s_waitcnt lgkmcnt(2)
    v_mfma_f32_16x16x32_bf16 v[104:107], a[180:183], v[36:39], v[104:107]
    v_mfma_f32_16x16x32_bf16 v[108:111], a[244:247], v[36:39], v[108:111]
    s_waitcnt lgkmcnt(1)
    v_mfma_f32_16x16x32_bf16 v[104:107], a[184:187], v[40:43], v[104:107]
    v_mfma_f32_16x16x32_bf16 v[108:111], a[248:251], v[40:43], v[108:111]
    s_waitcnt lgkmcnt(0)
    v_mfma_f32_16x16x32_bf16 v[104:107], a[188:191], v[44:47], v[104:107]
    v_mfma_f32_16x16x32_bf16 v[108:111], a[252:255], v[44:47], v[108:111]
    s_lshl_b32 s41, s22, 12
    s_lshl_b32 s42, s33, 11
    s_add_u32 s41, s41, s42
    s_lshl_b32 s42, s32, 10
    s_add_u32 s41, s41, s42
    s_add_u32 s41, s41, s26
    s_add_u32 s41, s41, 819200
    v_max_f32 v104, 0, v104
    v_max_f32 v105, 0, v105
    v_max_f32 v106, 0, v106
    v_max_f32 v107, 0, v107
    v_max_f32 v108, 0, v108
    v_max_f32 v109, 0, v109
    v_max_f32 v110, 0, v110
    v_max_f32 v111, 0, v111
    v_cvt_pk_bf16_f32 v124, v104, v105
    v_cvt_pk_bf16_f32 v125, v106, v107
    v_cvt_pk_bf16_f32 v126, v108, v109
    v_cvt_pk_bf16_f32 v127, v110, v111
    buffer_store_dwordx4 v[124:127], v3, s[4:7], s41 offen sc1
L_p2_S_n2:
    s_waitcnt vmcnt(0)
    s_barrier
    s_add_u32 s27, s27, 1
    s_cmp_lg_u32 s15, 0
    s_cbranch_scc1 L_p2_S_g4
    v_mov_b32 v14, s27
    s_mov_b64 exec, 1
    buffer_store_dword v14, off, s[4:7], s28 sc1
    s_mov_b64 exec, -1
    s_nop 15
    buffer_load_dword v150, v6, s[4:7], s29 offen sc1
    s_nop 11
    buffer_load_dword v150, v6, s[4:7], s29 offen sc1
    s_nop 11
    buffer_load_dword v150, v6, s[4:7], s29 offen sc1
    s_nop 11
L_po16:
    buffer_load_dword v150, v6, s[4:7], s29 offen sc1
    s_add_u32 s17, s17, 1
    s_cmp_gt_u32 s17, 0x400000
    s_cbranch_scc1 L_pe16
    s_waitcnt vmcnt(3)
    v_cmp_gt_u32 vcc, s27, v150
    s_cbranch_vccnz L_po16
L_pe16:
L_p2_S_g4:
    s_barrier
    s_mul_i32 s41, s30, 28672
    s_add_u32 s41, s41, s26
    s_add_u32 s41, s41, 819200
    s_lshl_b32 s42, s15, 11
    s_add_u32 s41, s41, s42
    s_add_u32 s43, s41, s19
    s_add_u32 s41, s41, s18
    s_lshl_b32 s42, s15, 10
    s_add_u32 m0, s42, 4096
    v_add_u32 v120, 4096, v3
    buffer_load_dwordx4 v3, s[4:7], s41 offen sc1 lds
    s_add_u32 m0, m0, 4096
    s_add_u32 s41, s41, 8192
    buffer_load_dwordx4 v3, s[4:7], s41 offen sc1 lds
    s_add_u32 m0, m0, 4096
    s_add_u32 s41, s41, 8192
    s_barrier
    buffer_load_dwordx4 v3, s[4:7], s41 offen sc1 lds
    s_add_u32 m0, m0, 4096
    s_add_u32 s41, s41, 8192
    buffer_load_dwordx4 v3, s[4:7], s41 offen sc1 lds
    s_add_u32 m0, m0, 4096
    s_mov_b32 s41, s43
    s_barrier
    buffer_load_dwordx4 v3, s[4:7], s41 offen sc1 lds
    s_add_u32 m0, m0, 4096
    s_add_u32 s41, s41, 8192
    buffer_load_dwordx4 v3, s[4:7], s41 offen sc1 lds
    s_add_u32 m0, m0, 4096
    s_add_u32 s41, s41, 8192
    s_barrier
    s_lshl_b32 s44, s18, 7
    s_add_u32 s44, s44, s26
    s_add_u32 s44, s44, 524288
    s_waitcnt vmcnt(4)
    s_barrier
    ds_read_b128 v[16:19], v120 offset:0
    ds_read_b128 v[20:23], v120 offset:1024
    ds_read_b128 v[24:27], v120 offset:2048
    ds_read_b128 v[28:31], v120 offset:3072
    s_waitcnt lgkmcnt(3)
    v_mfma_f32_16x16x32_bf16 v[104:107], v[16:19], v[200:203], 0
    ds_read_b128 v[32:35], v120 offset:4096
    s_waitcnt lgkmcnt(3)
    v_mfma_f32_16x16x32_bf16 v[104:107], v[20:23], v[204:207], v[104:107]
    ds_read_b128 v[36:39], v120 offset:5120
    buffer_load_dwordx4 v3, s[4:7], s41 offen sc1 lds
    s_add_u32 m0, m0, 4096
    s_add_u32 s41, s41, 8192
    s_waitcnt lgkmcnt(3)
    v_mfma_f32_16x16x32_bf16 v[104:107], v[24:27], v[208:211], v[104:107]
    ds_read_b128 v[40:43], v120 offset:6144
    s_waitcnt lgkmcnt(3)
    v_mfma_f32_16x16x32_bf16 v[104:107], v[28:31], v[212:215], v[104:107]
    ds_read_b128 v[44:47], v120 offset:7168
    s_waitcnt lgkmcnt(3)
    v_mfma_f32_16x16x32_bf16 v[104:107], v[32:35], v[216:219], v[104:107]
    s_waitcnt vmcnt(3)
    s_barrier
    ds_read_b128 v[16:19], v120 offset:8192
    s_waitcnt lgkmcnt(3)
    v_mfma_f32_16x16x32_bf16 v[104:107], v[36:39], v[220:223], v[104:107]
    ds_read_b128 v[20:23], v120 offset:9216
    buffer_load_dwordx4 v3, s[4:7], s41 offen sc1 lds
    s_add_u32 m0, m0, 4096
    s_add_u32 s41, s41, 8192
    s_waitcnt lgkmcnt(3)
    v_mfma_f32_16x16x32_bf16 v[104:107], v[40:43], v[224:227], v[104:107]
    ds_read_b128 v[24:27], v120 offset:10240
    s_waitcnt lgkmcnt(3)
    v_mfma_f32_16x16x32_bf16 v[104:107], v[44:47], v[228:231], v[104:107]
    ds_read_b128 v[28:31], v120 offset:11264
    s_waitcnt lgkmcnt(3)
    v_mfma_f32_16x16x32_bf16 v[104:107], v[16:19], v[232:235], v[104:107]
    ds_read_b128 v[32:35], v120 offset:12288
    s_waitcnt lgkmcnt(3)
    v_mfma_f32_16x16x32_bf16 v[104:107], v[20:23], v[236:239], v[104:107]
    ds_read_b128 v[36:39], v120 offset:13312
    s_waitcnt lgkmcnt(3)
    v_mfma_f32_16x16x32_bf16 v[104:107], v[24:27], v[240:243], v[104:107]
    s_waitcnt vmcnt(2)
    s_barrier
    ds_read_b128 v[40:43], v120 offset:16384
    s_waitcnt lgkmcnt(3)
    v_mfma_f32_16x16x32_bf16 v[104:107], v[28:31], v[244:247], v[104:107]
    ds_read_b128 v[44:47], v120 offset:17408
    s_waitcnt lgkmcnt(3)
    v_mfma_f32_16x16x32_bf16 v[104:107], v[32:35], v[248:251], v[104:107]
    ds_read_b128 v[16:19], v120 offset:18432
    s_waitcnt lgkmcnt(3)
    v_mfma_f32_16x16x32_bf16 v[104:107], v[36:39], v[252:255], v[104:107]
    s_cmp_lg_u32 s19, 1024
    s_cbranch_scc1 L_p2_S_gbh
    ds_read_b128 v[20:23], v120 offset:19456
    s_waitcnt lgkmcnt(3)
    v_mfma_f32_16x16x32_bf16 v[108:111], v[40:43], v[200:203], 0
    ds_read_b128 v[24:27], v120 offset:20480
    s_waitcnt lgkmcnt(3)
    v_mfma_f32_16x16x32_bf16 v[108:111], v[44:47], v[204:207], v[108:111]
    ds_read_b128 v[28:31], v120 offset:21504
    s_waitcnt lgkmcnt(3)
    v_mfma_f32_16x16x32_bf16 v[108:111], v[16:19], v[208:211], v[108:111]
    ds_read_b128 v[32:35], v120 offset:22528
    s_waitcnt lgkmcnt(3)
    v_mfma_f32_16x16x32_bf16 v[108:111], v[20:23], v[212:215], v[108:111]
    ds_read_b128 v[36:39], v120 offset:23552
    buffer_store_dword v104, v9, s[4:7], s44 offen sc1
    s_add_u32 s44, s44, 8192
    s_waitcnt lgkmcnt(3)
    v_mfma_f32_16x16x32_bf16 v[108:111], v[24:27], v[216:219], v[108:111]
    s_waitcnt vmcnt(1)
    s_barrier
    ds_read_b128 v[40:43], v120 offset:24576
    s_waitcnt lgkmcnt(3)
    v_mfma_f32_16x16x32_bf16 v[108:111], v[28:31], v[220:223], v[108:111]
    ds_read_b128 v[44:47], v120 offset:25600
    buffer_store_dword v105, v9, s[4:7], s44 offen sc1
    s_add_u32 s44, s44, 8192
    s_waitcnt lgkmcnt(3)
    v_mfma_f32_16x16x32_bf16 v[108:111], v[32:35], v[224:227], v[108:111]
    ds_read_b128 v[16:19], v120 offset:26624
    s_waitcnt lgkmcnt(3)
    v_mfma_f32_16x16x32_bf16 v[108:111], v[36:39], v[228:231], v[108:111]
    ds_read_b128 v[20:23], v120 offset:27648
    buffer_store_dword v106, v9, s[4:7], s44 offen sc1
    s_add_u32 s44, s44, 8192
    s_waitcnt lgkmcnt(3)
    v_mfma_f32_16x16x32_bf16 v[108:111], v[40:43], v[232:235], v[108:111]
    ds_read_b128 v[24:27], v120 offset:28672
    s_waitcnt lgkmcnt(3)
    v_mfma_f32_16x16x32_bf16 v[108:111], v[44:47], v[236:239], v[108:111]
    ds_read_b128 v[28:31], v120 offset:29696
    buffer_store_dword v107, v9, s[4:7], s44 offen sc1
    s_add_u32 s44, s44, 106496
    s_waitcnt lgkmcnt(3)
    v_mfma_f32_16x16x32_bf16 v[108:111], v[16:19], v[240:243], v[108:111]
    s_waitcnt lgkmcnt(2)
    v_mfma_f32_16x16x32_bf16 v[108:111], v[20:23], v[244:247], v[108:111]
    s_waitcnt lgkmcnt(1)
    v_mfma_f32_16x16x32_bf16 v[108:111], v[24:27], v[248:251], v[108:111]
    s_waitcnt lgkmcnt(0)
    v_mfma_f32_16x16x32_bf16 v[108:111], v[28:31], v[252:255], v[108:111]
    s_nop 7
    buffer_store_dword v108, v9, s[4:7], s44 offen sc1
    s_add_u32 s44, s44, 8192
    buffer_store_dword v109, v9, s[4:7], s44 offen sc1
    s_add_u32 s44, s44, 8192
    buffer_store_dword v110, v9, s[4:7], s44 offen sc1
    s_add_u32 s44, s44, 8192
    buffer_store_dword v111, v9, s[4:7], s44 offen sc1
    s_add_u32 s44, s44, 106496
L_p2_S_gbx:
    s_or_b32 s40, s15, s20
    s_cbranch_scc1 L_p2_S_n3
    s_lshl_b32 s41, s22, 13
    s_add_u32 s41, s41, s26
    s_add_u32 s41, s41, 524288
    s_add_u32 s42, s41, 4096
    s_sleep 4
L_p2_S_rb:
    buffer_load_dwordx4 v[16:19], v3, s[4:7], s41 offen offset:0 sc1
    buffer_load_dwordx4 v[20:23], v3, s[4:7], s41 offen offset:1024 sc1
    buffer_load_dwordx4 v[24:27], v3, s[4:7], s41 offen offset:2048 sc1
    buffer_load_dwordx4 v[28:31], v3, s[4:7], s41 offen offset:3072 sc1
    buffer_load_dwordx4 v[32:35], v3, s[4:7], s42 offen offset:0 sc1
    buffer_load_dwordx4 v[36:39], v3, s[4:7], s42 offen offset:1024 sc1
    buffer_load_dwordx4 v[40:43], v3, s[4:7], s42 offen offset:2048 sc1
    buffer_load_dwordx4 v[44:47], v3, s[4:7], s42 offen offset:3072 sc1
    s_add_u32 s17, s17, 4
    s_cmp_gt_u32 s17, 0x400000
    s_waitcnt vmcnt(5)
    v_pk_add_f32 v[16:17], v[16:17], v[24:25]
    v_pk_add_f32 v[18:19], v[18:19], v[26:27]
    s_waitcnt vmcnt(4)
    v_pk_add_f32 v[20:21], v[20:21], v[28:29]
    v_pk_add_f32 v[22:23], v[22:23], v[30:31]
    s_waitcnt vmcnt(3)
    v_pk_add_f32 v[16:17], v[16:17], v[32:33]
    v_pk_add_f32 v[18:19], v[18:19], v[34:35]
    s_waitcnt vmcnt(2)
    v_pk_add_f32 v[20:21], v[20:21], v[36:37]
    v_pk_add_f32 v[22:23], v[22:23], v[38:39]
    s_waitcnt vmcnt(1)
    v_pk_add_f32 v[16:17], v[16:17], v[40:41]
    v_pk_add_f32 v[18:19], v[18:19], v[42:43]
    s_waitcnt vmcnt(0)
    v_pk_add_f32 v[20:21], v[20:21], v[44:45]
    v_pk_add_f32 v[22:23], v[22:23], v[46:47]
    v_pk_add_f32 v[24:25], v[16:17], v[18:19]
    v_pk_add_f32 v[26:27], v[20:21], v[22:23]
    v_pk_add_f32 v[24:25], v[24:25], v[26:27]
    v_cmp_u_f32 vcc, v24, v25
    s_cbranch_scc1 L_p2_S_rbx
    s_cbranch_vccnz L_p2_S_rb
L_p2_S_rbx:
    v_cvt_pk_bf16_f32 v120, v16, v17
    v_lshlrev_b32 v16, 16, v120
    v_and_b32 v17, s16, v120
    v_cvt_pk_bf16_f32 v120, v18, v19
    v_lshlrev_b32 v18, 16, v120
    v_and_b32 v19, s16, v120
    v_cvt_pk_bf16_f32 v120, v20, v21
    v_lshlrev_b32 v20, 16, v120
    v_and_b32 v21, s16, v120
    v_cvt_pk_bf16_f32 v120, v22, v23
    v_lshlrev_b32 v22, 16, v120
    v_and_b32 v23, s16, v120
    v_pk_mul_f32 v[16:17], v[16:17], v[192:193]
    v_pk_mul_f32 v[18:19], v[18:19], v[194:195]
    v_pk_mul_f32 v[20:21], v[20:21], v[196:197]
    v_pk_mul_f32 v[22:23], v[22:23], v[198:199]
    v_cvt_pk_bf16_f32 v120, v16, v17
    v_lshlrev_b32 v16, 16, v120
    v_and_b32 v17, s16, v120
    v_cvt_pk_bf16_f32 v120, v18, v19
    v_lshlrev_b32 v18, 16, v120
    v_and_b32 v19, s16, v120
    v_cvt_pk_bf16_f32 v120, v20, v21
    v_lshlrev_b32 v20, 16, v120
    v_and_b32 v21, s16, v120
    v_cvt_pk_bf16_f32 v120, v22, v23
    v_lshlrev_b32 v22, 16, v120
    v_and_b32 v23, s16, v120
    v_pk_add_f32 v[16:17], v[16:17], v[140:141]
    v_pk_add_f32 v[18:19], v[18:19], v[142:143]
    v_pk_add_f32 v[20:21], v[20:21], v[144:145]
    v_pk_add_f32 v[22:23], v[22:23], v[146:147]
    v_cvt_pk_bf16_f32 v24, v16, v17
    v_cvt_pk_bf16_f32 v25, v18, v19
    v_cvt_pk_bf16_f32 v26, v20, v21
    v_cvt_pk_bf16_f32 v27, v22, v23
    v_add_u32 v120, s46, v149
    global_store_dwordx2 v120, v[24:25], s[76:77] offset:0
    global_store_dwordx2 v120, v[26:27], s[76:77] offset:512
    s_cmp_ge_u32 s25, 64
    s_cbranch_scc1 L_p2_S_n4
    buffer_store_dwordx4 v[152:155], v3, s[4:7], s41 offen offset:0 sc1
    buffer_store_dwordx4 v[152:155], v3, s[4:7], s41 offen offset:1024 sc1
    buffer_store_dwordx4 v[152:155], v3, s[4:7], s41 offen offset:2048 sc1
    buffer_store_dwordx4 v[152:155], v3, s[4:7], s41 offen offset:3072 sc1
    buffer_store_dwordx4 v[152:155], v3, s[4:7], s42 offen offset:0 sc1
    buffer_store_dwordx4 v[152:155], v3, s[4:7], s42 offen offset:1024 sc1
    buffer_store_dwordx4 v[152:155], v3, s[4:7], s42 offen offset:2048 sc1
    buffer_store_dwordx4 v[152:155], v3, s[4:7], s42 offen offset:3072 sc1
L_p2_S_n4:
L_p2_S_n3:
    s_lshl_b32 s41, s22, 2
    s_add_u32 s41, s41, s15
    s_lshl_b32 s41, s41, 11
    s_add_u32 s41, s41, s26
    s_add_u32 s41, s41, 262144
    s_cmp_ge_u32 s25, 64
    s_cbranch_scc1 L_p2_S_end
    s_barrier
    buffer_store_dwordx4 v[152:155], v3, s[4:7], s41 offen offset:0 sc1
    buffer_store_dwordx4 v[152:155], v3, s[4:7], s41 offen offset:1024 sc1
    s_mov_b32 s23, s25
    s_branch L_p2_S
L_p2_S_end:
    s_endpgm
L_p2_S_kd:
    s_cmp_ge_u32 s23, 62
    s_cbranch_scc1 L_p2_S_ke
    s_sleep 6
L_p2_S_ke:
    buffer_load_dwordx4 v[80:83], v3, s[4:7], s45 offen offset:0 sc1
    buffer_load_dwordx4 v[84:87], v3, s[4:7], s45 offen offset:1024 sc1
    s_branch L_p2_S_kc
L_p2_S_gah:
    s_nop 5
    buffer_store_dword v104, v9, s[4:7], s44 offen sc1
    s_add_u32 s44, s44, 8192
    buffer_store_dword v105, v9, s[4:7], s44 offen sc1
    s_add_u32 s44, s44, 8192
    buffer_store_dword v106, v9, s[4:7], s44 offen sc1
    s_add_u32 s44, s44, 8192
    buffer_store_dword v107, v9, s[4:7], s44 offen sc1
    s_add_u32 s44, s44, 106496
    s_waitcnt lgkmcnt(0)
    s_branch L_p2_S_gax
L_p2_S_gbh:
    s_nop 5
    buffer_store_dword v104, v9, s[4:7], s44 offen sc1
    s_add_u32 s44, s44, 8192
    buffer_store_dword v105, v9, s[4:7], s44 offen sc1
    s_add_u32 s44, s44, 8192
    buffer_store_dword v106, v9, s[4:7], s44 offen sc1
    s_add_u32 s44, s44, 8192
    buffer_store_dword v107, v9, s[4:7], s44 offen sc1
    s_add_u32 s44, s44, 106496
    s_waitcnt lgkmcnt(0)
    s_branch L_p2_S_gbx
L_codeend:
    s_endpgm
.section .rodata,"a"
.p2align 6
.amdhsa_kernel adaLN_cond__memory_aug_recurrent_mem_tr__dense_activation_relu__prompt_kernel
  .amdhsa_next_free_vgpr 512
  .amdhsa_next_free_sgpr 102
  .amdhsa_accum_offset 256
  .amdhsa_group_segment_fixed_size 0
  .amdhsa_kernarg_size 120
  .amdhsa_user_sgpr_count 2
  .amdhsa_user_sgpr_kernarg_segment_ptr 1
  .amdhsa_system_sgpr_workgroup_id_x 1
  .amdhsa_float_denorm_mode_32 3
.end_amdhsa_kernel
```
